```python
import torch

def _softmax(x, axis=-1):
    return torch.softmax(x, dim=axis)
def _gelu(x):
    return torch.nn.functional.gelu(x, approximate="tanh")
def _silu(x):
    return torch.nn.functional.silu(x)
def _sigmoid(x):
    return torch.sigmoid(x)
def _layernorm(x, axis=-1, eps=1e-5):
    m = x.mean(dim=axis, keepdim=True)
    v = x.var(dim=axis, keepdim=True, unbiased=False)
    return (x - m) / torch.sqrt(v + eps)
def _scatter_add(tgt, idx, src, axis=0):
    return tgt.clone().index_add_(axis, idx, src)
def _segment_sum(src, seg, n):
    out = torch.zeros((n,) + src.shape[1:], dtype=src.dtype)
    return out.index_add_(0, seg, src)
def _pad(x, pw):
    flat = tuple(v for pair in reversed(pw) for v in pair)
    return torch.nn.functional.pad(x, flat)

kernel_name = 'parallel_sum__sliding_block__glu_gated_bilinear__prompt'

def setup_inputs():

    _w = (lambda a: (lambda t: t.to(torch.bfloat16) if t.is_floating_point() else t)(torch.as_tensor(a)))
    def _A_setup():
        B, S, D = 1, 2048, 576
        return {
            "x": _w((lambda *s: torch.randn(*s, dtype=torch.bfloat16) * 0.05)(B, S, D)),
            "wqkv": _w((lambda *s: torch.randn(*s, dtype=torch.bfloat16) * 0.05)(D, 3 * D)),
            "wo": _w((lambda *s: torch.randn(*s, dtype=torch.bfloat16) * 0.05)(D, D)),
        }
    _A_in = _A_setup()

    def _B_setup():
        B, S, D, F = 1, 2048, 576, 4608
        return {
            "x": _w((lambda *s: torch.randn(*s, dtype=torch.bfloat16) * 0.05)(B, S, D)),
            "w_gate": _w((lambda *s: torch.randn(*s, dtype=torch.bfloat16) * 0.8)(D, F) * (D ** -0.5)),
            "w_up": _w((lambda *s: torch.randn(*s, dtype=torch.bfloat16) * 0.8)(D, F) * (D ** -0.5)),
            "w_down": _w((lambda *s: torch.randn(*s, dtype=torch.bfloat16) * 0.8)(F, D) * (F ** -0.5)),
        }
    _B_in = _B_setup()

    return {
        "A_x": _A_in["x"],
        "A_wqkv": _A_in["wqkv"],
        "A_wo": _A_in["wo"],
        "B_x": _B_in["x"],
        "B_w_gate": _B_in["w_gate"],
        "B_w_up": _B_in["w_up"],
        "B_w_down": _B_in["w_down"],
    }

def reference(A_x, A_wqkv, A_wo, B_x, B_w_gate, B_w_up, B_w_down):
    def _A_ref(x, wqkv, wo):
        B, S, D = x.shape
        H = 32; Dh = D // H; W = 256
        qkv = (lambda x, *d: x.permute(*d))((x @ wqkv).reshape(B, S, 3, H, Dh), 2, 0, 3, 1, 4)
        q, k, v = qkv[0], qkv[1], qkv[2]
        scores = torch.einsum("bhqd,bhkd->bhqk", q, k) * (Dh ** -0.5)
        idx = torch.arange(S)
        mask = (idx[:, None] - idx[None, :] >= 0) & (idx[:, None] - idx[None, :] < W)
        scores = torch.where(mask[None, None], scores, -1e9)
        p = _softmax(scores, axis=-1)
        o = torch.einsum("bhqk,bhkd->bhqd", p, v)
        return (lambda x, *d: x.permute(*d))(o, 0, 2, 1, 3).reshape(B, S, D) @ wo

    def _B_ref(x, w_gate, w_up, w_down):
        g = torch.einsum("bsd,df->bsf", x, w_gate)
        u = torch.einsum("bsd,df->bsf", x, w_up)
        h = g * u
        return torch.einsum("bsf,fd->bsd", h, w_down)

    x = A_x
    xn = _layernorm(x, axis=-1)
    return x + _A_ref(xn, A_wqkv, A_wo) + _B_ref(xn, B_w_gate, B_w_up, B_w_down)
```

```asm
; @launch grid=(256,1,1) block=(512,1,1) lds=159744
.amdgcn_target "amdgcn-amd-amdhsa--gfx950"
.text
.globl parallel_sum__sliding_block__glu_gated_bilinear__prompt_kernel
.p2align 8
.type parallel_sum__sliding_block__glu_gated_bilinear__prompt_kernel,@function
parallel_sum__sliding_block__glu_gated_bilinear__prompt_kernel:

    s_cmp_ge_u32 s2, 256
    s_cbranch_scc1 L_end
    s_load_dwordx4 s[4:7], s[0:1], 0
    s_load_dwordx4 s[8:11], s[0:1], 32
    s_load_dwordx4 s[12:15], s[0:1], 64
    s_load_dwordx2 s[44:45], s[0:1], 16
    s_load_dwordx4 s[48:51], s[0:1], 48
    s_memrealtime s[92:93]
    s_getpc_b64 s[96:97]
    s_lshr_b32 s3, s2, 3
    s_lshl_b32 s3, s3, 11
    v_lshl_add_u32 v14, v0, 7, s3
    v_min_u32 v14, L_code_end-parallel_sum__sliding_block__glu_gated_bilinear__prompt_kernel-192, v14
    v_cmp_gt_u32 vcc, 16, v0
    s_and_saveexec_b64 s[88:89], vcc
    s_cbranch_execz L_nocpf
    global_load_dword v255, v14, s[96:97]
L_nocpf:
    s_mov_b64 exec, s[88:89]
    v_and_b32 v1, 63, v0
    v_lshrrev_b32 v236, 6, v0
    s_and_b32 s38, s2, 7
    s_lshr_b32 s39, s2, 3
    v_readfirstlane_b32 s36, v236
    s_and_b32 s79, s39, 7
    s_lshr_b32 s41, s39, 3
    s_and_b32 s42, s38, 1
    s_lshr_b32 s40, s38, 1
    s_lshl_b32 s52, s42, 3
    s_add_u32 s52, s52, s79
    s_lshl_b32 s53, s40, 2
    s_add_u32 s53, s53, s41
    s_mul_i32 s43, s79, 1
    s_mul_i32 s41, s41, 2
    s_mul_i32 s40, s40, 1
    s_add_u32 s54, s43, s41
    s_add_u32 s54, s54, s40
    s_mul_i32 s40, s54, 57
    s_lshr_b32 s40, s40, 9
    s_mul_i32 s40, s40, 9
    s_sub_u32 s54, s54, s40
    s_and_b32 s37, s36, 3
    s_cmp_ge_u32 s36, 4
    s_cbranch_scc1 L_loader
    s_lshl_b32 s40, s52, 7
    s_lshl_b32 s41, s36, 5
    s_add_u32 s40, s40, s41
    s_mul_i32 s67, s40, 1152
    s_lshl_b32 s68, s54, 7
    s_mul_i32 s69, s36, 18432
    s_add_u32 s69, s69, 77824
    v_lshrrev_b32 v237, 3, v1
    v_and_b32 v238, 7, v1
    v_mul_u32_u24 v240, 1152, v237
    v_lshrrev_b32 v241, 4, v1
    v_xor_b32 v242, v238, v241
    v_lshl_add_u32 v236, v242, 4, v240
    v_xor_b32 v242, 4, v242
    v_lshl_add_u32 v239, v242, 4, v240
    v_add_u32 v239, 9216, v239
    s_waitcnt lgkmcnt(0)
    s_mov_b32 s16, s4
    s_mov_b32 s17, s5
    s_mov_b32 s18, 2359296
    s_mov_b32 s19, 0x00020000
    s_add_u32 s42, s67, s68
    s_add_u32 m0, s69, 0
    s_add_u32 s43, s42, 18432
    buffer_load_dwordx4 v236, s[16:19], s42 offen lds
    s_add_u32 m0, s69, 1024
    s_add_u32 s68, s68, 128
    buffer_load_dwordx4 v239, s[16:19], s42 offen lds
    s_add_u32 m0, s69, 2048
    s_cmp_eq_u32 s68, 1152
    buffer_load_dwordx4 v236, s[16:19], s43 offen lds
    s_cselect_b32 s68, 0, s68
    s_add_u32 m0, s69, 3072
    s_nop 0
    buffer_load_dwordx4 v239, s[16:19], s43 offen lds
    s_add_u32 s42, s67, s68
    s_add_u32 m0, s69, 4096
    s_add_u32 s43, s42, 18432
    buffer_load_dwordx4 v236, s[16:19], s42 offen lds
    s_add_u32 m0, s69, 5120
    s_add_u32 s68, s68, 128
    buffer_load_dwordx4 v239, s[16:19], s42 offen lds
    s_add_u32 m0, s69, 6144
    s_cmp_eq_u32 s68, 1152
    buffer_load_dwordx4 v236, s[16:19], s43 offen lds
    s_cselect_b32 s68, 0, s68
    s_add_u32 m0, s69, 7168
    s_nop 0
    buffer_load_dwordx4 v239, s[16:19], s43 offen lds
    s_and_b32 s40, s38, 1
    s_lshl_b32 s40, s40, 2
    s_and_b32 s41, s39, 3
    s_add_u32 s40, s40, s41
    s_lshr_b32 s41, s38, 1
    s_lshl_b32 s41, s41, 3
    s_lshr_b32 s39, s39, 2
    s_add_u32 s39, s39, s41
    s_mov_b32 s38, s40
    s_mov_b32 s32, s14
    s_mov_b32 s33, s15
    s_mov_b32 s34, 29466624
    s_mov_b32 s35, 0x00020000
    s_lshr_b32 s40, s53, 1
    s_bitcmp1_b32 0x15, s40
    s_cselect_b32 s55, 3, 2
    s_add_u32 s57, s40, 1
    s_lshr_b32 s57, s57, 1
    s_min_u32 s57, s57, 3
    s_lshl_b32 s41, s40, 1
    s_add_u32 s57, s57, s41
    s_add_u32 s57, s57, 8
    s_add_u32 s58, s40, 16
    s_bitcmp0_b32 s53, 0
    s_cselect_b32 s55, 1, s55
    s_cselect_b32 s57, s40, s57
    s_cselect_b32 s58, s41, s58
    s_cselect_b32 s94, 2, 1
    s_lshl_b32 s60, s94, 1
    s_add_u32 s60, s60, 6
    s_add_u32 s60, s60, s55
    s_mul_i32 s71, s60, 3
    v_lshlrev_b32 v6, 4, v1
    v_and_b32 v242, 15, v1
    v_lshrrev_b32 v245, 1, v242
    v_xor_b32 v245, v245, v241
    v_lshlrev_b32 v245, 4, v245
    v_lshl_add_u32 v245, v242, 7, v245
    v_add_u32 v243, s69, v245
    v_xor_b32 v245, 64, v245
    v_add_u32 v244, s69, v245
    v_lshrrev_b32 v245, 2, v242
    v_cmp_eq_u32 vcc, v245, v241
    v_and_b32 v245, 1, v1
    v_lshlrev_b32 v245, 4, v245
    v_mov_b32 v237, 0x3f80
    v_lshlrev_b32 v245, v245, v237
    v_cndmask_b32 v245, 0, v245, vcc
    s_mov_b32 s72, 0xcccccccc
    s_mov_b32 s73, 0xcccccccc
    s_mov_b32 s74, 0xaaaaaaaa
    s_mov_b32 s75, 0xaaaaaaaa
    s_mov_b32 s76, 0xf0000f
    s_mov_b32 s77, 0xf0000f00
    v_cndmask_b32 v226, v245, 0, s[72:73]
    v_cndmask_b32 v227, 0, v245, s[72:73]
    v_mov_b32 v224, 0
    v_mov_b32 v225, 0
    v_mov_b32 v228, 0
    v_mov_b32 v229, 0
    v_mov_b32 v232, 0x3f803f80
    v_mov_b32 v233, 0x3f803f80
    v_mov_b32 v234, 0x3f803f80
    v_mov_b32 v235, 0x3f803f80
    v_mul_u32_u24 v245, 18432, v241
    v_add_u32 v245, 4096, v245
    v_bfe_u32 v242, v1, 2, 2
    v_lshl_add_u32 v245, v242, 6, v245
    v_and_b32 v242, 3, v1
    v_lshl_add_u32 v245, v242, 3, v245
    v_and_b32 v242, 1, v241
    v_lshl_add_u32 v2, v242, 5, v245
    v_xor_b32 v3, 32, v2
    v_add_u32 v4, 73728, v2
    v_add_u32 v5, 73728, v3
    s_add_u32 s42, s67, s68
    s_add_u32 m0, s69, 8192
    s_add_u32 s43, s42, 18432
    buffer_load_dwordx4 v236, s[16:19], s42 offen lds
    s_add_u32 m0, s69, 9216
    s_add_u32 s68, s68, 128
    buffer_load_dwordx4 v239, s[16:19], s42 offen lds
    s_add_u32 m0, s69, 10240
    s_cmp_eq_u32 s68, 1152
    buffer_load_dwordx4 v236, s[16:19], s43 offen lds
    s_cselect_b32 s68, 0, s68
    s_add_u32 m0, s69, 11264
    s_nop 0
    buffer_load_dwordx4 v239, s[16:19], s43 offen lds
    s_add_u32 s42, s67, s68
    s_add_u32 m0, s69, 12288
    s_add_u32 s43, s42, 18432
    buffer_load_dwordx4 v236, s[16:19], s42 offen lds
    s_add_u32 m0, s69, 13312
    s_add_u32 s68, s68, 128
    buffer_load_dwordx4 v239, s[16:19], s42 offen lds
    s_add_u32 m0, s69, 14336
    s_cmp_eq_u32 s68, 1152
    buffer_load_dwordx4 v236, s[16:19], s43 offen lds
    s_cselect_b32 s68, 0, s68
    s_add_u32 m0, s69, 15360
    s_nop 0
    buffer_load_dwordx4 v239, s[16:19], s43 offen lds
    s_lshl_b32 s40, s52, 3
    s_lshl_b32 s41, s36, 1
    s_add_u32 s40, s40, s41
    s_add_u32 s40, s40, 0
    s_mul_i32 s41, s40, 205
    s_lshr_b32 s41, s41, 10
    s_mul_i32 s41, s41, 835
    s_add_u32 s40, s40, s41
    s_lshl_b32 s63, s40, 10
    s_lshl_b32 s40, s52, 3
    s_lshl_b32 s41, s36, 1
    s_add_u32 s40, s40, s41
    s_add_u32 s40, s40, 1
    s_mul_i32 s41, s40, 205
    s_lshr_b32 s41, s41, 10
    s_mul_i32 s41, s41, 835
    s_add_u32 s40, s40, s41
    s_lshl_b32 s64, s40, 10
    s_lshl_b32 s91, s52, 6
    s_add_u32 s91, s91, s53
    s_lshl_b32 s91, s91, 2
    s_add_u32 s91, s91, 29442048
    s_mov_b32 s78, 0
    s_lshl_b32 s40, s52, 2
    s_add_u32 s40, s40, s36
    s_mul_i32 s40, s40, 108
    s_lshl_b32 s41, s57, 2
    s_add_u32 s40, s40, s41
    s_lshl_b32 s65, s40, 10
    s_add_u32 s65, s65, 22364160
    s_waitcnt vmcnt(12)
    ds_read_b128 v[16:19], v243 offset:0
    ds_read_b128 v[20:23], v243 offset:2048
    ds_read_b128 v[24:27], v244 offset:0
    ds_read_b128 v[28:31], v244 offset:2048
    s_waitcnt vmcnt(8)
    ds_read_b128 v[32:35], v243 offset:4096
    ds_read_b128 v[36:39], v243 offset:6144
    ds_read_b128 v[40:43], v244 offset:4096
    ds_read_b128 v[44:47], v244 offset:6144
    s_waitcnt lgkmcnt(4)
    s_add_u32 s42, s67, s68
    s_add_u32 m0, s69, 0
    s_add_u32 s43, s42, 18432
    buffer_load_dwordx4 v236, s[16:19], s42 offen lds
    s_add_u32 m0, s69, 1024
    s_add_u32 s68, s68, 128
    buffer_load_dwordx4 v239, s[16:19], s42 offen lds
    s_add_u32 m0, s69, 2048
    s_cmp_eq_u32 s68, 1152
    buffer_load_dwordx4 v236, s[16:19], s43 offen lds
    s_cselect_b32 s68, 0, s68
    s_add_u32 m0, s69, 3072
    s_nop 0
    buffer_load_dwordx4 v239, s[16:19], s43 offen lds
    v_mfma_f32_16x16x32_bf16 v[160:163], v[232:235], v[16:19], 0
    v_mfma_f32_16x16x32_bf16 v[208:211], v[16:19], v[16:19], 0
    v_mfma_f32_16x16x32_bf16 v[164:167], v[232:235], v[20:23], 0
    v_mfma_f32_16x16x32_bf16 v[212:215], v[20:23], v[20:23], 0
    v_mfma_f32_16x16x32_bf16 v[160:163], v[232:235], v[24:27], v[160:163]
    v_mfma_f32_16x16x32_bf16 v[208:211], v[24:27], v[24:27], v[208:211]
    v_mfma_f32_16x16x32_bf16 v[164:167], v[232:235], v[28:31], v[164:167]
    v_mfma_f32_16x16x32_bf16 v[212:215], v[28:31], v[28:31], v[212:215]
    s_waitcnt vmcnt(8)
    ds_read_b128 v[48:51], v243 offset:8192
    ds_read_b128 v[52:55], v243 offset:10240
    ds_read_b128 v[56:59], v244 offset:8192
    ds_read_b128 v[60:63], v244 offset:10240
    s_waitcnt lgkmcnt(4)
    s_add_u32 s42, s67, s68
    s_add_u32 m0, s69, 4096
    s_add_u32 s43, s42, 18432
    buffer_load_dwordx4 v236, s[16:19], s42 offen lds
    s_add_u32 m0, s69, 5120
    s_add_u32 s68, s68, 128
    buffer_load_dwordx4 v239, s[16:19], s42 offen lds
    s_add_u32 m0, s69, 6144
    s_cmp_eq_u32 s68, 1152
    buffer_load_dwordx4 v236, s[16:19], s43 offen lds
    s_cselect_b32 s68, 0, s68
    s_add_u32 m0, s69, 7168
    s_nop 0
    buffer_load_dwordx4 v239, s[16:19], s43 offen lds
    v_mfma_f32_16x16x32_bf16 v[160:163], v[232:235], v[32:35], v[160:163]
    v_mfma_f32_16x16x32_bf16 v[208:211], v[32:35], v[32:35], v[208:211]
    v_mfma_f32_16x16x32_bf16 v[164:167], v[232:235], v[36:39], v[164:167]
    v_mfma_f32_16x16x32_bf16 v[212:215], v[36:39], v[36:39], v[212:215]
    v_mfma_f32_16x16x32_bf16 v[160:163], v[232:235], v[40:43], v[160:163]
    v_mfma_f32_16x16x32_bf16 v[208:211], v[40:43], v[40:43], v[208:211]
    v_mfma_f32_16x16x32_bf16 v[164:167], v[232:235], v[44:47], v[164:167]
    v_mfma_f32_16x16x32_bf16 v[212:215], v[44:47], v[44:47], v[212:215]
    s_waitcnt vmcnt(8)
    ds_read_b128 v[64:67], v243 offset:12288
    ds_read_b128 v[68:71], v243 offset:14336
    ds_read_b128 v[72:75], v244 offset:12288
    ds_read_b128 v[76:79], v244 offset:14336
    s_waitcnt lgkmcnt(4)
    s_add_u32 s42, s67, s68
    s_add_u32 m0, s69, 8192
    s_add_u32 s43, s42, 18432
    buffer_load_dwordx4 v236, s[16:19], s42 offen lds
    s_add_u32 m0, s69, 9216
    s_add_u32 s68, s68, 128
    buffer_load_dwordx4 v239, s[16:19], s42 offen lds
    s_add_u32 m0, s69, 10240
    s_cmp_eq_u32 s68, 1152
    buffer_load_dwordx4 v236, s[16:19], s43 offen lds
    s_cselect_b32 s68, 0, s68
    s_add_u32 m0, s69, 11264
    s_nop 0
    buffer_load_dwordx4 v239, s[16:19], s43 offen lds
    v_mfma_f32_16x16x32_bf16 v[160:163], v[232:235], v[48:51], v[160:163]
    v_mfma_f32_16x16x32_bf16 v[208:211], v[48:51], v[48:51], v[208:211]
    v_mfma_f32_16x16x32_bf16 v[164:167], v[232:235], v[52:55], v[164:167]
    v_mfma_f32_16x16x32_bf16 v[212:215], v[52:55], v[52:55], v[212:215]
    v_mfma_f32_16x16x32_bf16 v[160:163], v[232:235], v[56:59], v[160:163]
    v_mfma_f32_16x16x32_bf16 v[208:211], v[56:59], v[56:59], v[208:211]
    v_mfma_f32_16x16x32_bf16 v[164:167], v[232:235], v[60:63], v[164:167]
    v_mfma_f32_16x16x32_bf16 v[212:215], v[60:63], v[60:63], v[212:215]
    s_waitcnt vmcnt(8)
    ds_read_b128 v[80:83], v243 offset:0
    ds_read_b128 v[84:87], v243 offset:2048
    ds_read_b128 v[88:91], v244 offset:0
    ds_read_b128 v[92:95], v244 offset:2048
    s_waitcnt lgkmcnt(4)
    s_add_u32 s42, s67, s68
    s_add_u32 m0, s69, 12288
    s_add_u32 s43, s42, 18432
    buffer_load_dwordx4 v236, s[16:19], s42 offen lds
    s_add_u32 m0, s69, 13312
    s_add_u32 s68, s68, 128
    buffer_load_dwordx4 v239, s[16:19], s42 offen lds
    s_add_u32 m0, s69, 14336
    s_cmp_eq_u32 s68, 1152
    buffer_load_dwordx4 v236, s[16:19], s43 offen lds
    s_cselect_b32 s68, 0, s68
    s_add_u32 m0, s69, 15360
    s_nop 0
    buffer_load_dwordx4 v239, s[16:19], s43 offen lds
    v_mfma_f32_16x16x32_bf16 v[160:163], v[232:235], v[64:67], v[160:163]
    v_mfma_f32_16x16x32_bf16 v[208:211], v[64:67], v[64:67], v[208:211]
    v_mfma_f32_16x16x32_bf16 v[164:167], v[232:235], v[68:71], v[164:167]
    v_mfma_f32_16x16x32_bf16 v[212:215], v[68:71], v[68:71], v[212:215]
    v_mfma_f32_16x16x32_bf16 v[160:163], v[232:235], v[72:75], v[160:163]
    v_mfma_f32_16x16x32_bf16 v[208:211], v[72:75], v[72:75], v[208:211]
    v_mfma_f32_16x16x32_bf16 v[164:167], v[232:235], v[76:79], v[164:167]
    v_mfma_f32_16x16x32_bf16 v[212:215], v[76:79], v[76:79], v[212:215]
    s_waitcnt vmcnt(8)
    ds_read_b128 v[96:99], v243 offset:4096
    ds_read_b128 v[100:103], v243 offset:6144
    ds_read_b128 v[104:107], v244 offset:4096
    ds_read_b128 v[108:111], v244 offset:6144
    s_waitcnt lgkmcnt(4)
    s_add_u32 s42, s67, s68
    s_add_u32 m0, s69, 0
    s_add_u32 s43, s42, 18432
    buffer_load_dwordx4 v236, s[16:19], s42 offen lds
    s_add_u32 m0, s69, 1024
    s_add_u32 s68, s68, 128
    buffer_load_dwordx4 v239, s[16:19], s42 offen lds
    s_add_u32 m0, s69, 2048
    s_cmp_eq_u32 s68, 1152
    buffer_load_dwordx4 v236, s[16:19], s43 offen lds
    s_cselect_b32 s68, 0, s68
    s_add_u32 m0, s69, 3072
    s_nop 0
    buffer_load_dwordx4 v239, s[16:19], s43 offen lds
    v_mfma_f32_16x16x32_bf16 v[160:163], v[232:235], v[80:83], v[160:163]
    v_mfma_f32_16x16x32_bf16 v[208:211], v[80:83], v[80:83], v[208:211]
    v_mfma_f32_16x16x32_bf16 v[164:167], v[232:235], v[84:87], v[164:167]
    v_mfma_f32_16x16x32_bf16 v[212:215], v[84:87], v[84:87], v[212:215]
    v_mfma_f32_16x16x32_bf16 v[160:163], v[232:235], v[88:91], v[160:163]
    v_mfma_f32_16x16x32_bf16 v[208:211], v[88:91], v[88:91], v[208:211]
    v_mfma_f32_16x16x32_bf16 v[164:167], v[232:235], v[92:95], v[164:167]
    v_mfma_f32_16x16x32_bf16 v[212:215], v[92:95], v[92:95], v[212:215]
    s_waitcnt vmcnt(8)
    ds_read_b128 v[112:115], v243 offset:8192
    ds_read_b128 v[116:119], v243 offset:10240
    ds_read_b128 v[120:123], v244 offset:8192
    ds_read_b128 v[124:127], v244 offset:10240
    s_waitcnt lgkmcnt(4)
    v_mfma_f32_16x16x32_bf16 v[160:163], v[232:235], v[96:99], v[160:163]
    v_mfma_f32_16x16x32_bf16 v[208:211], v[96:99], v[96:99], v[208:211]
    v_mfma_f32_16x16x32_bf16 v[164:167], v[232:235], v[100:103], v[164:167]
    v_mfma_f32_16x16x32_bf16 v[212:215], v[100:103], v[100:103], v[212:215]
    v_mfma_f32_16x16x32_bf16 v[160:163], v[232:235], v[104:107], v[160:163]
    v_mfma_f32_16x16x32_bf16 v[208:211], v[104:107], v[104:107], v[208:211]
    v_mfma_f32_16x16x32_bf16 v[164:167], v[232:235], v[108:111], v[164:167]
    v_mfma_f32_16x16x32_bf16 v[212:215], v[108:111], v[108:111], v[212:215]
    s_waitcnt vmcnt(4)
    ds_read_b128 v[128:131], v243 offset:12288
    ds_read_b128 v[132:135], v243 offset:14336
    ds_read_b128 v[136:139], v244 offset:12288
    ds_read_b128 v[140:143], v244 offset:14336
    s_waitcnt lgkmcnt(4)
    v_mfma_f32_16x16x32_bf16 v[160:163], v[232:235], v[112:115], v[160:163]
    v_mfma_f32_16x16x32_bf16 v[208:211], v[112:115], v[112:115], v[208:211]
    v_mfma_f32_16x16x32_bf16 v[164:167], v[232:235], v[116:119], v[164:167]
    v_mfma_f32_16x16x32_bf16 v[212:215], v[116:119], v[116:119], v[212:215]
    v_mfma_f32_16x16x32_bf16 v[160:163], v[232:235], v[120:123], v[160:163]
    v_mfma_f32_16x16x32_bf16 v[208:211], v[120:123], v[120:123], v[208:211]
    v_mfma_f32_16x16x32_bf16 v[164:167], v[232:235], v[124:127], v[164:167]
    v_mfma_f32_16x16x32_bf16 v[212:215], v[124:127], v[124:127], v[212:215]
    s_waitcnt vmcnt(0)
    ds_read_b128 v[144:147], v243 offset:0
    ds_read_b128 v[148:151], v243 offset:2048
    ds_read_b128 v[152:155], v244 offset:0
    ds_read_b128 v[156:159], v244 offset:2048
    s_waitcnt lgkmcnt(4)
    v_mfma_f32_16x16x32_bf16 v[160:163], v[232:235], v[128:131], v[160:163]
    v_mfma_f32_16x16x32_bf16 v[208:211], v[128:131], v[128:131], v[208:211]
    v_mfma_f32_16x16x32_bf16 v[164:167], v[232:235], v[132:135], v[164:167]
    v_mfma_f32_16x16x32_bf16 v[212:215], v[132:135], v[132:135], v[212:215]
    v_mfma_f32_16x16x32_bf16 v[160:163], v[232:235], v[136:139], v[160:163]
    v_mfma_f32_16x16x32_bf16 v[208:211], v[136:139], v[136:139], v[208:211]
    v_mfma_f32_16x16x32_bf16 v[164:167], v[232:235], v[140:143], v[164:167]
    v_mfma_f32_16x16x32_bf16 v[212:215], v[140:143], v[140:143], v[212:215]
    s_waitcnt lgkmcnt(0)
    s_barrier
    v_mfma_f32_16x16x32_bf16 v[160:163], v[232:235], v[144:147], v[160:163]
    v_mfma_f32_16x16x32_bf16 v[208:211], v[144:147], v[144:147], v[208:211]
    v_mfma_f32_16x16x32_bf16 v[164:167], v[232:235], v[148:151], v[164:167]
    v_mfma_f32_16x16x32_bf16 v[212:215], v[148:151], v[148:151], v[212:215]
    v_mfma_f32_16x16x32_bf16 v[160:163], v[232:235], v[152:155], v[160:163]
    v_mfma_f32_16x16x32_bf16 v[208:211], v[152:155], v[152:155], v[208:211]
    v_mfma_f32_16x16x32_bf16 v[164:167], v[232:235], v[156:159], v[164:167]
    v_mfma_f32_16x16x32_bf16 v[212:215], v[156:159], v[156:159], v[212:215]
    s_nop 6
    v_mul_f32 v168, 0x3ae38e39, v160
    v_mul_f32 v169, 0x3ae38e39, v164
    v_cvt_pk_bf16_f32 v170, v168, v169
    v_xor_b32 v170, 0x80008000, v170
    v_lshlrev_b32 v160, 16, v170
    v_lshlrev_b32 v161, 16, v170
    v_lshlrev_b32 v162, 16, v170
    v_lshlrev_b32 v163, 16, v170
    v_and_b32 v164, 0xffff0000, v170
    v_and_b32 v165, 0xffff0000, v170
    v_and_b32 v166, 0xffff0000, v170
    v_and_b32 v167, 0xffff0000, v170
    v_mfma_f32_16x16x32_bf16 v[176:179], v[226:229], v[16:19], v[160:163]
    v_mfma_f32_16x16x32_bf16 v[180:183], v[224:227], v[16:19], v[160:163]
    v_mfma_f32_16x16x32_bf16 v[184:187], v[226:229], v[20:23], v[164:167]
    v_mfma_f32_16x16x32_bf16 v[188:191], v[224:227], v[20:23], v[164:167]
    v_mfma_f32_16x16x32_bf16 v[192:195], v[226:229], v[24:27], v[160:163]
    v_mfma_f32_16x16x32_bf16 v[196:199], v[224:227], v[24:27], v[160:163]
    s_nop 3
    v_cvt_pk_bf16_f32 v16, v176, v177
    v_cvt_pk_bf16_f32 v17, v178, v179
    v_mfma_f32_16x16x32_bf16 v[200:203], v[226:229], v[28:31], v[164:167]
    v_cvt_pk_bf16_f32 v18, v180, v181
    v_cvt_pk_bf16_f32 v19, v182, v183
    v_mfma_f32_16x16x32_bf16 v[204:207], v[224:227], v[28:31], v[164:167]
    v_cvt_pk_bf16_f32 v20, v184, v185
    v_cvt_pk_bf16_f32 v21, v186, v187
    v_mfma_f32_16x16x32_bf16 v[176:179], v[226:229], v[32:35], v[160:163]
    v_cvt_pk_bf16_f32 v22, v188, v189
    v_cvt_pk_bf16_f32 v23, v190, v191
    v_mfma_f32_16x16x32_bf16 v[180:183], v[224:227], v[32:35], v[160:163]
    v_cvt_pk_bf16_f32 v24, v192, v193
    v_cvt_pk_bf16_f32 v25, v194, v195
    v_mfma_f32_16x16x32_bf16 v[184:187], v[226:229], v[36:39], v[164:167]
    v_cvt_pk_bf16_f32 v26, v196, v197
    v_cvt_pk_bf16_f32 v27, v198, v199
    v_mfma_f32_16x16x32_bf16 v[188:191], v[224:227], v[36:39], v[164:167]
    v_cvt_pk_bf16_f32 v28, v200, v201
    v_cvt_pk_bf16_f32 v29, v202, v203
    v_mfma_f32_16x16x32_bf16 v[192:195], v[226:229], v[40:43], v[160:163]
    v_cvt_pk_bf16_f32 v30, v204, v205
    v_cvt_pk_bf16_f32 v31, v206, v207
    v_mfma_f32_16x16x32_bf16 v[196:199], v[224:227], v[40:43], v[160:163]
    v_cvt_pk_bf16_f32 v32, v176, v177
    v_cvt_pk_bf16_f32 v33, v178, v179
    v_mfma_f32_16x16x32_bf16 v[200:203], v[226:229], v[44:47], v[164:167]
    v_cvt_pk_bf16_f32 v34, v180, v181
    v_cvt_pk_bf16_f32 v35, v182, v183
    v_mfma_f32_16x16x32_bf16 v[204:207], v[224:227], v[44:47], v[164:167]
    v_cvt_pk_bf16_f32 v36, v184, v185
    v_cvt_pk_bf16_f32 v37, v186, v187
    v_mfma_f32_16x16x32_bf16 v[176:179], v[226:229], v[48:51], v[160:163]
    v_cvt_pk_bf16_f32 v38, v188, v189
    v_cvt_pk_bf16_f32 v39, v190, v191
    v_mfma_f32_16x16x32_bf16 v[180:183], v[224:227], v[48:51], v[160:163]
    v_cvt_pk_bf16_f32 v40, v192, v193
    v_cvt_pk_bf16_f32 v41, v194, v195
    v_mfma_f32_16x16x32_bf16 v[184:187], v[226:229], v[52:55], v[164:167]
    v_cvt_pk_bf16_f32 v42, v196, v197
    v_cvt_pk_bf16_f32 v43, v198, v199
    v_mfma_f32_16x16x32_bf16 v[188:191], v[224:227], v[52:55], v[164:167]
    v_cvt_pk_bf16_f32 v44, v200, v201
    v_cvt_pk_bf16_f32 v45, v202, v203
    v_mfma_f32_16x16x32_bf16 v[192:195], v[226:229], v[56:59], v[160:163]
    v_cvt_pk_bf16_f32 v46, v204, v205
    v_cvt_pk_bf16_f32 v47, v206, v207
    v_mfma_f32_16x16x32_bf16 v[196:199], v[224:227], v[56:59], v[160:163]
    v_cvt_pk_bf16_f32 v48, v176, v177
    v_cvt_pk_bf16_f32 v49, v178, v179
    v_mfma_f32_16x16x32_bf16 v[200:203], v[226:229], v[60:63], v[164:167]
    v_cvt_pk_bf16_f32 v50, v180, v181
    v_cvt_pk_bf16_f32 v51, v182, v183
    v_mfma_f32_16x16x32_bf16 v[204:207], v[224:227], v[60:63], v[164:167]
    v_cvt_pk_bf16_f32 v52, v184, v185
    v_cvt_pk_bf16_f32 v53, v186, v187
    v_mfma_f32_16x16x32_bf16 v[176:179], v[226:229], v[64:67], v[160:163]
    v_cvt_pk_bf16_f32 v54, v188, v189
    v_cvt_pk_bf16_f32 v55, v190, v191
    v_mfma_f32_16x16x32_bf16 v[180:183], v[224:227], v[64:67], v[160:163]
    v_cvt_pk_bf16_f32 v56, v192, v193
    v_cvt_pk_bf16_f32 v57, v194, v195
    v_mfma_f32_16x16x32_bf16 v[184:187], v[226:229], v[68:71], v[164:167]
    v_cndmask_b32 v208, v208, v209, s[74:75]
    v_cvt_pk_bf16_f32 v58, v196, v197
    v_cvt_pk_bf16_f32 v59, v198, v199
    v_mfma_f32_16x16x32_bf16 v[188:191], v[224:227], v[68:71], v[164:167]
    v_cndmask_b32 v210, v210, v211, s[74:75]
    v_cvt_pk_bf16_f32 v60, v200, v201
    v_cvt_pk_bf16_f32 v61, v202, v203
    v_mfma_f32_16x16x32_bf16 v[192:195], v[226:229], v[72:75], v[160:163]
    v_cndmask_b32 v212, v212, v213, s[74:75]
    v_cvt_pk_bf16_f32 v62, v204, v205
    v_cvt_pk_bf16_f32 v63, v206, v207
    v_mfma_f32_16x16x32_bf16 v[196:199], v[224:227], v[72:75], v[160:163]
    v_cndmask_b32 v214, v214, v215, s[74:75]
    v_cvt_pk_bf16_f32 v64, v176, v177
    v_cvt_pk_bf16_f32 v65, v178, v179
    v_mfma_f32_16x16x32_bf16 v[200:203], v[226:229], v[76:79], v[164:167]
    v_cndmask_b32 v208, v208, v210, s[72:73]
    v_cvt_pk_bf16_f32 v66, v180, v181
    v_cvt_pk_bf16_f32 v67, v182, v183
    v_mfma_f32_16x16x32_bf16 v[204:207], v[224:227], v[76:79], v[164:167]
    v_cndmask_b32 v212, v212, v214, s[72:73]
    v_cvt_pk_bf16_f32 v68, v184, v185
    v_cvt_pk_bf16_f32 v69, v186, v187
    v_mfma_f32_16x16x32_bf16 v[176:179], v[226:229], v[80:83], v[160:163]
    v_cndmask_b32 v208, 0, v208, s[76:77]
    v_cvt_pk_bf16_f32 v70, v188, v189
    v_cvt_pk_bf16_f32 v71, v190, v191
    v_mfma_f32_16x16x32_bf16 v[180:183], v[224:227], v[80:83], v[160:163]
    v_cndmask_b32 v212, 0, v212, s[76:77]
    v_cvt_pk_bf16_f32 v72, v192, v193
    v_cvt_pk_bf16_f32 v73, v194, v195
    v_mfma_f32_16x16x32_bf16 v[184:187], v[226:229], v[84:87], v[164:167]
    v_mov_b32 v209, v208
    v_cvt_pk_bf16_f32 v74, v196, v197
    v_cvt_pk_bf16_f32 v75, v198, v199
    v_mfma_f32_16x16x32_bf16 v[188:191], v[224:227], v[84:87], v[164:167]
    v_mov_b32 v213, v212
    v_cvt_pk_bf16_f32 v76, v200, v201
    v_cvt_pk_bf16_f32 v77, v202, v203
    v_mfma_f32_16x16x32_bf16 v[192:195], v[226:229], v[88:91], v[160:163]
    v_permlane16_swap_b32 v208, v209
    v_cvt_pk_bf16_f32 v78, v204, v205
    v_cvt_pk_bf16_f32 v79, v206, v207
    v_mfma_f32_16x16x32_bf16 v[196:199], v[224:227], v[88:91], v[160:163]
    v_permlane16_swap_b32 v212, v213
    v_cvt_pk_bf16_f32 v80, v176, v177
    v_cvt_pk_bf16_f32 v81, v178, v179
    v_mfma_f32_16x16x32_bf16 v[200:203], v[226:229], v[92:95], v[164:167]
    v_add_f32 v208, v208, v209
    v_cvt_pk_bf16_f32 v82, v180, v181
    v_cvt_pk_bf16_f32 v83, v182, v183
    v_mfma_f32_16x16x32_bf16 v[204:207], v[224:227], v[92:95], v[164:167]
    v_add_f32 v212, v212, v213
    v_cvt_pk_bf16_f32 v84, v184, v185
    v_cvt_pk_bf16_f32 v85, v186, v187
    v_mfma_f32_16x16x32_bf16 v[176:179], v[226:229], v[96:99], v[160:163]
    v_mov_b32 v209, v208
    v_cvt_pk_bf16_f32 v86, v188, v189
    v_cvt_pk_bf16_f32 v87, v190, v191
    v_mfma_f32_16x16x32_bf16 v[180:183], v[224:227], v[96:99], v[160:163]
    v_mov_b32 v213, v212
    v_cvt_pk_bf16_f32 v88, v192, v193
    v_cvt_pk_bf16_f32 v89, v194, v195
    v_mfma_f32_16x16x32_bf16 v[184:187], v[226:229], v[100:103], v[164:167]
    v_permlane32_swap_b32 v208, v209
    v_cvt_pk_bf16_f32 v90, v196, v197
    v_cvt_pk_bf16_f32 v91, v198, v199
    v_mfma_f32_16x16x32_bf16 v[188:191], v[224:227], v[100:103], v[164:167]
    v_permlane32_swap_b32 v212, v213
    v_cvt_pk_bf16_f32 v92, v200, v201
    v_cvt_pk_bf16_f32 v93, v202, v203
    v_mfma_f32_16x16x32_bf16 v[192:195], v[226:229], v[104:107], v[160:163]
    v_add_f32 v208, v208, v209
    v_cvt_pk_bf16_f32 v94, v204, v205
    v_cvt_pk_bf16_f32 v95, v206, v207
    v_mfma_f32_16x16x32_bf16 v[196:199], v[224:227], v[104:107], v[160:163]
    v_add_f32 v212, v212, v213
    v_cvt_pk_bf16_f32 v96, v176, v177
    v_cvt_pk_bf16_f32 v97, v178, v179
    v_mfma_f32_16x16x32_bf16 v[200:203], v[226:229], v[108:111], v[164:167]
    v_mul_f32 v208, 0x3ae38e39, v208
    v_cvt_pk_bf16_f32 v98, v180, v181
    v_cvt_pk_bf16_f32 v99, v182, v183
    v_mfma_f32_16x16x32_bf16 v[204:207], v[224:227], v[108:111], v[164:167]
    v_mul_f32 v212, 0x3ae38e39, v212
    v_cvt_pk_bf16_f32 v100, v184, v185
    v_cvt_pk_bf16_f32 v101, v186, v187
    v_mfma_f32_16x16x32_bf16 v[176:179], v[226:229], v[112:115], v[160:163]
    v_fma_f32 v208, -v168, v168, v208
    v_cvt_pk_bf16_f32 v102, v188, v189
    v_cvt_pk_bf16_f32 v103, v190, v191
    v_mfma_f32_16x16x32_bf16 v[180:183], v[224:227], v[112:115], v[160:163]
    v_fma_f32 v212, -v169, v169, v212
    v_cvt_pk_bf16_f32 v104, v192, v193
    v_cvt_pk_bf16_f32 v105, v194, v195
    v_mfma_f32_16x16x32_bf16 v[184:187], v[226:229], v[116:119], v[164:167]
    v_max_f32 v208, 0, v208
    v_cvt_pk_bf16_f32 v106, v196, v197
    v_cvt_pk_bf16_f32 v107, v198, v199
    v_mfma_f32_16x16x32_bf16 v[188:191], v[224:227], v[116:119], v[164:167]
    v_max_f32 v212, 0, v212
    v_cvt_pk_bf16_f32 v108, v200, v201
    v_cvt_pk_bf16_f32 v109, v202, v203
    v_mfma_f32_16x16x32_bf16 v[192:195], v[226:229], v[120:123], v[160:163]
    v_cvt_pk_bf16_f32 v208, v208, v208
    v_cvt_pk_bf16_f32 v110, v204, v205
    v_cvt_pk_bf16_f32 v111, v206, v207
    v_mfma_f32_16x16x32_bf16 v[196:199], v[224:227], v[120:123], v[160:163]
    v_cvt_pk_bf16_f32 v212, v212, v212
    v_cvt_pk_bf16_f32 v112, v176, v177
    v_cvt_pk_bf16_f32 v113, v178, v179
    v_mfma_f32_16x16x32_bf16 v[200:203], v[226:229], v[124:127], v[164:167]
    v_and_b32 v208, 0xffff0000, v208
    v_cvt_pk_bf16_f32 v114, v180, v181
    v_cvt_pk_bf16_f32 v115, v182, v183
    v_mfma_f32_16x16x32_bf16 v[204:207], v[224:227], v[124:127], v[164:167]
    v_and_b32 v212, 0xffff0000, v212
    v_cvt_pk_bf16_f32 v116, v184, v185
    v_cvt_pk_bf16_f32 v117, v186, v187
    v_mfma_f32_16x16x32_bf16 v[176:179], v[226:229], v[128:131], v[160:163]
    v_add_f32 v208, 0x3727c5ac, v208
    v_cvt_pk_bf16_f32 v118, v188, v189
    v_cvt_pk_bf16_f32 v119, v190, v191
    v_mfma_f32_16x16x32_bf16 v[180:183], v[224:227], v[128:131], v[160:163]
    v_add_f32 v212, 0x3727c5ac, v212
    v_cvt_pk_bf16_f32 v120, v192, v193
    v_cvt_pk_bf16_f32 v121, v194, v195
    v_mfma_f32_16x16x32_bf16 v[184:187], v[226:229], v[132:135], v[164:167]
    v_cvt_pk_bf16_f32 v208, v208, v208
    v_cvt_pk_bf16_f32 v122, v196, v197
    v_cvt_pk_bf16_f32 v123, v198, v199
    v_mfma_f32_16x16x32_bf16 v[188:191], v[224:227], v[132:135], v[164:167]
    v_cvt_pk_bf16_f32 v212, v212, v212
    v_cvt_pk_bf16_f32 v124, v200, v201
    v_cvt_pk_bf16_f32 v125, v202, v203
    v_mfma_f32_16x16x32_bf16 v[192:195], v[226:229], v[136:139], v[160:163]
    v_and_b32 v208, 0xffff0000, v208
    v_cvt_pk_bf16_f32 v126, v204, v205
    v_cvt_pk_bf16_f32 v127, v206, v207
    v_mfma_f32_16x16x32_bf16 v[196:199], v[224:227], v[136:139], v[160:163]
    v_and_b32 v212, 0xffff0000, v212
    v_cvt_pk_bf16_f32 v128, v176, v177
    v_cvt_pk_bf16_f32 v129, v178, v179
    v_mfma_f32_16x16x32_bf16 v[200:203], v[226:229], v[140:143], v[164:167]
    v_sqrt_f32 v208, v208
    v_cvt_pk_bf16_f32 v130, v180, v181
    v_cvt_pk_bf16_f32 v131, v182, v183
    v_mfma_f32_16x16x32_bf16 v[204:207], v[224:227], v[140:143], v[164:167]
    v_sqrt_f32 v212, v212
    v_cvt_pk_bf16_f32 v132, v184, v185
    v_cvt_pk_bf16_f32 v133, v186, v187
    v_mfma_f32_16x16x32_bf16 v[176:179], v[226:229], v[144:147], v[160:163]
    v_cvt_pk_bf16_f32 v208, v208, v208
    v_cvt_pk_bf16_f32 v134, v188, v189
    v_cvt_pk_bf16_f32 v135, v190, v191
    v_mfma_f32_16x16x32_bf16 v[180:183], v[224:227], v[144:147], v[160:163]
    v_cvt_pk_bf16_f32 v212, v212, v212
    v_cvt_pk_bf16_f32 v136, v192, v193
    v_cvt_pk_bf16_f32 v137, v194, v195
    v_mfma_f32_16x16x32_bf16 v[184:187], v[226:229], v[148:151], v[164:167]
    v_and_b32 v208, 0xffff0000, v208
    v_cvt_pk_bf16_f32 v138, v196, v197
    v_cvt_pk_bf16_f32 v139, v198, v199
    v_mfma_f32_16x16x32_bf16 v[188:191], v[224:227], v[148:151], v[164:167]
    v_and_b32 v212, 0xffff0000, v212
    v_cvt_pk_bf16_f32 v140, v200, v201
    v_cvt_pk_bf16_f32 v141, v202, v203
    v_mfma_f32_16x16x32_bf16 v[192:195], v[226:229], v[152:155], v[160:163]
    v_rcp_f32 v7, v208
    v_cvt_pk_bf16_f32 v142, v204, v205
    v_cvt_pk_bf16_f32 v143, v206, v207
    v_mfma_f32_16x16x32_bf16 v[196:199], v[224:227], v[152:155], v[160:163]
    v_rcp_f32 v8, v212
    v_cvt_pk_bf16_f32 v144, v176, v177
    v_cvt_pk_bf16_f32 v145, v178, v179
    v_mfma_f32_16x16x32_bf16 v[200:203], v[226:229], v[156:159], v[164:167]
    v_mul_f32 v9, v7, v7
    v_cvt_pk_bf16_f32 v146, v180, v181
    v_cvt_pk_bf16_f32 v147, v182, v183
    v_mfma_f32_16x16x32_bf16 v[204:207], v[224:227], v[156:159], v[164:167]
    v_mul_f32 v10, v8, v8
    v_cvt_pk_bf16_f32 v148, v184, v185
    v_cvt_pk_bf16_f32 v149, v186, v187
    v_cvt_pk_bf16_f32 v150, v188, v189
    v_cvt_pk_bf16_f32 v151, v190, v191
    v_cvt_pk_bf16_f32 v152, v192, v193
    v_cvt_pk_bf16_f32 v153, v194, v195
    v_cvt_pk_bf16_f32 v154, v196, v197
    v_cvt_pk_bf16_f32 v155, v198, v199
    v_cvt_pk_bf16_f32 v156, v200, v201
    v_cvt_pk_bf16_f32 v157, v202, v203
    v_cvt_pk_bf16_f32 v158, v204, v205
    v_cvt_pk_bf16_f32 v159, v206, v207
    s_barrier
    ds_read_b64_tr_b16 v[224:225], v2 offset:0
    ds_read_b64_tr_b16 v[226:227], v2 offset:256
    ds_read_b64_tr_b16 v[228:229], v3 offset:0
    ds_read_b64_tr_b16 v[230:231], v3 offset:256
    ds_read_b64_tr_b16 v[232:233], v2 offset:512
    ds_read_b64_tr_b16 v[234:235], v2 offset:768
    ds_read_b64_tr_b16 v[236:237], v3 offset:512
    ds_read_b64_tr_b16 v[238:239], v3 offset:768
    ds_read_b64_tr_b16 v[240:241], v2 offset:1024
    ds_read_b64_tr_b16 v[242:243], v2 offset:1280
    ds_read_b64_tr_b16 v[244:245], v3 offset:1024
    ds_read_b64_tr_b16 v[246:247], v3 offset:1280
    ds_read_b64_tr_b16 v[248:249], v2 offset:1536
    ds_read_b64_tr_b16 v[250:251], v2 offset:1792
    s_mov_b32 s59, 0
    s_mov_b32 m0, 0
    s_sub_u32 s70, s60, 1
L_b0n:
    s_waitcnt lgkmcnt(10)
    v_mfma_f32_16x16x32_bf16 v[160:163], v[224:227], v[16:19], 0
    ds_read_b64_tr_b16 v[252:253], v3 offset:1536
    v_mfma_f32_16x16x32_bf16 v[176:179], v[224:227], v[20:23], 0
    ds_read_b64_tr_b16 v[254:255], v3 offset:1792
    v_mfma_f32_16x16x32_bf16 v[164:167], v[228:231], v[16:19], 0
    ds_read_b64_tr_b16 v[224:225], v2 offset:2048
    v_mfma_f32_16x16x32_bf16 v[180:183], v[228:231], v[20:23], 0
    ds_read_b64_tr_b16 v[226:227], v2 offset:2304
    s_waitcnt lgkmcnt(10)
    v_mfma_f32_16x16x32_bf16 v[168:171], v[232:235], v[16:19], 0
    ds_read_b64_tr_b16 v[228:229], v3 offset:2048
    v_mfma_f32_16x16x32_bf16 v[184:187], v[232:235], v[20:23], 0
    ds_read_b64_tr_b16 v[230:231], v3 offset:2304
    v_mfma_f32_16x16x32_bf16 v[172:175], v[236:239], v[16:19], 0
    ds_read_b64_tr_b16 v[232:233], v2 offset:2560
    v_mfma_f32_16x16x32_bf16 v[188:191], v[236:239], v[20:23], 0
    ds_read_b64_tr_b16 v[234:235], v2 offset:2816
    s_waitcnt lgkmcnt(10)
    v_mfma_f32_16x16x32_bf16 v[160:163], v[240:243], v[24:27], v[160:163]
    ds_read_b64_tr_b16 v[236:237], v3 offset:2560
    v_mfma_f32_16x16x32_bf16 v[176:179], v[240:243], v[28:31], v[176:179]
    ds_read_b64_tr_b16 v[238:239], v3 offset:2816
    v_mfma_f32_16x16x32_bf16 v[164:167], v[244:247], v[24:27], v[164:167]
    ds_read_b64_tr_b16 v[240:241], v2 offset:3072
    v_mfma_f32_16x16x32_bf16 v[180:183], v[244:247], v[28:31], v[180:183]
    ds_read_b64_tr_b16 v[242:243], v2 offset:3328
    s_waitcnt lgkmcnt(10)
    v_mfma_f32_16x16x32_bf16 v[168:171], v[248:251], v[24:27], v[168:171]
    ds_read_b64_tr_b16 v[244:245], v3 offset:3072
    s_mov_b32 s41, s78
    v_mfma_f32_16x16x32_bf16 v[184:187], v[248:251], v[28:31], v[184:187]
    ds_read_b64_tr_b16 v[246:247], v3 offset:3328
    s_sub_u32 s42, s41, s94
    v_mfma_f32_16x16x32_bf16 v[172:175], v[252:255], v[24:27], v[172:175]
    ds_read_b64_tr_b16 v[248:249], v2 offset:3584
    s_lshl_b32 s43, s53, 1
    v_mfma_f32_16x16x32_bf16 v[188:191], v[252:255], v[28:31], v[188:191]
    ds_read_b64_tr_b16 v[250:251], v2 offset:3840
    s_waitcnt lgkmcnt(10)
    v_mfma_f32_16x16x32_bf16 v[160:163], v[224:227], v[32:35], v[160:163]
    ds_read_b64_tr_b16 v[252:253], v3 offset:3584
    s_add_u32 s43, s43, s42
    v_mfma_f32_16x16x32_bf16 v[176:179], v[224:227], v[36:39], v[176:179]
    ds_read_b64_tr_b16 v[254:255], v3 offset:3840
    s_add_u32 s43, s43, 39
    v_mfma_f32_16x16x32_bf16 v[164:167], v[228:231], v[32:35], v[164:167]
    ds_read_b64_tr_b16 v[224:225], v2 offset:4096
    s_add_u32 s42, s53, 24
    v_mfma_f32_16x16x32_bf16 v[180:183], v[228:231], v[36:39], v[180:183]
    ds_read_b64_tr_b16 v[226:227], v2 offset:4352
    s_waitcnt lgkmcnt(10)
    v_mfma_f32_16x16x32_bf16 v[168:171], v[232:235], v[32:35], v[168:171]
    ds_read_b64_tr_b16 v[228:229], v3 offset:4096
    s_cmp_eq_u32 s41, s94
    v_mfma_f32_16x16x32_bf16 v[184:187], v[232:235], v[36:39], v[184:187]
    ds_read_b64_tr_b16 v[230:231], v3 offset:4352
    s_cselect_b32 s43, s42, s43
    v_mfma_f32_16x16x32_bf16 v[172:175], v[236:239], v[32:35], v[172:175]
    ds_read_b64_tr_b16 v[232:233], v2 offset:4608
    s_add_u32 s42, s41, s58
    v_mfma_f32_16x16x32_bf16 v[188:191], v[236:239], v[36:39], v[188:191]
    ds_read_b64_tr_b16 v[234:235], v2 offset:4864
    s_waitcnt lgkmcnt(10)
    v_mfma_f32_16x16x32_bf16 v[160:163], v[240:243], v[40:43], v[160:163]
    ds_read_b64_tr_b16 v[236:237], v3 offset:4608
    s_cmp_lt_u32 s41, s94
    v_mfma_f32_16x16x32_bf16 v[176:179], v[240:243], v[44:47], v[176:179]
    ds_read_b64_tr_b16 v[238:239], v3 offset:4864
    s_cselect_b32 s41, s42, s43
    v_mfma_f32_16x16x32_bf16 v[164:167], v[244:247], v[40:43], v[164:167]
    ds_read_b64_tr_b16 v[240:241], v2 offset:5120
    s_mul_i32 s41, s41, 10240
    v_mfma_f32_16x16x32_bf16 v[180:183], v[244:247], v[44:47], v[180:183]
    ds_read_b64_tr_b16 v[242:243], v2 offset:5376
    s_waitcnt lgkmcnt(10)
    v_mfma_f32_16x16x32_bf16 v[168:171], v[248:251], v[40:43], v[168:171]
    ds_read_b64_tr_b16 v[244:245], v3 offset:5120
    s_add_u32 s61, s63, s41
    v_mfma_f32_16x16x32_bf16 v[184:187], v[248:251], v[44:47], v[184:187]
    ds_read_b64_tr_b16 v[246:247], v3 offset:5376
    s_add_u32 s62, s64, s41
    v_mfma_f32_16x16x32_bf16 v[172:175], v[252:255], v[40:43], v[172:175]
    ds_read_b64_tr_b16 v[248:249], v2 offset:5632
    v_mul_f32 v192, v9, v192
    v_mfma_f32_16x16x32_bf16 v[188:191], v[252:255], v[44:47], v[188:191]
    ds_read_b64_tr_b16 v[250:251], v2 offset:5888
    s_waitcnt lgkmcnt(10)
    v_mfma_f32_16x16x32_bf16 v[160:163], v[224:227], v[48:51], v[160:163]
    ds_read_b64_tr_b16 v[252:253], v3 offset:5632
    v_mul_f32 v193, v9, v193
    v_mfma_f32_16x16x32_bf16 v[176:179], v[224:227], v[52:55], v[176:179]
    ds_read_b64_tr_b16 v[254:255], v3 offset:5888
    v_mul_f32 v194, v9, v194
    s_barrier
    v_mfma_f32_16x16x32_bf16 v[164:167], v[228:231], v[48:51], v[164:167]
    ds_read_b64_tr_b16 v[224:225], v2 offset:6144
    v_mul_f32 v195, v9, v195
    v_mfma_f32_16x16x32_bf16 v[180:183], v[228:231], v[52:55], v[180:183]
    ds_read_b64_tr_b16 v[226:227], v2 offset:6400
    s_waitcnt lgkmcnt(10)
    v_mfma_f32_16x16x32_bf16 v[168:171], v[232:235], v[48:51], v[168:171]
    ds_read_b64_tr_b16 v[228:229], v3 offset:6144
    v_mul_f32 v196, v9, v196
    v_mfma_f32_16x16x32_bf16 v[184:187], v[232:235], v[52:55], v[184:187]
    ds_read_b64_tr_b16 v[230:231], v3 offset:6400
    v_mul_f32 v197, v9, v197
    v_mfma_f32_16x16x32_bf16 v[172:175], v[236:239], v[48:51], v[172:175]
    ds_read_b64_tr_b16 v[232:233], v2 offset:6656
    v_mul_f32 v198, v9, v198
    v_mfma_f32_16x16x32_bf16 v[188:191], v[236:239], v[52:55], v[188:191]
    ds_read_b64_tr_b16 v[234:235], v2 offset:6912
    s_waitcnt lgkmcnt(10)
    v_mfma_f32_16x16x32_bf16 v[160:163], v[240:243], v[56:59], v[160:163]
    ds_read_b64_tr_b16 v[236:237], v3 offset:6656
    v_mul_f32 v199, v9, v199
    v_mfma_f32_16x16x32_bf16 v[176:179], v[240:243], v[60:63], v[176:179]
    ds_read_b64_tr_b16 v[238:239], v3 offset:6912
    v_mul_f32 v200, v9, v200
    v_mfma_f32_16x16x32_bf16 v[164:167], v[244:247], v[56:59], v[164:167]
    ds_read_b64_tr_b16 v[240:241], v2 offset:7168
    v_mul_f32 v201, v9, v201
    v_mfma_f32_16x16x32_bf16 v[180:183], v[244:247], v[60:63], v[180:183]
    ds_read_b64_tr_b16 v[242:243], v2 offset:7424
    s_waitcnt lgkmcnt(10)
    v_mfma_f32_16x16x32_bf16 v[168:171], v[248:251], v[56:59], v[168:171]
    ds_read_b64_tr_b16 v[244:245], v3 offset:7168
    v_mul_f32 v202, v9, v202
    v_mfma_f32_16x16x32_bf16 v[184:187], v[248:251], v[60:63], v[184:187]
    ds_read_b64_tr_b16 v[246:247], v3 offset:7424
    v_mul_f32 v203, v9, v203
    v_mfma_f32_16x16x32_bf16 v[172:175], v[252:255], v[56:59], v[172:175]
    ds_read_b64_tr_b16 v[248:249], v2 offset:7680
    v_mul_f32 v204, v9, v204
    v_mfma_f32_16x16x32_bf16 v[188:191], v[252:255], v[60:63], v[188:191]
    ds_read_b64_tr_b16 v[250:251], v2 offset:7936
    s_waitcnt lgkmcnt(10)
    v_mfma_f32_16x16x32_bf16 v[160:163], v[224:227], v[64:67], v[160:163]
    ds_read_b64_tr_b16 v[252:253], v3 offset:7680
    v_mul_f32 v205, v9, v205
    v_mfma_f32_16x16x32_bf16 v[176:179], v[224:227], v[68:71], v[176:179]
    ds_read_b64_tr_b16 v[254:255], v3 offset:7936
    v_mul_f32 v206, v9, v206
    v_mfma_f32_16x16x32_bf16 v[164:167], v[228:231], v[64:67], v[164:167]
    ds_read_b64_tr_b16 v[224:225], v2 offset:8192
    v_mul_f32 v207, v9, v207
    v_mfma_f32_16x16x32_bf16 v[180:183], v[228:231], v[68:71], v[180:183]
    ds_read_b64_tr_b16 v[226:227], v2 offset:8448
    s_waitcnt lgkmcnt(10)
    v_mfma_f32_16x16x32_bf16 v[168:171], v[232:235], v[64:67], v[168:171]
    ds_read_b64_tr_b16 v[228:229], v3 offset:8192
    v_mul_f32 v208, v10, v208
    v_mfma_f32_16x16x32_bf16 v[184:187], v[232:235], v[68:71], v[184:187]
    ds_read_b64_tr_b16 v[230:231], v3 offset:8448
    v_mul_f32 v209, v10, v209
    v_mfma_f32_16x16x32_bf16 v[172:175], v[236:239], v[64:67], v[172:175]
    ds_read_b64_tr_b16 v[232:233], v2 offset:8704
    v_mul_f32 v210, v10, v210
    v_mfma_f32_16x16x32_bf16 v[188:191], v[236:239], v[68:71], v[188:191]
    ds_read_b64_tr_b16 v[234:235], v2 offset:8960
    s_waitcnt lgkmcnt(10)
    v_mfma_f32_16x16x32_bf16 v[160:163], v[240:243], v[72:75], v[160:163]
    ds_read_b64_tr_b16 v[236:237], v3 offset:8704
    v_mul_f32 v211, v10, v211
    v_mfma_f32_16x16x32_bf16 v[176:179], v[240:243], v[76:79], v[176:179]
    ds_read_b64_tr_b16 v[238:239], v3 offset:8960
    v_mul_f32 v212, v10, v212
    v_mfma_f32_16x16x32_bf16 v[164:167], v[244:247], v[72:75], v[164:167]
    ds_read_b64_tr_b16 v[240:241], v2 offset:9216
    v_mul_f32 v213, v10, v213
    v_mfma_f32_16x16x32_bf16 v[180:183], v[244:247], v[76:79], v[180:183]
    ds_read_b64_tr_b16 v[242:243], v2 offset:9472
    s_waitcnt lgkmcnt(10)
    v_mfma_f32_16x16x32_bf16 v[168:171], v[248:251], v[72:75], v[168:171]
    ds_read_b64_tr_b16 v[244:245], v3 offset:9216
    v_mul_f32 v214, v10, v214
    v_mfma_f32_16x16x32_bf16 v[184:187], v[248:251], v[76:79], v[184:187]
    ds_read_b64_tr_b16 v[246:247], v3 offset:9472
    v_mul_f32 v215, v10, v215
    v_mfma_f32_16x16x32_bf16 v[172:175], v[252:255], v[72:75], v[172:175]
    ds_read_b64_tr_b16 v[248:249], v2 offset:9728
    v_mul_f32 v216, v10, v216
    v_mfma_f32_16x16x32_bf16 v[188:191], v[252:255], v[76:79], v[188:191]
    ds_read_b64_tr_b16 v[250:251], v2 offset:9984
    s_waitcnt lgkmcnt(10)
    v_mfma_f32_16x16x32_bf16 v[160:163], v[224:227], v[80:83], v[160:163]
    ds_read_b64_tr_b16 v[252:253], v3 offset:9728
    v_mul_f32 v217, v10, v217
    v_mfma_f32_16x16x32_bf16 v[176:179], v[224:227], v[84:87], v[176:179]
    ds_read_b64_tr_b16 v[254:255], v3 offset:9984
    v_mul_f32 v218, v10, v218
    v_mfma_f32_16x16x32_bf16 v[164:167], v[228:231], v[80:83], v[164:167]
    ds_read_b64_tr_b16 v[224:225], v2 offset:10240
    v_mul_f32 v219, v10, v219
    v_mfma_f32_16x16x32_bf16 v[180:183], v[228:231], v[84:87], v[180:183]
    ds_read_b64_tr_b16 v[226:227], v2 offset:10496
    s_waitcnt lgkmcnt(10)
    v_mfma_f32_16x16x32_bf16 v[168:171], v[232:235], v[80:83], v[168:171]
    ds_read_b64_tr_b16 v[228:229], v3 offset:10240
    v_mul_f32 v220, v10, v220
    v_mfma_f32_16x16x32_bf16 v[184:187], v[232:235], v[84:87], v[184:187]
    ds_read_b64_tr_b16 v[230:231], v3 offset:10496
    v_mul_f32 v221, v10, v221
    v_mfma_f32_16x16x32_bf16 v[172:175], v[236:239], v[80:83], v[172:175]
    ds_read_b64_tr_b16 v[232:233], v2 offset:10752
    v_mul_f32 v222, v10, v222
    v_mfma_f32_16x16x32_bf16 v[188:191], v[236:239], v[84:87], v[188:191]
    ds_read_b64_tr_b16 v[234:235], v2 offset:11008
    s_waitcnt lgkmcnt(10)
    v_mfma_f32_16x16x32_bf16 v[160:163], v[240:243], v[88:91], v[160:163]
    ds_read_b64_tr_b16 v[236:237], v3 offset:10752
    v_mul_f32 v223, v10, v223
    v_mfma_f32_16x16x32_bf16 v[176:179], v[240:243], v[92:95], v[176:179]
    ds_read_b64_tr_b16 v[238:239], v3 offset:11008
    v_mfma_f32_16x16x32_bf16 v[164:167], v[244:247], v[88:91], v[164:167]
    ds_read_b64_tr_b16 v[240:241], v2 offset:11264
    v_mfma_f32_16x16x32_bf16 v[180:183], v[244:247], v[92:95], v[180:183]
    ds_read_b64_tr_b16 v[242:243], v2 offset:11520
    s_waitcnt lgkmcnt(10)
    v_mfma_f32_16x16x32_bf16 v[168:171], v[248:251], v[88:91], v[168:171]
    ds_read_b64_tr_b16 v[244:245], v3 offset:11264
    v_mfma_f32_16x16x32_bf16 v[184:187], v[248:251], v[92:95], v[184:187]
    ds_read_b64_tr_b16 v[246:247], v3 offset:11520
    v_mfma_f32_16x16x32_bf16 v[172:175], v[252:255], v[88:91], v[172:175]
    ds_read_b64_tr_b16 v[248:249], v2 offset:11776
    v_mfma_f32_16x16x32_bf16 v[188:191], v[252:255], v[92:95], v[188:191]
    ds_read_b64_tr_b16 v[250:251], v2 offset:12032
    s_waitcnt lgkmcnt(10)
    v_mfma_f32_16x16x32_bf16 v[160:163], v[224:227], v[96:99], v[160:163]
    ds_read_b64_tr_b16 v[252:253], v3 offset:11776
    v_mfma_f32_16x16x32_bf16 v[176:179], v[224:227], v[100:103], v[176:179]
    ds_read_b64_tr_b16 v[254:255], v3 offset:12032
    s_barrier
    v_mfma_f32_16x16x32_bf16 v[164:167], v[228:231], v[96:99], v[164:167]
    ds_read_b64_tr_b16 v[224:225], v2 offset:12288
    v_mfma_f32_16x16x32_bf16 v[180:183], v[228:231], v[100:103], v[180:183]
    ds_read_b64_tr_b16 v[226:227], v2 offset:12544
    s_waitcnt lgkmcnt(10)
    v_mfma_f32_16x16x32_bf16 v[168:171], v[232:235], v[96:99], v[168:171]
    ds_read_b64_tr_b16 v[228:229], v3 offset:12288
    v_mfma_f32_16x16x32_bf16 v[184:187], v[232:235], v[100:103], v[184:187]
    ds_read_b64_tr_b16 v[230:231], v3 offset:12544
    v_mfma_f32_16x16x32_bf16 v[172:175], v[236:239], v[96:99], v[172:175]
    ds_read_b64_tr_b16 v[232:233], v2 offset:12800
    v_mfma_f32_16x16x32_bf16 v[188:191], v[236:239], v[100:103], v[188:191]
    ds_read_b64_tr_b16 v[234:235], v2 offset:13056
    s_waitcnt lgkmcnt(10)
    v_mfma_f32_16x16x32_bf16 v[160:163], v[240:243], v[104:107], v[160:163]
    ds_read_b64_tr_b16 v[236:237], v3 offset:12800
    v_mfma_f32_16x16x32_bf16 v[176:179], v[240:243], v[108:111], v[176:179]
    ds_read_b64_tr_b16 v[238:239], v3 offset:13056
    v_mfma_f32_16x16x32_bf16 v[164:167], v[244:247], v[104:107], v[164:167]
    ds_read_b64_tr_b16 v[240:241], v2 offset:13312
    v_mfma_f32_16x16x32_bf16 v[180:183], v[244:247], v[108:111], v[180:183]
    ds_read_b64_tr_b16 v[242:243], v2 offset:13568
    s_waitcnt lgkmcnt(10)
    v_mfma_f32_16x16x32_bf16 v[168:171], v[248:251], v[104:107], v[168:171]
    ds_read_b64_tr_b16 v[244:245], v3 offset:13312
    v_mfma_f32_16x16x32_bf16 v[184:187], v[248:251], v[108:111], v[184:187]
    ds_read_b64_tr_b16 v[246:247], v3 offset:13568
    v_mfma_f32_16x16x32_bf16 v[172:175], v[252:255], v[104:107], v[172:175]
    ds_read_b64_tr_b16 v[248:249], v2 offset:13824
    v_mfma_f32_16x16x32_bf16 v[188:191], v[252:255], v[108:111], v[188:191]
    ds_read_b64_tr_b16 v[250:251], v2 offset:14080
    s_waitcnt lgkmcnt(10)
    v_mfma_f32_16x16x32_bf16 v[160:163], v[224:227], v[112:115], v[160:163]
    ds_read_b64_tr_b16 v[252:253], v3 offset:13824
    v_mfma_f32_16x16x32_bf16 v[176:179], v[224:227], v[116:119], v[176:179]
    ds_read_b64_tr_b16 v[254:255], v3 offset:14080
    v_mfma_f32_16x16x32_bf16 v[164:167], v[228:231], v[112:115], v[164:167]
    ds_read_b64_tr_b16 v[224:225], v2 offset:14336
    v_mfma_f32_16x16x32_bf16 v[180:183], v[228:231], v[116:119], v[180:183]
    ds_read_b64_tr_b16 v[226:227], v2 offset:14592
    s_waitcnt lgkmcnt(10)
    v_mfma_f32_16x16x32_bf16 v[168:171], v[232:235], v[112:115], v[168:171]
    ds_read_b64_tr_b16 v[228:229], v3 offset:14336
    v_mfma_f32_16x16x32_bf16 v[184:187], v[232:235], v[116:119], v[184:187]
    ds_read_b64_tr_b16 v[230:231], v3 offset:14592
    v_mfma_f32_16x16x32_bf16 v[172:175], v[236:239], v[112:115], v[172:175]
    ds_read_b64_tr_b16 v[232:233], v2 offset:14848
    v_mfma_f32_16x16x32_bf16 v[188:191], v[236:239], v[116:119], v[188:191]
    ds_read_b64_tr_b16 v[234:235], v2 offset:15104
    s_waitcnt lgkmcnt(10)
    v_mfma_f32_16x16x32_bf16 v[160:163], v[240:243], v[120:123], v[160:163]
    ds_read_b64_tr_b16 v[236:237], v3 offset:14848
    v_mfma_f32_16x16x32_bf16 v[176:179], v[240:243], v[124:127], v[176:179]
    ds_read_b64_tr_b16 v[238:239], v3 offset:15104
    v_mfma_f32_16x16x32_bf16 v[164:167], v[244:247], v[120:123], v[164:167]
    ds_read_b64_tr_b16 v[240:241], v2 offset:15360
    v_mfma_f32_16x16x32_bf16 v[180:183], v[244:247], v[124:127], v[180:183]
    ds_read_b64_tr_b16 v[242:243], v2 offset:15616
    s_waitcnt lgkmcnt(10)
    v_mfma_f32_16x16x32_bf16 v[168:171], v[248:251], v[120:123], v[168:171]
    ds_read_b64_tr_b16 v[244:245], v3 offset:15360
    v_mfma_f32_16x16x32_bf16 v[184:187], v[248:251], v[124:127], v[184:187]
    ds_read_b64_tr_b16 v[246:247], v3 offset:15616
    v_mfma_f32_16x16x32_bf16 v[172:175], v[252:255], v[120:123], v[172:175]
    ds_read_b64_tr_b16 v[248:249], v2 offset:15872
    v_mfma_f32_16x16x32_bf16 v[188:191], v[252:255], v[124:127], v[188:191]
    ds_read_b64_tr_b16 v[250:251], v2 offset:16128
    s_waitcnt lgkmcnt(10)
    v_mfma_f32_16x16x32_bf16 v[160:163], v[224:227], v[128:131], v[160:163]
    ds_read_b64_tr_b16 v[252:253], v3 offset:15872
    v_mfma_f32_16x16x32_bf16 v[176:179], v[224:227], v[132:135], v[176:179]
    ds_read_b64_tr_b16 v[254:255], v3 offset:16128
    v_mfma_f32_16x16x32_bf16 v[164:167], v[228:231], v[128:131], v[164:167]
    ds_read_b64_tr_b16 v[224:225], v2 offset:16384
    v_mfma_f32_16x16x32_bf16 v[180:183], v[228:231], v[132:135], v[180:183]
    ds_read_b64_tr_b16 v[226:227], v2 offset:16640
    s_waitcnt lgkmcnt(10)
    v_mfma_f32_16x16x32_bf16 v[168:171], v[232:235], v[128:131], v[168:171]
    ds_read_b64_tr_b16 v[228:229], v3 offset:16384
    v_mfma_f32_16x16x32_bf16 v[184:187], v[232:235], v[132:135], v[184:187]
    ds_read_b64_tr_b16 v[230:231], v3 offset:16640
    v_mfma_f32_16x16x32_bf16 v[172:175], v[236:239], v[128:131], v[172:175]
    ds_read_b64_tr_b16 v[232:233], v2 offset:16896
    v_mfma_f32_16x16x32_bf16 v[188:191], v[236:239], v[132:135], v[188:191]
    ds_read_b64_tr_b16 v[234:235], v2 offset:17152
    s_waitcnt lgkmcnt(10)
    v_mfma_f32_16x16x32_bf16 v[160:163], v[240:243], v[136:139], v[160:163]
    ds_read_b64_tr_b16 v[236:237], v3 offset:16896
    v_mfma_f32_16x16x32_bf16 v[176:179], v[240:243], v[140:143], v[176:179]
    ds_read_b64_tr_b16 v[238:239], v3 offset:17152
    v_mfma_f32_16x16x32_bf16 v[164:167], v[244:247], v[136:139], v[164:167]
    ds_read_b64_tr_b16 v[240:241], v2 offset:17408
    v_mfma_f32_16x16x32_bf16 v[180:183], v[244:247], v[140:143], v[180:183]
    ds_read_b64_tr_b16 v[242:243], v2 offset:17664
    s_waitcnt lgkmcnt(10)
    v_mfma_f32_16x16x32_bf16 v[168:171], v[248:251], v[136:139], v[168:171]
    ds_read_b64_tr_b16 v[244:245], v3 offset:17408
    v_mfma_f32_16x16x32_bf16 v[184:187], v[248:251], v[140:143], v[184:187]
    ds_read_b64_tr_b16 v[246:247], v3 offset:17664
    v_mfma_f32_16x16x32_bf16 v[172:175], v[252:255], v[136:139], v[172:175]
    ds_read_b64_tr_b16 v[248:249], v2 offset:17920
    v_mfma_f32_16x16x32_bf16 v[188:191], v[252:255], v[140:143], v[188:191]
    ds_read_b64_tr_b16 v[250:251], v2 offset:18176
    s_waitcnt lgkmcnt(10)
    v_mfma_f32_16x16x32_bf16 v[160:163], v[224:227], v[144:147], v[160:163]
    ds_read_b64_tr_b16 v[252:253], v3 offset:17920
    v_mfma_f32_16x16x32_bf16 v[176:179], v[224:227], v[148:151], v[176:179]
    ds_read_b64_tr_b16 v[254:255], v3 offset:18176
    s_barrier
    v_mfma_f32_16x16x32_bf16 v[164:167], v[228:231], v[144:147], v[164:167]
    ds_read_b64_tr_b16 v[224:225], v4 offset:0
    v_mfma_f32_16x16x32_bf16 v[180:183], v[228:231], v[148:151], v[180:183]
    ds_read_b64_tr_b16 v[226:227], v4 offset:256
    s_waitcnt lgkmcnt(10)
    v_mfma_f32_16x16x32_bf16 v[168:171], v[232:235], v[144:147], v[168:171]
    ds_read_b64_tr_b16 v[228:229], v5 offset:0
    v_mfma_f32_16x16x32_bf16 v[184:187], v[232:235], v[148:151], v[184:187]
    ds_read_b64_tr_b16 v[230:231], v5 offset:256
    v_mfma_f32_16x16x32_bf16 v[172:175], v[236:239], v[144:147], v[172:175]
    ds_read_b64_tr_b16 v[232:233], v4 offset:512
    v_mfma_f32_16x16x32_bf16 v[188:191], v[236:239], v[148:151], v[188:191]
    ds_read_b64_tr_b16 v[234:235], v4 offset:768
    s_waitcnt lgkmcnt(10)
    v_mfma_f32_16x16x32_bf16 v[160:163], v[240:243], v[152:155], v[160:163]
    ds_read_b64_tr_b16 v[236:237], v5 offset:512
    v_mfma_f32_16x16x32_bf16 v[176:179], v[240:243], v[156:159], v[176:179]
    ds_read_b64_tr_b16 v[238:239], v5 offset:768
    v_mfma_f32_16x16x32_bf16 v[164:167], v[244:247], v[152:155], v[164:167]
    ds_read_b64_tr_b16 v[240:241], v4 offset:1024
    v_mfma_f32_16x16x32_bf16 v[180:183], v[244:247], v[156:159], v[180:183]
    ds_read_b64_tr_b16 v[242:243], v4 offset:1280
    s_waitcnt lgkmcnt(10)
    v_mfma_f32_16x16x32_bf16 v[168:171], v[248:251], v[152:155], v[168:171]
    ds_read_b64_tr_b16 v[244:245], v5 offset:1024
    v_mfma_f32_16x16x32_bf16 v[184:187], v[248:251], v[156:159], v[184:187]
    ds_read_b64_tr_b16 v[246:247], v5 offset:1280
    v_mfma_f32_16x16x32_bf16 v[172:175], v[252:255], v[152:155], v[172:175]
    ds_read_b64_tr_b16 v[248:249], v4 offset:1536
    v_mfma_f32_16x16x32_bf16 v[188:191], v[252:255], v[156:159], v[188:191]
    ds_read_b64_tr_b16 v[250:251], v4 offset:1792
    s_add_u32 s59, s59, 1
    s_cmp_le_u32 s59, s55
    s_cbranch_scc1 L_wasq0
    s_waitcnt vmcnt(0)
    s_add_u32 s78, s78, 1
L_b1u:
    s_waitcnt lgkmcnt(10)
    v_pk_mul_f32 v[160:161], v[192:193], v[160:161]
    v_pk_mul_f32 v[162:163], v[194:195], v[162:163]
    v_mfma_f32_16x16x32_bf16 v[192:195], v[224:227], v[16:19], 0
    ds_read_b64_tr_b16 v[252:253], v5 offset:1536
    v_pk_mul_f32 v[176:177], v[208:209], v[176:177]
    v_pk_mul_f32 v[178:179], v[210:211], v[178:179]
    v_mfma_f32_16x16x32_bf16 v[208:211], v[224:227], v[20:23], 0
    ds_read_b64_tr_b16 v[254:255], v5 offset:1792
    v_pk_mul_f32 v[164:165], v[196:197], v[164:165]
    v_pk_mul_f32 v[166:167], v[198:199], v[166:167]
    v_mfma_f32_16x16x32_bf16 v[196:199], v[228:231], v[16:19], 0
    ds_read_b64_tr_b16 v[224:225], v4 offset:2048
    v_pk_mul_f32 v[180:181], v[212:213], v[180:181]
    v_pk_mul_f32 v[182:183], v[214:215], v[182:183]
    v_mfma_f32_16x16x32_bf16 v[212:215], v[228:231], v[20:23], 0
    ds_read_b64_tr_b16 v[226:227], v4 offset:2304
    s_waitcnt lgkmcnt(10)
    v_pk_mul_f32 v[168:169], v[200:201], v[168:169]
    v_pk_mul_f32 v[170:171], v[202:203], v[170:171]
    v_mfma_f32_16x16x32_bf16 v[200:203], v[232:235], v[16:19], 0
    ds_read_b64_tr_b16 v[228:229], v5 offset:2048
    v_pk_mul_f32 v[184:185], v[216:217], v[184:185]
    v_pk_mul_f32 v[186:187], v[218:219], v[186:187]
    v_mfma_f32_16x16x32_bf16 v[216:219], v[232:235], v[20:23], 0
    ds_read_b64_tr_b16 v[230:231], v5 offset:2304
    v_pk_mul_f32 v[172:173], v[204:205], v[172:173]
    v_pk_mul_f32 v[174:175], v[206:207], v[174:175]
    v_mfma_f32_16x16x32_bf16 v[204:207], v[236:239], v[16:19], 0
    ds_read_b64_tr_b16 v[232:233], v4 offset:2560
    v_pk_mul_f32 v[188:189], v[220:221], v[188:189]
    v_pk_mul_f32 v[190:191], v[222:223], v[190:191]
    v_mfma_f32_16x16x32_bf16 v[220:223], v[236:239], v[20:23], 0
    ds_read_b64_tr_b16 v[234:235], v4 offset:2816
    s_waitcnt lgkmcnt(10)
    v_mfma_f32_16x16x32_bf16 v[192:195], v[240:243], v[24:27], v[192:195]
    ds_read_b64_tr_b16 v[236:237], v5 offset:2560
    v_mfma_f32_16x16x32_bf16 v[208:211], v[240:243], v[28:31], v[208:211]
    ds_read_b64_tr_b16 v[238:239], v5 offset:2816
    v_mfma_f32_16x16x32_bf16 v[196:199], v[244:247], v[24:27], v[196:199]
    ds_read_b64_tr_b16 v[240:241], v4 offset:3072
    v_mfma_f32_16x16x32_bf16 v[212:215], v[244:247], v[28:31], v[212:215]
    ds_read_b64_tr_b16 v[242:243], v4 offset:3328
    s_waitcnt lgkmcnt(10)
    v_mfma_f32_16x16x32_bf16 v[200:203], v[248:251], v[24:27], v[200:203]
    ds_read_b64_tr_b16 v[244:245], v5 offset:3072
    v_cvt_pk_bf16_f32 v160, v160, v161
    v_mfma_f32_16x16x32_bf16 v[216:219], v[248:251], v[28:31], v[216:219]
    ds_read_b64_tr_b16 v[246:247], v5 offset:3328
    v_cvt_pk_bf16_f32 v161, v162, v163
    v_mfma_f32_16x16x32_bf16 v[204:207], v[252:255], v[24:27], v[204:207]
    ds_read_b64_tr_b16 v[248:249], v4 offset:3584
    v_cvt_pk_bf16_f32 v162, v164, v165
    v_mfma_f32_16x16x32_bf16 v[220:223], v[252:255], v[28:31], v[220:223]
    ds_read_b64_tr_b16 v[250:251], v4 offset:3840
    s_waitcnt lgkmcnt(10)
    v_mfma_f32_16x16x32_bf16 v[192:195], v[224:227], v[32:35], v[192:195]
    ds_read_b64_tr_b16 v[252:253], v5 offset:3584
    v_cvt_pk_bf16_f32 v163, v166, v167
    v_mfma_f32_16x16x32_bf16 v[208:211], v[224:227], v[36:39], v[208:211]
    ds_read_b64_tr_b16 v[254:255], v5 offset:3840
    buffer_store_dwordx4 v[160:163], v6, s[32:35], s61 offen sc1
    v_mfma_f32_16x16x32_bf16 v[196:199], v[228:231], v[32:35], v[196:199]
    ds_read_b64_tr_b16 v[224:225], v4 offset:4096
    v_cvt_pk_bf16_f32 v168, v168, v169
    v_mfma_f32_16x16x32_bf16 v[212:215], v[228:231], v[36:39], v[212:215]
    ds_read_b64_tr_b16 v[226:227], v4 offset:4352
    s_waitcnt lgkmcnt(10)
    v_mfma_f32_16x16x32_bf16 v[200:203], v[232:235], v[32:35], v[200:203]
    ds_read_b64_tr_b16 v[228:229], v5 offset:4096
    v_cvt_pk_bf16_f32 v169, v170, v171
    v_mfma_f32_16x16x32_bf16 v[216:219], v[232:235], v[36:39], v[216:219]
    ds_read_b64_tr_b16 v[230:231], v5 offset:4352
    v_cvt_pk_bf16_f32 v170, v172, v173
    v_mfma_f32_16x16x32_bf16 v[204:207], v[236:239], v[32:35], v[204:207]
    ds_read_b64_tr_b16 v[232:233], v4 offset:4608
    v_cvt_pk_bf16_f32 v171, v174, v175
    v_mfma_f32_16x16x32_bf16 v[220:223], v[236:239], v[36:39], v[220:223]
    ds_read_b64_tr_b16 v[234:235], v4 offset:4864
    s_waitcnt lgkmcnt(10)
    v_mfma_f32_16x16x32_bf16 v[192:195], v[240:243], v[40:43], v[192:195]
    ds_read_b64_tr_b16 v[236:237], v5 offset:4608
    s_add_u32 s66, s61, 5120
    v_mfma_f32_16x16x32_bf16 v[208:211], v[240:243], v[44:47], v[208:211]
    ds_read_b64_tr_b16 v[238:239], v5 offset:4864
    buffer_store_dwordx4 v[168:171], v6, s[32:35], s66 offen sc1
    v_mfma_f32_16x16x32_bf16 v[196:199], v[244:247], v[40:43], v[196:199]
    ds_read_b64_tr_b16 v[240:241], v4 offset:5120
    v_cvt_pk_bf16_f32 v176, v176, v177
    v_mfma_f32_16x16x32_bf16 v[212:215], v[244:247], v[44:47], v[212:215]
    ds_read_b64_tr_b16 v[242:243], v4 offset:5376
    s_waitcnt lgkmcnt(10)
    v_mfma_f32_16x16x32_bf16 v[200:203], v[248:251], v[40:43], v[200:203]
    ds_read_b64_tr_b16 v[244:245], v5 offset:5120
    v_cvt_pk_bf16_f32 v177, v178, v179
    v_mfma_f32_16x16x32_bf16 v[216:219], v[248:251], v[44:47], v[216:219]
    ds_read_b64_tr_b16 v[246:247], v5 offset:5376
    v_cvt_pk_bf16_f32 v178, v180, v181
    v_mfma_f32_16x16x32_bf16 v[204:207], v[252:255], v[40:43], v[204:207]
    ds_read_b64_tr_b16 v[248:249], v4 offset:5632
    v_cvt_pk_bf16_f32 v179, v182, v183
    v_mfma_f32_16x16x32_bf16 v[220:223], v[252:255], v[44:47], v[220:223]
    ds_read_b64_tr_b16 v[250:251], v4 offset:5888
    s_waitcnt lgkmcnt(10)
    v_mfma_f32_16x16x32_bf16 v[192:195], v[224:227], v[48:51], v[192:195]
    ds_read_b64_tr_b16 v[252:253], v5 offset:5632
    buffer_store_dwordx4 v[176:179], v6, s[32:35], s62 offen sc1
    v_mfma_f32_16x16x32_bf16 v[208:211], v[224:227], v[52:55], v[208:211]
    ds_read_b64_tr_b16 v[254:255], v5 offset:5888
    v_cvt_pk_bf16_f32 v184, v184, v185
    s_barrier
    v_mfma_f32_16x16x32_bf16 v[196:199], v[228:231], v[48:51], v[196:199]
    ds_read_b64_tr_b16 v[224:225], v4 offset:6144
    v_cvt_pk_bf16_f32 v185, v186, v187
    v_mfma_f32_16x16x32_bf16 v[212:215], v[228:231], v[52:55], v[212:215]
    ds_read_b64_tr_b16 v[226:227], v4 offset:6400
    s_waitcnt lgkmcnt(10)
    v_mfma_f32_16x16x32_bf16 v[200:203], v[232:235], v[48:51], v[200:203]
    ds_read_b64_tr_b16 v[228:229], v5 offset:6144
    v_cvt_pk_bf16_f32 v186, v188, v189
    v_mfma_f32_16x16x32_bf16 v[216:219], v[232:235], v[52:55], v[216:219]
    ds_read_b64_tr_b16 v[230:231], v5 offset:6400
    v_cvt_pk_bf16_f32 v187, v190, v191
    v_mfma_f32_16x16x32_bf16 v[204:207], v[236:239], v[48:51], v[204:207]
    ds_read_b64_tr_b16 v[232:233], v4 offset:6656
    s_add_u32 s66, s62, 5120
    v_mfma_f32_16x16x32_bf16 v[220:223], v[236:239], v[52:55], v[220:223]
    ds_read_b64_tr_b16 v[234:235], v4 offset:6912
    s_waitcnt lgkmcnt(10)
    v_mfma_f32_16x16x32_bf16 v[192:195], v[240:243], v[56:59], v[192:195]
    ds_read_b64_tr_b16 v[236:237], v5 offset:6656
    buffer_store_dwordx4 v[184:187], v6, s[32:35], s66 offen sc1
    v_mfma_f32_16x16x32_bf16 v[208:211], v[240:243], v[60:63], v[208:211]
    ds_read_b64_tr_b16 v[238:239], v5 offset:6912
    v_mfma_f32_16x16x32_bf16 v[196:199], v[244:247], v[56:59], v[196:199]
    ds_read_b64_tr_b16 v[240:241], v4 offset:7168
    v_mfma_f32_16x16x32_bf16 v[212:215], v[244:247], v[60:63], v[212:215]
    ds_read_b64_tr_b16 v[242:243], v4 offset:7424
    s_waitcnt lgkmcnt(10)
    v_mfma_f32_16x16x32_bf16 v[200:203], v[248:251], v[56:59], v[200:203]
    ds_read_b64_tr_b16 v[244:245], v5 offset:7168
    v_mfma_f32_16x16x32_bf16 v[216:219], v[248:251], v[60:63], v[216:219]
    ds_read_b64_tr_b16 v[246:247], v5 offset:7424
    v_mfma_f32_16x16x32_bf16 v[204:207], v[252:255], v[56:59], v[204:207]
    ds_read_b64_tr_b16 v[248:249], v4 offset:7680
    v_mfma_f32_16x16x32_bf16 v[220:223], v[252:255], v[60:63], v[220:223]
    ds_read_b64_tr_b16 v[250:251], v4 offset:7936
    s_waitcnt lgkmcnt(10)
    v_mfma_f32_16x16x32_bf16 v[192:195], v[224:227], v[64:67], v[192:195]
    ds_read_b64_tr_b16 v[252:253], v5 offset:7680
    v_mfma_f32_16x16x32_bf16 v[208:211], v[224:227], v[68:71], v[208:211]
    ds_read_b64_tr_b16 v[254:255], v5 offset:7936
    v_mfma_f32_16x16x32_bf16 v[196:199], v[228:231], v[64:67], v[196:199]
    ds_read_b64_tr_b16 v[224:225], v4 offset:8192
    v_mfma_f32_16x16x32_bf16 v[212:215], v[228:231], v[68:71], v[212:215]
    ds_read_b64_tr_b16 v[226:227], v4 offset:8448
    s_waitcnt lgkmcnt(10)
    v_mfma_f32_16x16x32_bf16 v[200:203], v[232:235], v[64:67], v[200:203]
    ds_read_b64_tr_b16 v[228:229], v5 offset:8192
    v_mfma_f32_16x16x32_bf16 v[216:219], v[232:235], v[68:71], v[216:219]
    ds_read_b64_tr_b16 v[230:231], v5 offset:8448
    v_mfma_f32_16x16x32_bf16 v[204:207], v[236:239], v[64:67], v[204:207]
    ds_read_b64_tr_b16 v[232:233], v4 offset:8704
    v_mfma_f32_16x16x32_bf16 v[220:223], v[236:239], v[68:71], v[220:223]
    ds_read_b64_tr_b16 v[234:235], v4 offset:8960
    s_waitcnt lgkmcnt(10)
    v_mfma_f32_16x16x32_bf16 v[192:195], v[240:243], v[72:75], v[192:195]
    ds_read_b64_tr_b16 v[236:237], v5 offset:8704
    v_mfma_f32_16x16x32_bf16 v[208:211], v[240:243], v[76:79], v[208:211]
    ds_read_b64_tr_b16 v[238:239], v5 offset:8960
    v_mfma_f32_16x16x32_bf16 v[196:199], v[244:247], v[72:75], v[196:199]
    ds_read_b64_tr_b16 v[240:241], v4 offset:9216
    v_mfma_f32_16x16x32_bf16 v[212:215], v[244:247], v[76:79], v[212:215]
    ds_read_b64_tr_b16 v[242:243], v4 offset:9472
    s_waitcnt lgkmcnt(10)
    v_mfma_f32_16x16x32_bf16 v[200:203], v[248:251], v[72:75], v[200:203]
    ds_read_b64_tr_b16 v[244:245], v5 offset:9216
    v_mfma_f32_16x16x32_bf16 v[216:219], v[248:251], v[76:79], v[216:219]
    ds_read_b64_tr_b16 v[246:247], v5 offset:9472
    v_mfma_f32_16x16x32_bf16 v[204:207], v[252:255], v[72:75], v[204:207]
    ds_read_b64_tr_b16 v[248:249], v4 offset:9728
    v_mfma_f32_16x16x32_bf16 v[220:223], v[252:255], v[76:79], v[220:223]
    ds_read_b64_tr_b16 v[250:251], v4 offset:9984
    s_waitcnt lgkmcnt(10)
    v_mfma_f32_16x16x32_bf16 v[192:195], v[224:227], v[80:83], v[192:195]
    ds_read_b64_tr_b16 v[252:253], v5 offset:9728
    v_mfma_f32_16x16x32_bf16 v[208:211], v[224:227], v[84:87], v[208:211]
    ds_read_b64_tr_b16 v[254:255], v5 offset:9984
    v_mfma_f32_16x16x32_bf16 v[196:199], v[228:231], v[80:83], v[196:199]
    ds_read_b64_tr_b16 v[224:225], v4 offset:10240
    v_mfma_f32_16x16x32_bf16 v[212:215], v[228:231], v[84:87], v[212:215]
    ds_read_b64_tr_b16 v[226:227], v4 offset:10496
    s_waitcnt lgkmcnt(10)
    v_mfma_f32_16x16x32_bf16 v[200:203], v[232:235], v[80:83], v[200:203]
    ds_read_b64_tr_b16 v[228:229], v5 offset:10240
    v_mfma_f32_16x16x32_bf16 v[216:219], v[232:235], v[84:87], v[216:219]
    ds_read_b64_tr_b16 v[230:231], v5 offset:10496
    v_mfma_f32_16x16x32_bf16 v[204:207], v[236:239], v[80:83], v[204:207]
    ds_read_b64_tr_b16 v[232:233], v4 offset:10752
    v_mfma_f32_16x16x32_bf16 v[220:223], v[236:239], v[84:87], v[220:223]
    ds_read_b64_tr_b16 v[234:235], v4 offset:11008
    s_waitcnt lgkmcnt(10)
    v_mfma_f32_16x16x32_bf16 v[192:195], v[240:243], v[88:91], v[192:195]
    ds_read_b64_tr_b16 v[236:237], v5 offset:10752
    v_mfma_f32_16x16x32_bf16 v[208:211], v[240:243], v[92:95], v[208:211]
    ds_read_b64_tr_b16 v[238:239], v5 offset:11008
    v_mfma_f32_16x16x32_bf16 v[196:199], v[244:247], v[88:91], v[196:199]
    ds_read_b64_tr_b16 v[240:241], v4 offset:11264
    v_mfma_f32_16x16x32_bf16 v[212:215], v[244:247], v[92:95], v[212:215]
    ds_read_b64_tr_b16 v[242:243], v4 offset:11520
    s_waitcnt lgkmcnt(10)
    v_mfma_f32_16x16x32_bf16 v[200:203], v[248:251], v[88:91], v[200:203]
    ds_read_b64_tr_b16 v[244:245], v5 offset:11264
    v_mfma_f32_16x16x32_bf16 v[216:219], v[248:251], v[92:95], v[216:219]
    ds_read_b64_tr_b16 v[246:247], v5 offset:11520
    v_mfma_f32_16x16x32_bf16 v[204:207], v[252:255], v[88:91], v[204:207]
    ds_read_b64_tr_b16 v[248:249], v4 offset:11776
    v_mfma_f32_16x16x32_bf16 v[220:223], v[252:255], v[92:95], v[220:223]
    ds_read_b64_tr_b16 v[250:251], v4 offset:12032
    s_waitcnt lgkmcnt(10)
    v_mfma_f32_16x16x32_bf16 v[192:195], v[224:227], v[96:99], v[192:195]
    ds_read_b64_tr_b16 v[252:253], v5 offset:11776
    v_mfma_f32_16x16x32_bf16 v[208:211], v[224:227], v[100:103], v[208:211]
    ds_read_b64_tr_b16 v[254:255], v5 offset:12032
    s_barrier
    v_mfma_f32_16x16x32_bf16 v[196:199], v[228:231], v[96:99], v[196:199]
    ds_read_b64_tr_b16 v[224:225], v4 offset:12288
    v_mfma_f32_16x16x32_bf16 v[212:215], v[228:231], v[100:103], v[212:215]
    ds_read_b64_tr_b16 v[226:227], v4 offset:12544
    s_waitcnt lgkmcnt(10)
    v_mfma_f32_16x16x32_bf16 v[200:203], v[232:235], v[96:99], v[200:203]
    ds_read_b64_tr_b16 v[228:229], v5 offset:12288
    v_mfma_f32_16x16x32_bf16 v[216:219], v[232:235], v[100:103], v[216:219]
    ds_read_b64_tr_b16 v[230:231], v5 offset:12544
    v_mfma_f32_16x16x32_bf16 v[204:207], v[236:239], v[96:99], v[204:207]
    ds_read_b64_tr_b16 v[232:233], v4 offset:12800
    v_mfma_f32_16x16x32_bf16 v[220:223], v[236:239], v[100:103], v[220:223]
    ds_read_b64_tr_b16 v[234:235], v4 offset:13056
    s_waitcnt lgkmcnt(10)
    v_mfma_f32_16x16x32_bf16 v[192:195], v[240:243], v[104:107], v[192:195]
    ds_read_b64_tr_b16 v[236:237], v5 offset:12800
    v_mfma_f32_16x16x32_bf16 v[208:211], v[240:243], v[108:111], v[208:211]
    ds_read_b64_tr_b16 v[238:239], v5 offset:13056
    v_mfma_f32_16x16x32_bf16 v[196:199], v[244:247], v[104:107], v[196:199]
    ds_read_b64_tr_b16 v[240:241], v4 offset:13312
    v_mfma_f32_16x16x32_bf16 v[212:215], v[244:247], v[108:111], v[212:215]
    ds_read_b64_tr_b16 v[242:243], v4 offset:13568
    s_waitcnt lgkmcnt(10)
    v_mfma_f32_16x16x32_bf16 v[200:203], v[248:251], v[104:107], v[200:203]
    ds_read_b64_tr_b16 v[244:245], v5 offset:13312
    v_mfma_f32_16x16x32_bf16 v[216:219], v[248:251], v[108:111], v[216:219]
    ds_read_b64_tr_b16 v[246:247], v5 offset:13568
    v_mfma_f32_16x16x32_bf16 v[204:207], v[252:255], v[104:107], v[204:207]
    ds_read_b64_tr_b16 v[248:249], v4 offset:13824
    v_mfma_f32_16x16x32_bf16 v[220:223], v[252:255], v[108:111], v[220:223]
    ds_read_b64_tr_b16 v[250:251], v4 offset:14080
    s_waitcnt lgkmcnt(10)
    v_mfma_f32_16x16x32_bf16 v[192:195], v[224:227], v[112:115], v[192:195]
    ds_read_b64_tr_b16 v[252:253], v5 offset:13824
    v_mfma_f32_16x16x32_bf16 v[208:211], v[224:227], v[116:119], v[208:211]
    ds_read_b64_tr_b16 v[254:255], v5 offset:14080
    v_mfma_f32_16x16x32_bf16 v[196:199], v[228:231], v[112:115], v[196:199]
    ds_read_b64_tr_b16 v[224:225], v4 offset:14336
    v_mfma_f32_16x16x32_bf16 v[212:215], v[228:231], v[116:119], v[212:215]
    ds_read_b64_tr_b16 v[226:227], v4 offset:14592
    s_waitcnt lgkmcnt(10)
    v_mfma_f32_16x16x32_bf16 v[200:203], v[232:235], v[112:115], v[200:203]
    ds_read_b64_tr_b16 v[228:229], v5 offset:14336
    v_mfma_f32_16x16x32_bf16 v[216:219], v[232:235], v[116:119], v[216:219]
    ds_read_b64_tr_b16 v[230:231], v5 offset:14592
    v_mfma_f32_16x16x32_bf16 v[204:207], v[236:239], v[112:115], v[204:207]
    ds_read_b64_tr_b16 v[232:233], v4 offset:14848
    v_mfma_f32_16x16x32_bf16 v[220:223], v[236:239], v[116:119], v[220:223]
    ds_read_b64_tr_b16 v[234:235], v4 offset:15104
    s_waitcnt lgkmcnt(10)
    v_mfma_f32_16x16x32_bf16 v[192:195], v[240:243], v[120:123], v[192:195]
    ds_read_b64_tr_b16 v[236:237], v5 offset:14848
    v_mfma_f32_16x16x32_bf16 v[208:211], v[240:243], v[124:127], v[208:211]
    ds_read_b64_tr_b16 v[238:239], v5 offset:15104
    v_mfma_f32_16x16x32_bf16 v[196:199], v[244:247], v[120:123], v[196:199]
    ds_read_b64_tr_b16 v[240:241], v4 offset:15360
    v_mfma_f32_16x16x32_bf16 v[212:215], v[244:247], v[124:127], v[212:215]
    ds_read_b64_tr_b16 v[242:243], v4 offset:15616
    s_waitcnt lgkmcnt(10)
    v_mfma_f32_16x16x32_bf16 v[200:203], v[248:251], v[120:123], v[200:203]
    ds_read_b64_tr_b16 v[244:245], v5 offset:15360
    v_mfma_f32_16x16x32_bf16 v[216:219], v[248:251], v[124:127], v[216:219]
    ds_read_b64_tr_b16 v[246:247], v5 offset:15616
    v_mfma_f32_16x16x32_bf16 v[204:207], v[252:255], v[120:123], v[204:207]
    ds_read_b64_tr_b16 v[248:249], v4 offset:15872
    v_mfma_f32_16x16x32_bf16 v[220:223], v[252:255], v[124:127], v[220:223]
    ds_read_b64_tr_b16 v[250:251], v4 offset:16128
    s_waitcnt lgkmcnt(10)
    v_mfma_f32_16x16x32_bf16 v[192:195], v[224:227], v[128:131], v[192:195]
    ds_read_b64_tr_b16 v[252:253], v5 offset:15872
    v_mfma_f32_16x16x32_bf16 v[208:211], v[224:227], v[132:135], v[208:211]
    ds_read_b64_tr_b16 v[254:255], v5 offset:16128
    v_mfma_f32_16x16x32_bf16 v[196:199], v[228:231], v[128:131], v[196:199]
    ds_read_b64_tr_b16 v[224:225], v4 offset:16384
    v_mfma_f32_16x16x32_bf16 v[212:215], v[228:231], v[132:135], v[212:215]
    ds_read_b64_tr_b16 v[226:227], v4 offset:16640
    s_waitcnt lgkmcnt(10)
    v_mfma_f32_16x16x32_bf16 v[200:203], v[232:235], v[128:131], v[200:203]
    ds_read_b64_tr_b16 v[228:229], v5 offset:16384
    v_mfma_f32_16x16x32_bf16 v[216:219], v[232:235], v[132:135], v[216:219]
    ds_read_b64_tr_b16 v[230:231], v5 offset:16640
    v_mfma_f32_16x16x32_bf16 v[204:207], v[236:239], v[128:131], v[204:207]
    ds_read_b64_tr_b16 v[232:233], v4 offset:16896
    v_mfma_f32_16x16x32_bf16 v[220:223], v[236:239], v[132:135], v[220:223]
    ds_read_b64_tr_b16 v[234:235], v4 offset:17152
    s_waitcnt lgkmcnt(10)
    v_mfma_f32_16x16x32_bf16 v[192:195], v[240:243], v[136:139], v[192:195]
    ds_read_b64_tr_b16 v[236:237], v5 offset:16896
    v_mfma_f32_16x16x32_bf16 v[208:211], v[240:243], v[140:143], v[208:211]
    ds_read_b64_tr_b16 v[238:239], v5 offset:17152
    v_mfma_f32_16x16x32_bf16 v[196:199], v[244:247], v[136:139], v[196:199]
    ds_read_b64_tr_b16 v[240:241], v4 offset:17408
    v_mfma_f32_16x16x32_bf16 v[212:215], v[244:247], v[140:143], v[212:215]
    ds_read_b64_tr_b16 v[242:243], v4 offset:17664
    s_waitcnt lgkmcnt(10)
    v_mfma_f32_16x16x32_bf16 v[200:203], v[248:251], v[136:139], v[200:203]
    ds_read_b64_tr_b16 v[244:245], v5 offset:17408
    v_mfma_f32_16x16x32_bf16 v[216:219], v[248:251], v[140:143], v[216:219]
    ds_read_b64_tr_b16 v[246:247], v5 offset:17664
    v_mfma_f32_16x16x32_bf16 v[204:207], v[252:255], v[136:139], v[204:207]
    ds_read_b64_tr_b16 v[248:249], v4 offset:17920
    v_mfma_f32_16x16x32_bf16 v[220:223], v[252:255], v[140:143], v[220:223]
    ds_read_b64_tr_b16 v[250:251], v4 offset:18176
    s_waitcnt lgkmcnt(10)
    v_mfma_f32_16x16x32_bf16 v[192:195], v[224:227], v[144:147], v[192:195]
    ds_read_b64_tr_b16 v[252:253], v5 offset:17920
    v_mfma_f32_16x16x32_bf16 v[208:211], v[224:227], v[148:151], v[208:211]
    ds_read_b64_tr_b16 v[254:255], v5 offset:18176
    s_barrier
    v_mfma_f32_16x16x32_bf16 v[196:199], v[228:231], v[144:147], v[196:199]
    ds_read_b64_tr_b16 v[224:225], v2 offset:0
    v_mfma_f32_16x16x32_bf16 v[212:215], v[228:231], v[148:151], v[212:215]
    ds_read_b64_tr_b16 v[226:227], v2 offset:256
    s_waitcnt lgkmcnt(10)
    v_mfma_f32_16x16x32_bf16 v[200:203], v[232:235], v[144:147], v[200:203]
    ds_read_b64_tr_b16 v[228:229], v3 offset:0
    v_mfma_f32_16x16x32_bf16 v[216:219], v[232:235], v[148:151], v[216:219]
    ds_read_b64_tr_b16 v[230:231], v3 offset:256
    v_mfma_f32_16x16x32_bf16 v[204:207], v[236:239], v[144:147], v[204:207]
    ds_read_b64_tr_b16 v[232:233], v2 offset:512
    v_mfma_f32_16x16x32_bf16 v[220:223], v[236:239], v[148:151], v[220:223]
    ds_read_b64_tr_b16 v[234:235], v2 offset:768
    s_waitcnt lgkmcnt(10)
    v_mfma_f32_16x16x32_bf16 v[192:195], v[240:243], v[152:155], v[192:195]
    ds_read_b64_tr_b16 v[236:237], v3 offset:512
    v_mfma_f32_16x16x32_bf16 v[208:211], v[240:243], v[156:159], v[208:211]
    ds_read_b64_tr_b16 v[238:239], v3 offset:768
    v_mfma_f32_16x16x32_bf16 v[196:199], v[244:247], v[152:155], v[196:199]
    ds_read_b64_tr_b16 v[240:241], v2 offset:1024
    v_mfma_f32_16x16x32_bf16 v[212:215], v[244:247], v[156:159], v[212:215]
    ds_read_b64_tr_b16 v[242:243], v2 offset:1280
    s_waitcnt lgkmcnt(10)
    v_mfma_f32_16x16x32_bf16 v[200:203], v[248:251], v[152:155], v[200:203]
    ds_read_b64_tr_b16 v[244:245], v3 offset:1024
    v_mfma_f32_16x16x32_bf16 v[216:219], v[248:251], v[156:159], v[216:219]
    ds_read_b64_tr_b16 v[246:247], v3 offset:1280
    v_mfma_f32_16x16x32_bf16 v[204:207], v[252:255], v[152:155], v[204:207]
    ds_read_b64_tr_b16 v[248:249], v2 offset:1536
    v_mfma_f32_16x16x32_bf16 v[220:223], v[252:255], v[156:159], v[220:223]
    ds_read_b64_tr_b16 v[250:251], v2 offset:1792
    s_add_u32 s59, s59, 1
    s_cmp_eq_u32 s59, s70
    s_cbranch_scc1 L_b0l
    s_branch L_b0n
L_b1q:
    s_waitcnt lgkmcnt(10)
    v_mfma_f32_16x16x32_bf16 v[192:195], v[224:227], v[16:19], 0
    ds_read_b64_tr_b16 v[252:253], v5 offset:1536
    v_mfma_f32_16x16x32_bf16 v[208:211], v[224:227], v[20:23], 0
    ds_read_b64_tr_b16 v[254:255], v5 offset:1792
    v_mfma_f32_16x16x32_bf16 v[196:199], v[228:231], v[16:19], 0
    ds_read_b64_tr_b16 v[224:225], v4 offset:2048
    v_mfma_f32_16x16x32_bf16 v[212:215], v[228:231], v[20:23], 0
    ds_read_b64_tr_b16 v[226:227], v4 offset:2304
    s_waitcnt lgkmcnt(10)
    v_mfma_f32_16x16x32_bf16 v[200:203], v[232:235], v[16:19], 0
    ds_read_b64_tr_b16 v[228:229], v5 offset:2048
    v_mfma_f32_16x16x32_bf16 v[216:219], v[232:235], v[20:23], 0
    ds_read_b64_tr_b16 v[230:231], v5 offset:2304
    v_mfma_f32_16x16x32_bf16 v[204:207], v[236:239], v[16:19], 0
    ds_read_b64_tr_b16 v[232:233], v4 offset:2560
    v_mfma_f32_16x16x32_bf16 v[220:223], v[236:239], v[20:23], 0
    ds_read_b64_tr_b16 v[234:235], v4 offset:2816
    s_waitcnt lgkmcnt(10)
    v_mfma_f32_16x16x32_bf16 v[192:195], v[240:243], v[24:27], v[192:195]
    ds_read_b64_tr_b16 v[236:237], v5 offset:2560
    v_mfma_f32_16x16x32_bf16 v[208:211], v[240:243], v[28:31], v[208:211]
    ds_read_b64_tr_b16 v[238:239], v5 offset:2816
    v_mfma_f32_16x16x32_bf16 v[196:199], v[244:247], v[24:27], v[196:199]
    ds_read_b64_tr_b16 v[240:241], v4 offset:3072
    v_mfma_f32_16x16x32_bf16 v[212:215], v[244:247], v[28:31], v[212:215]
    ds_read_b64_tr_b16 v[242:243], v4 offset:3328
    s_waitcnt lgkmcnt(10)
    v_mfma_f32_16x16x32_bf16 v[200:203], v[248:251], v[24:27], v[200:203]
    ds_read_b64_tr_b16 v[244:245], v5 offset:3072
    v_mul_f32 v160, v7, v160
    v_mfma_f32_16x16x32_bf16 v[216:219], v[248:251], v[28:31], v[216:219]
    ds_read_b64_tr_b16 v[246:247], v5 offset:3328
    v_mul_f32 v176, v8, v176
    v_mfma_f32_16x16x32_bf16 v[204:207], v[252:255], v[24:27], v[204:207]
    ds_read_b64_tr_b16 v[248:249], v4 offset:3584
    v_mul_f32 v161, v7, v161
    v_mfma_f32_16x16x32_bf16 v[220:223], v[252:255], v[28:31], v[220:223]
    ds_read_b64_tr_b16 v[250:251], v4 offset:3840
    s_waitcnt lgkmcnt(10)
    v_mfma_f32_16x16x32_bf16 v[192:195], v[224:227], v[32:35], v[192:195]
    ds_read_b64_tr_b16 v[252:253], v5 offset:3584
    v_mul_f32 v177, v8, v177
    v_mfma_f32_16x16x32_bf16 v[208:211], v[224:227], v[36:39], v[208:211]
    ds_read_b64_tr_b16 v[254:255], v5 offset:3840
    v_mul_f32 v162, v7, v162
    v_mfma_f32_16x16x32_bf16 v[196:199], v[228:231], v[32:35], v[196:199]
    ds_read_b64_tr_b16 v[224:225], v4 offset:4096
    v_mul_f32 v178, v8, v178
    v_mfma_f32_16x16x32_bf16 v[212:215], v[228:231], v[36:39], v[212:215]
    ds_read_b64_tr_b16 v[226:227], v4 offset:4352
    s_waitcnt lgkmcnt(10)
    v_mfma_f32_16x16x32_bf16 v[200:203], v[232:235], v[32:35], v[200:203]
    ds_read_b64_tr_b16 v[228:229], v5 offset:4096
    v_mul_f32 v163, v7, v163
    v_mfma_f32_16x16x32_bf16 v[216:219], v[232:235], v[36:39], v[216:219]
    ds_read_b64_tr_b16 v[230:231], v5 offset:4352
    v_mul_f32 v179, v8, v179
    v_mfma_f32_16x16x32_bf16 v[204:207], v[236:239], v[32:35], v[204:207]
    ds_read_b64_tr_b16 v[232:233], v4 offset:4608
    v_cvt_pk_bf16_f32 v160, v160, v161
    v_mfma_f32_16x16x32_bf16 v[220:223], v[236:239], v[36:39], v[220:223]
    ds_read_b64_tr_b16 v[234:235], v4 offset:4864
    s_waitcnt lgkmcnt(10)
    v_mfma_f32_16x16x32_bf16 v[192:195], v[240:243], v[40:43], v[192:195]
    ds_read_b64_tr_b16 v[236:237], v5 offset:4608
    v_cvt_pk_bf16_f32 v161, v162, v163
    v_mfma_f32_16x16x32_bf16 v[208:211], v[240:243], v[44:47], v[208:211]
    ds_read_b64_tr_b16 v[238:239], v5 offset:4864
    v_cvt_pk_bf16_f32 v162, v176, v177
    v_mfma_f32_16x16x32_bf16 v[196:199], v[244:247], v[40:43], v[196:199]
    ds_read_b64_tr_b16 v[240:241], v4 offset:5120
    v_cvt_pk_bf16_f32 v163, v178, v179
    v_mfma_f32_16x16x32_bf16 v[212:215], v[244:247], v[44:47], v[212:215]
    ds_read_b64_tr_b16 v[242:243], v4 offset:5376
    s_waitcnt lgkmcnt(10)
    v_mfma_f32_16x16x32_bf16 v[200:203], v[248:251], v[40:43], v[200:203]
    ds_read_b64_tr_b16 v[244:245], v5 offset:5120
    s_nop 1
    v_mfma_f32_16x16x32_bf16 v[216:219], v[248:251], v[44:47], v[216:219]
    ds_read_b64_tr_b16 v[246:247], v5 offset:5376
    v_permlane16_swap_b32 v160, v162
    v_mfma_f32_16x16x32_bf16 v[204:207], v[252:255], v[40:43], v[204:207]
    ds_read_b64_tr_b16 v[248:249], v4 offset:5632
    v_permlane16_swap_b32 v161, v163
    v_mfma_f32_16x16x32_bf16 v[220:223], v[252:255], v[44:47], v[220:223]
    ds_read_b64_tr_b16 v[250:251], v4 offset:5888
    s_waitcnt lgkmcnt(10)
    v_mfma_f32_16x16x32_bf16 v[192:195], v[224:227], v[48:51], v[192:195]
    ds_read_b64_tr_b16 v[252:253], v5 offset:5632
    buffer_store_dwordx4 v[160:163], v6, s[32:35], s61 offen offset:0 sc1
    v_mfma_f32_16x16x32_bf16 v[208:211], v[224:227], v[52:55], v[208:211]
    ds_read_b64_tr_b16 v[254:255], v5 offset:5888
    v_mul_f32 v164, v7, v164
    s_barrier
    v_mfma_f32_16x16x32_bf16 v[196:199], v[228:231], v[48:51], v[196:199]
    ds_read_b64_tr_b16 v[224:225], v4 offset:6144
    v_mul_f32 v180, v8, v180
    v_mfma_f32_16x16x32_bf16 v[212:215], v[228:231], v[52:55], v[212:215]
    ds_read_b64_tr_b16 v[226:227], v4 offset:6400
    s_waitcnt lgkmcnt(10)
    v_mfma_f32_16x16x32_bf16 v[200:203], v[232:235], v[48:51], v[200:203]
    ds_read_b64_tr_b16 v[228:229], v5 offset:6144
    v_mul_f32 v165, v7, v165
    v_mfma_f32_16x16x32_bf16 v[216:219], v[232:235], v[52:55], v[216:219]
    ds_read_b64_tr_b16 v[230:231], v5 offset:6400
    v_mul_f32 v181, v8, v181
    v_mfma_f32_16x16x32_bf16 v[204:207], v[236:239], v[48:51], v[204:207]
    ds_read_b64_tr_b16 v[232:233], v4 offset:6656
    v_mul_f32 v166, v7, v166
    v_mfma_f32_16x16x32_bf16 v[220:223], v[236:239], v[52:55], v[220:223]
    ds_read_b64_tr_b16 v[234:235], v4 offset:6912
    s_waitcnt lgkmcnt(10)
    v_mfma_f32_16x16x32_bf16 v[192:195], v[240:243], v[56:59], v[192:195]
    ds_read_b64_tr_b16 v[236:237], v5 offset:6656
    v_mul_f32 v182, v8, v182
    v_mfma_f32_16x16x32_bf16 v[208:211], v[240:243], v[60:63], v[208:211]
    ds_read_b64_tr_b16 v[238:239], v5 offset:6912
    v_mul_f32 v167, v7, v167
    v_mfma_f32_16x16x32_bf16 v[196:199], v[244:247], v[56:59], v[196:199]
    ds_read_b64_tr_b16 v[240:241], v4 offset:7168
    v_mul_f32 v183, v8, v183
    v_mfma_f32_16x16x32_bf16 v[212:215], v[244:247], v[60:63], v[212:215]
    ds_read_b64_tr_b16 v[242:243], v4 offset:7424
    s_waitcnt lgkmcnt(10)
    v_mfma_f32_16x16x32_bf16 v[200:203], v[248:251], v[56:59], v[200:203]
    ds_read_b64_tr_b16 v[244:245], v5 offset:7168
    v_cvt_pk_bf16_f32 v164, v164, v165
    v_mfma_f32_16x16x32_bf16 v[216:219], v[248:251], v[60:63], v[216:219]
    ds_read_b64_tr_b16 v[246:247], v5 offset:7424
    v_cvt_pk_bf16_f32 v165, v166, v167
    v_mfma_f32_16x16x32_bf16 v[204:207], v[252:255], v[56:59], v[204:207]
    ds_read_b64_tr_b16 v[248:249], v4 offset:7680
    v_cvt_pk_bf16_f32 v166, v180, v181
    v_mfma_f32_16x16x32_bf16 v[220:223], v[252:255], v[60:63], v[220:223]
    ds_read_b64_tr_b16 v[250:251], v4 offset:7936
    s_waitcnt lgkmcnt(10)
    v_mfma_f32_16x16x32_bf16 v[192:195], v[224:227], v[64:67], v[192:195]
    ds_read_b64_tr_b16 v[252:253], v5 offset:7680
    v_cvt_pk_bf16_f32 v167, v182, v183
    v_mfma_f32_16x16x32_bf16 v[208:211], v[224:227], v[68:71], v[208:211]
    ds_read_b64_tr_b16 v[254:255], v5 offset:7936
    s_nop 1
    v_mfma_f32_16x16x32_bf16 v[196:199], v[228:231], v[64:67], v[196:199]
    ds_read_b64_tr_b16 v[224:225], v4 offset:8192
    v_permlane16_swap_b32 v164, v166
    v_mfma_f32_16x16x32_bf16 v[212:215], v[228:231], v[68:71], v[212:215]
    ds_read_b64_tr_b16 v[226:227], v4 offset:8448
    s_waitcnt lgkmcnt(10)
    v_mfma_f32_16x16x32_bf16 v[200:203], v[232:235], v[64:67], v[200:203]
    ds_read_b64_tr_b16 v[228:229], v5 offset:8192
    v_permlane16_swap_b32 v165, v167
    v_mfma_f32_16x16x32_bf16 v[216:219], v[232:235], v[68:71], v[216:219]
    ds_read_b64_tr_b16 v[230:231], v5 offset:8448
    buffer_store_dwordx4 v[164:167], v6, s[32:35], s61 offen offset:1024 sc1
    v_mfma_f32_16x16x32_bf16 v[204:207], v[236:239], v[64:67], v[204:207]
    ds_read_b64_tr_b16 v[232:233], v4 offset:8704
    v_mul_f32 v168, v7, v168
    v_mfma_f32_16x16x32_bf16 v[220:223], v[236:239], v[68:71], v[220:223]
    ds_read_b64_tr_b16 v[234:235], v4 offset:8960
    s_waitcnt lgkmcnt(10)
    v_mfma_f32_16x16x32_bf16 v[192:195], v[240:243], v[72:75], v[192:195]
    ds_read_b64_tr_b16 v[236:237], v5 offset:8704
    v_mul_f32 v184, v8, v184
    v_mfma_f32_16x16x32_bf16 v[208:211], v[240:243], v[76:79], v[208:211]
    ds_read_b64_tr_b16 v[238:239], v5 offset:8960
    v_mul_f32 v169, v7, v169
    v_mfma_f32_16x16x32_bf16 v[196:199], v[244:247], v[72:75], v[196:199]
    ds_read_b64_tr_b16 v[240:241], v4 offset:9216
    v_mul_f32 v185, v8, v185
    v_mfma_f32_16x16x32_bf16 v[212:215], v[244:247], v[76:79], v[212:215]
    ds_read_b64_tr_b16 v[242:243], v4 offset:9472
    s_waitcnt lgkmcnt(10)
    v_mfma_f32_16x16x32_bf16 v[200:203], v[248:251], v[72:75], v[200:203]
    ds_read_b64_tr_b16 v[244:245], v5 offset:9216
    v_mul_f32 v170, v7, v170
    v_mfma_f32_16x16x32_bf16 v[216:219], v[248:251], v[76:79], v[216:219]
    ds_read_b64_tr_b16 v[246:247], v5 offset:9472
    v_mul_f32 v186, v8, v186
    v_mfma_f32_16x16x32_bf16 v[204:207], v[252:255], v[72:75], v[204:207]
    ds_read_b64_tr_b16 v[248:249], v4 offset:9728
    v_mul_f32 v171, v7, v171
    v_mfma_f32_16x16x32_bf16 v[220:223], v[252:255], v[76:79], v[220:223]
    ds_read_b64_tr_b16 v[250:251], v4 offset:9984
    s_waitcnt lgkmcnt(10)
    v_mfma_f32_16x16x32_bf16 v[192:195], v[224:227], v[80:83], v[192:195]
    ds_read_b64_tr_b16 v[252:253], v5 offset:9728
    v_mul_f32 v187, v8, v187
    v_mfma_f32_16x16x32_bf16 v[208:211], v[224:227], v[84:87], v[208:211]
    ds_read_b64_tr_b16 v[254:255], v5 offset:9984
    v_cvt_pk_bf16_f32 v168, v168, v169
    v_mfma_f32_16x16x32_bf16 v[196:199], v[228:231], v[80:83], v[196:199]
    ds_read_b64_tr_b16 v[224:225], v4 offset:10240
    v_cvt_pk_bf16_f32 v169, v170, v171
    v_mfma_f32_16x16x32_bf16 v[212:215], v[228:231], v[84:87], v[212:215]
    ds_read_b64_tr_b16 v[226:227], v4 offset:10496
    s_waitcnt lgkmcnt(10)
    v_mfma_f32_16x16x32_bf16 v[200:203], v[232:235], v[80:83], v[200:203]
    ds_read_b64_tr_b16 v[228:229], v5 offset:10240
    v_cvt_pk_bf16_f32 v170, v184, v185
    v_mfma_f32_16x16x32_bf16 v[216:219], v[232:235], v[84:87], v[216:219]
    ds_read_b64_tr_b16 v[230:231], v5 offset:10496
    v_cvt_pk_bf16_f32 v171, v186, v187
    v_mfma_f32_16x16x32_bf16 v[204:207], v[236:239], v[80:83], v[204:207]
    ds_read_b64_tr_b16 v[232:233], v4 offset:10752
    s_nop 1
    v_mfma_f32_16x16x32_bf16 v[220:223], v[236:239], v[84:87], v[220:223]
    ds_read_b64_tr_b16 v[234:235], v4 offset:11008
    s_waitcnt lgkmcnt(10)
    v_mfma_f32_16x16x32_bf16 v[192:195], v[240:243], v[88:91], v[192:195]
    ds_read_b64_tr_b16 v[236:237], v5 offset:10752
    v_permlane16_swap_b32 v168, v170
    v_mfma_f32_16x16x32_bf16 v[208:211], v[240:243], v[92:95], v[208:211]
    ds_read_b64_tr_b16 v[238:239], v5 offset:11008
    v_permlane16_swap_b32 v169, v171
    v_mfma_f32_16x16x32_bf16 v[196:199], v[244:247], v[88:91], v[196:199]
    ds_read_b64_tr_b16 v[240:241], v4 offset:11264
    buffer_store_dwordx4 v[168:171], v6, s[32:35], s61 offen offset:2048 sc1
    v_mfma_f32_16x16x32_bf16 v[212:215], v[244:247], v[92:95], v[212:215]
    ds_read_b64_tr_b16 v[242:243], v4 offset:11520
    s_waitcnt lgkmcnt(10)
    v_mfma_f32_16x16x32_bf16 v[200:203], v[248:251], v[88:91], v[200:203]
    ds_read_b64_tr_b16 v[244:245], v5 offset:11264
    v_mul_f32 v172, v7, v172
    v_mfma_f32_16x16x32_bf16 v[216:219], v[248:251], v[92:95], v[216:219]
    ds_read_b64_tr_b16 v[246:247], v5 offset:11520
    v_mul_f32 v188, v8, v188
    v_mfma_f32_16x16x32_bf16 v[204:207], v[252:255], v[88:91], v[204:207]
    ds_read_b64_tr_b16 v[248:249], v4 offset:11776
    v_mul_f32 v173, v7, v173
    v_mfma_f32_16x16x32_bf16 v[220:223], v[252:255], v[92:95], v[220:223]
    ds_read_b64_tr_b16 v[250:251], v4 offset:12032
    s_waitcnt lgkmcnt(10)
    v_mfma_f32_16x16x32_bf16 v[192:195], v[224:227], v[96:99], v[192:195]
    ds_read_b64_tr_b16 v[252:253], v5 offset:11776
    v_mul_f32 v189, v8, v189
    v_mfma_f32_16x16x32_bf16 v[208:211], v[224:227], v[100:103], v[208:211]
    ds_read_b64_tr_b16 v[254:255], v5 offset:12032
    v_mul_f32 v174, v7, v174
    s_barrier
    v_mfma_f32_16x16x32_bf16 v[196:199], v[228:231], v[96:99], v[196:199]
    ds_read_b64_tr_b16 v[224:225], v4 offset:12288
    v_mul_f32 v190, v8, v190
    v_mfma_f32_16x16x32_bf16 v[212:215], v[228:231], v[100:103], v[212:215]
    ds_read_b64_tr_b16 v[226:227], v4 offset:12544
    s_waitcnt lgkmcnt(10)
    v_mfma_f32_16x16x32_bf16 v[200:203], v[232:235], v[96:99], v[200:203]
    ds_read_b64_tr_b16 v[228:229], v5 offset:12288
    v_mul_f32 v175, v7, v175
    v_mfma_f32_16x16x32_bf16 v[216:219], v[232:235], v[100:103], v[216:219]
    ds_read_b64_tr_b16 v[230:231], v5 offset:12544
    v_mul_f32 v191, v8, v191
    v_mfma_f32_16x16x32_bf16 v[204:207], v[236:239], v[96:99], v[204:207]
    ds_read_b64_tr_b16 v[232:233], v4 offset:12800
    v_cvt_pk_bf16_f32 v172, v172, v173
    v_mfma_f32_16x16x32_bf16 v[220:223], v[236:239], v[100:103], v[220:223]
    ds_read_b64_tr_b16 v[234:235], v4 offset:13056
    s_waitcnt lgkmcnt(10)
    v_mfma_f32_16x16x32_bf16 v[192:195], v[240:243], v[104:107], v[192:195]
    ds_read_b64_tr_b16 v[236:237], v5 offset:12800
    v_cvt_pk_bf16_f32 v173, v174, v175
    v_mfma_f32_16x16x32_bf16 v[208:211], v[240:243], v[108:111], v[208:211]
    ds_read_b64_tr_b16 v[238:239], v5 offset:13056
    v_cvt_pk_bf16_f32 v174, v188, v189
    v_mfma_f32_16x16x32_bf16 v[196:199], v[244:247], v[104:107], v[196:199]
    ds_read_b64_tr_b16 v[240:241], v4 offset:13312
    v_cvt_pk_bf16_f32 v175, v190, v191
    v_mfma_f32_16x16x32_bf16 v[212:215], v[244:247], v[108:111], v[212:215]
    ds_read_b64_tr_b16 v[242:243], v4 offset:13568
    s_waitcnt lgkmcnt(10)
    v_mfma_f32_16x16x32_bf16 v[200:203], v[248:251], v[104:107], v[200:203]
    ds_read_b64_tr_b16 v[244:245], v5 offset:13312
    s_nop 1
    v_mfma_f32_16x16x32_bf16 v[216:219], v[248:251], v[108:111], v[216:219]
    ds_read_b64_tr_b16 v[246:247], v5 offset:13568
    v_permlane16_swap_b32 v172, v174
    v_mfma_f32_16x16x32_bf16 v[204:207], v[252:255], v[104:107], v[204:207]
    ds_read_b64_tr_b16 v[248:249], v4 offset:13824
    v_permlane16_swap_b32 v173, v175
    v_mfma_f32_16x16x32_bf16 v[220:223], v[252:255], v[108:111], v[220:223]
    ds_read_b64_tr_b16 v[250:251], v4 offset:14080
    s_waitcnt lgkmcnt(10)
    v_mfma_f32_16x16x32_bf16 v[192:195], v[224:227], v[112:115], v[192:195]
    ds_read_b64_tr_b16 v[252:253], v5 offset:13824
    buffer_store_dwordx4 v[172:175], v6, s[32:35], s61 offen offset:3072 sc1
    v_mfma_f32_16x16x32_bf16 v[208:211], v[224:227], v[116:119], v[208:211]
    ds_read_b64_tr_b16 v[254:255], v5 offset:14080
    v_mfma_f32_16x16x32_bf16 v[196:199], v[228:231], v[112:115], v[196:199]
    ds_read_b64_tr_b16 v[224:225], v4 offset:14336
    v_mfma_f32_16x16x32_bf16 v[212:215], v[228:231], v[116:119], v[212:215]
    ds_read_b64_tr_b16 v[226:227], v4 offset:14592
    s_waitcnt lgkmcnt(10)
    v_mfma_f32_16x16x32_bf16 v[200:203], v[232:235], v[112:115], v[200:203]
    ds_read_b64_tr_b16 v[228:229], v5 offset:14336
    v_mfma_f32_16x16x32_bf16 v[216:219], v[232:235], v[116:119], v[216:219]
    ds_read_b64_tr_b16 v[230:231], v5 offset:14592
    v_mfma_f32_16x16x32_bf16 v[204:207], v[236:239], v[112:115], v[204:207]
    ds_read_b64_tr_b16 v[232:233], v4 offset:14848
    v_mfma_f32_16x16x32_bf16 v[220:223], v[236:239], v[116:119], v[220:223]
    ds_read_b64_tr_b16 v[234:235], v4 offset:15104
    s_waitcnt lgkmcnt(10)
    v_mfma_f32_16x16x32_bf16 v[192:195], v[240:243], v[120:123], v[192:195]
    ds_read_b64_tr_b16 v[236:237], v5 offset:14848
    v_mfma_f32_16x16x32_bf16 v[208:211], v[240:243], v[124:127], v[208:211]
    ds_read_b64_tr_b16 v[238:239], v5 offset:15104
    v_mfma_f32_16x16x32_bf16 v[196:199], v[244:247], v[120:123], v[196:199]
    ds_read_b64_tr_b16 v[240:241], v4 offset:15360
    v_mfma_f32_16x16x32_bf16 v[212:215], v[244:247], v[124:127], v[212:215]
    ds_read_b64_tr_b16 v[242:243], v4 offset:15616
    s_waitcnt lgkmcnt(10)
    v_mfma_f32_16x16x32_bf16 v[200:203], v[248:251], v[120:123], v[200:203]
    ds_read_b64_tr_b16 v[244:245], v5 offset:15360
    v_mfma_f32_16x16x32_bf16 v[216:219], v[248:251], v[124:127], v[216:219]
    ds_read_b64_tr_b16 v[246:247], v5 offset:15616
    v_mfma_f32_16x16x32_bf16 v[204:207], v[252:255], v[120:123], v[204:207]
    ds_read_b64_tr_b16 v[248:249], v4 offset:15872
    v_mfma_f32_16x16x32_bf16 v[220:223], v[252:255], v[124:127], v[220:223]
    ds_read_b64_tr_b16 v[250:251], v4 offset:16128
    s_waitcnt lgkmcnt(10)
    v_mfma_f32_16x16x32_bf16 v[192:195], v[224:227], v[128:131], v[192:195]
    ds_read_b64_tr_b16 v[252:253], v5 offset:15872
    v_mfma_f32_16x16x32_bf16 v[208:211], v[224:227], v[132:135], v[208:211]
    ds_read_b64_tr_b16 v[254:255], v5 offset:16128
    v_mfma_f32_16x16x32_bf16 v[196:199], v[228:231], v[128:131], v[196:199]
    ds_read_b64_tr_b16 v[224:225], v4 offset:16384
    v_mfma_f32_16x16x32_bf16 v[212:215], v[228:231], v[132:135], v[212:215]
    ds_read_b64_tr_b16 v[226:227], v4 offset:16640
    s_waitcnt lgkmcnt(10)
    v_mfma_f32_16x16x32_bf16 v[200:203], v[232:235], v[128:131], v[200:203]
    ds_read_b64_tr_b16 v[228:229], v5 offset:16384
    v_mfma_f32_16x16x32_bf16 v[216:219], v[232:235], v[132:135], v[216:219]
    ds_read_b64_tr_b16 v[230:231], v5 offset:16640
    v_mfma_f32_16x16x32_bf16 v[204:207], v[236:239], v[128:131], v[204:207]
    ds_read_b64_tr_b16 v[232:233], v4 offset:16896
    v_mfma_f32_16x16x32_bf16 v[220:223], v[236:239], v[132:135], v[220:223]
    ds_read_b64_tr_b16 v[234:235], v4 offset:17152
    s_waitcnt lgkmcnt(10)
    v_mfma_f32_16x16x32_bf16 v[192:195], v[240:243], v[136:139], v[192:195]
    ds_read_b64_tr_b16 v[236:237], v5 offset:16896
    v_mfma_f32_16x16x32_bf16 v[208:211], v[240:243], v[140:143], v[208:211]
    ds_read_b64_tr_b16 v[238:239], v5 offset:17152
    v_mfma_f32_16x16x32_bf16 v[196:199], v[244:247], v[136:139], v[196:199]
    ds_read_b64_tr_b16 v[240:241], v4 offset:17408
    v_mfma_f32_16x16x32_bf16 v[212:215], v[244:247], v[140:143], v[212:215]
    ds_read_b64_tr_b16 v[242:243], v4 offset:17664
    s_waitcnt lgkmcnt(10)
    v_mfma_f32_16x16x32_bf16 v[200:203], v[248:251], v[136:139], v[200:203]
    ds_read_b64_tr_b16 v[244:245], v5 offset:17408
    v_mfma_f32_16x16x32_bf16 v[216:219], v[248:251], v[140:143], v[216:219]
    ds_read_b64_tr_b16 v[246:247], v5 offset:17664
    v_mfma_f32_16x16x32_bf16 v[204:207], v[252:255], v[136:139], v[204:207]
    ds_read_b64_tr_b16 v[248:249], v4 offset:17920
    v_mfma_f32_16x16x32_bf16 v[220:223], v[252:255], v[140:143], v[220:223]
    ds_read_b64_tr_b16 v[250:251], v4 offset:18176
    s_waitcnt lgkmcnt(10)
    v_mfma_f32_16x16x32_bf16 v[192:195], v[224:227], v[144:147], v[192:195]
    ds_read_b64_tr_b16 v[252:253], v5 offset:17920
    v_mfma_f32_16x16x32_bf16 v[208:211], v[224:227], v[148:151], v[208:211]
    ds_read_b64_tr_b16 v[254:255], v5 offset:18176
    s_barrier
    v_mfma_f32_16x16x32_bf16 v[196:199], v[228:231], v[144:147], v[196:199]
    ds_read_b64_tr_b16 v[224:225], v2 offset:0
    v_mfma_f32_16x16x32_bf16 v[212:215], v[228:231], v[148:151], v[212:215]
    ds_read_b64_tr_b16 v[226:227], v2 offset:256
    s_waitcnt lgkmcnt(10)
    v_mfma_f32_16x16x32_bf16 v[200:203], v[232:235], v[144:147], v[200:203]
    ds_read_b64_tr_b16 v[228:229], v3 offset:0
    v_mfma_f32_16x16x32_bf16 v[216:219], v[232:235], v[148:151], v[216:219]
    ds_read_b64_tr_b16 v[230:231], v3 offset:256
    v_mfma_f32_16x16x32_bf16 v[204:207], v[236:239], v[144:147], v[204:207]
    ds_read_b64_tr_b16 v[232:233], v2 offset:512
    v_mfma_f32_16x16x32_bf16 v[220:223], v[236:239], v[148:151], v[220:223]
    ds_read_b64_tr_b16 v[234:235], v2 offset:768
    s_waitcnt lgkmcnt(10)
    v_mfma_f32_16x16x32_bf16 v[192:195], v[240:243], v[152:155], v[192:195]
    ds_read_b64_tr_b16 v[236:237], v3 offset:512
    v_mfma_f32_16x16x32_bf16 v[208:211], v[240:243], v[156:159], v[208:211]
    ds_read_b64_tr_b16 v[238:239], v3 offset:768
    v_mfma_f32_16x16x32_bf16 v[196:199], v[244:247], v[152:155], v[196:199]
    ds_read_b64_tr_b16 v[240:241], v2 offset:1024
    v_mfma_f32_16x16x32_bf16 v[212:215], v[244:247], v[156:159], v[212:215]
    ds_read_b64_tr_b16 v[242:243], v2 offset:1280
    s_waitcnt lgkmcnt(10)
    v_mfma_f32_16x16x32_bf16 v[200:203], v[248:251], v[152:155], v[200:203]
    ds_read_b64_tr_b16 v[244:245], v3 offset:1024
    v_mfma_f32_16x16x32_bf16 v[216:219], v[248:251], v[156:159], v[216:219]
    ds_read_b64_tr_b16 v[246:247], v3 offset:1280
    v_mfma_f32_16x16x32_bf16 v[204:207], v[252:255], v[152:155], v[204:207]
    ds_read_b64_tr_b16 v[248:249], v2 offset:1536
    v_mfma_f32_16x16x32_bf16 v[220:223], v[252:255], v[156:159], v[220:223]
    ds_read_b64_tr_b16 v[250:251], v2 offset:1792
    s_add_u32 s59, s59, 1
    s_cmp_le_u32 s59, s55
    s_cbranch_scc1 L_wasq1
    s_waitcnt vmcnt(0)
    s_cmp_eq_u32 s59, s70
    s_cbranch_scc1 L_b0l
    s_branch L_b0n
L_b0q:
    s_waitcnt lgkmcnt(10)
    v_mfma_f32_16x16x32_bf16 v[160:163], v[224:227], v[16:19], 0
    ds_read_b64_tr_b16 v[252:253], v3 offset:1536
    v_mfma_f32_16x16x32_bf16 v[176:179], v[224:227], v[20:23], 0
    ds_read_b64_tr_b16 v[254:255], v3 offset:1792
    v_mfma_f32_16x16x32_bf16 v[164:167], v[228:231], v[16:19], 0
    ds_read_b64_tr_b16 v[224:225], v2 offset:2048
    v_mfma_f32_16x16x32_bf16 v[180:183], v[228:231], v[20:23], 0
    ds_read_b64_tr_b16 v[226:227], v2 offset:2304
    s_waitcnt lgkmcnt(10)
    v_mfma_f32_16x16x32_bf16 v[168:171], v[232:235], v[16:19], 0
    ds_read_b64_tr_b16 v[228:229], v3 offset:2048
    v_mfma_f32_16x16x32_bf16 v[184:187], v[232:235], v[20:23], 0
    ds_read_b64_tr_b16 v[230:231], v3 offset:2304
    v_mfma_f32_16x16x32_bf16 v[172:175], v[236:239], v[16:19], 0
    ds_read_b64_tr_b16 v[232:233], v2 offset:2560
    v_mfma_f32_16x16x32_bf16 v[188:191], v[236:239], v[20:23], 0
    ds_read_b64_tr_b16 v[234:235], v2 offset:2816
    s_waitcnt lgkmcnt(10)
    v_mfma_f32_16x16x32_bf16 v[160:163], v[240:243], v[24:27], v[160:163]
    ds_read_b64_tr_b16 v[236:237], v3 offset:2560
    v_mfma_f32_16x16x32_bf16 v[176:179], v[240:243], v[28:31], v[176:179]
    ds_read_b64_tr_b16 v[238:239], v3 offset:2816
    v_mfma_f32_16x16x32_bf16 v[164:167], v[244:247], v[24:27], v[164:167]
    ds_read_b64_tr_b16 v[240:241], v2 offset:3072
    v_mfma_f32_16x16x32_bf16 v[180:183], v[244:247], v[28:31], v[180:183]
    ds_read_b64_tr_b16 v[242:243], v2 offset:3328
    s_waitcnt lgkmcnt(10)
    v_mfma_f32_16x16x32_bf16 v[168:171], v[248:251], v[24:27], v[168:171]
    ds_read_b64_tr_b16 v[244:245], v3 offset:3072
    v_mul_f32 v192, v7, v192
    v_mfma_f32_16x16x32_bf16 v[184:187], v[248:251], v[28:31], v[184:187]
    ds_read_b64_tr_b16 v[246:247], v3 offset:3328
    v_mul_f32 v208, v8, v208
    v_mfma_f32_16x16x32_bf16 v[172:175], v[252:255], v[24:27], v[172:175]
    ds_read_b64_tr_b16 v[248:249], v2 offset:3584
    v_mul_f32 v193, v7, v193
    v_mfma_f32_16x16x32_bf16 v[188:191], v[252:255], v[28:31], v[188:191]
    ds_read_b64_tr_b16 v[250:251], v2 offset:3840
    s_waitcnt lgkmcnt(10)
    v_mfma_f32_16x16x32_bf16 v[160:163], v[224:227], v[32:35], v[160:163]
    ds_read_b64_tr_b16 v[252:253], v3 offset:3584
    v_mul_f32 v209, v8, v209
    v_mfma_f32_16x16x32_bf16 v[176:179], v[224:227], v[36:39], v[176:179]
    ds_read_b64_tr_b16 v[254:255], v3 offset:3840
    v_mul_f32 v194, v7, v194
    v_mfma_f32_16x16x32_bf16 v[164:167], v[228:231], v[32:35], v[164:167]
    ds_read_b64_tr_b16 v[224:225], v2 offset:4096
    v_mul_f32 v210, v8, v210
    v_mfma_f32_16x16x32_bf16 v[180:183], v[228:231], v[36:39], v[180:183]
    ds_read_b64_tr_b16 v[226:227], v2 offset:4352
    s_waitcnt lgkmcnt(10)
    v_mfma_f32_16x16x32_bf16 v[168:171], v[232:235], v[32:35], v[168:171]
    ds_read_b64_tr_b16 v[228:229], v3 offset:4096
    v_mul_f32 v195, v7, v195
    v_mfma_f32_16x16x32_bf16 v[184:187], v[232:235], v[36:39], v[184:187]
    ds_read_b64_tr_b16 v[230:231], v3 offset:4352
    v_mul_f32 v211, v8, v211
    v_mfma_f32_16x16x32_bf16 v[172:175], v[236:239], v[32:35], v[172:175]
    ds_read_b64_tr_b16 v[232:233], v2 offset:4608
    v_cvt_pk_bf16_f32 v192, v192, v193
    v_mfma_f32_16x16x32_bf16 v[188:191], v[236:239], v[36:39], v[188:191]
    ds_read_b64_tr_b16 v[234:235], v2 offset:4864
    s_waitcnt lgkmcnt(10)
    v_mfma_f32_16x16x32_bf16 v[160:163], v[240:243], v[40:43], v[160:163]
    ds_read_b64_tr_b16 v[236:237], v3 offset:4608
    v_cvt_pk_bf16_f32 v193, v194, v195
    v_mfma_f32_16x16x32_bf16 v[176:179], v[240:243], v[44:47], v[176:179]
    ds_read_b64_tr_b16 v[238:239], v3 offset:4864
    v_cvt_pk_bf16_f32 v194, v208, v209
    v_mfma_f32_16x16x32_bf16 v[164:167], v[244:247], v[40:43], v[164:167]
    ds_read_b64_tr_b16 v[240:241], v2 offset:5120
    v_cvt_pk_bf16_f32 v195, v210, v211
    v_mfma_f32_16x16x32_bf16 v[180:183], v[244:247], v[44:47], v[180:183]
    ds_read_b64_tr_b16 v[242:243], v2 offset:5376
    s_waitcnt lgkmcnt(10)
    v_mfma_f32_16x16x32_bf16 v[168:171], v[248:251], v[40:43], v[168:171]
    ds_read_b64_tr_b16 v[244:245], v3 offset:5120
    s_nop 1
    v_mfma_f32_16x16x32_bf16 v[184:187], v[248:251], v[44:47], v[184:187]
    ds_read_b64_tr_b16 v[246:247], v3 offset:5376
    v_permlane16_swap_b32 v192, v194
    v_mfma_f32_16x16x32_bf16 v[172:175], v[252:255], v[40:43], v[172:175]
    ds_read_b64_tr_b16 v[248:249], v2 offset:5632
    v_permlane16_swap_b32 v193, v195
    v_mfma_f32_16x16x32_bf16 v[188:191], v[252:255], v[44:47], v[188:191]
    ds_read_b64_tr_b16 v[250:251], v2 offset:5888
    s_waitcnt lgkmcnt(10)
    v_mfma_f32_16x16x32_bf16 v[160:163], v[224:227], v[48:51], v[160:163]
    ds_read_b64_tr_b16 v[252:253], v3 offset:5632
    buffer_store_dwordx4 v[192:195], v6, s[32:35], s61 offen offset:0 sc1
    v_mfma_f32_16x16x32_bf16 v[176:179], v[224:227], v[52:55], v[176:179]
    ds_read_b64_tr_b16 v[254:255], v3 offset:5888
    v_mul_f32 v196, v7, v196
    s_barrier
    v_mfma_f32_16x16x32_bf16 v[164:167], v[228:231], v[48:51], v[164:167]
    ds_read_b64_tr_b16 v[224:225], v2 offset:6144
    v_mul_f32 v212, v8, v212
    v_mfma_f32_16x16x32_bf16 v[180:183], v[228:231], v[52:55], v[180:183]
    ds_read_b64_tr_b16 v[226:227], v2 offset:6400
    s_waitcnt lgkmcnt(10)
    v_mfma_f32_16x16x32_bf16 v[168:171], v[232:235], v[48:51], v[168:171]
    ds_read_b64_tr_b16 v[228:229], v3 offset:6144
    v_mul_f32 v197, v7, v197
    v_mfma_f32_16x16x32_bf16 v[184:187], v[232:235], v[52:55], v[184:187]
    ds_read_b64_tr_b16 v[230:231], v3 offset:6400
    v_mul_f32 v213, v8, v213
    v_mfma_f32_16x16x32_bf16 v[172:175], v[236:239], v[48:51], v[172:175]
    ds_read_b64_tr_b16 v[232:233], v2 offset:6656
    v_mul_f32 v198, v7, v198
    v_mfma_f32_16x16x32_bf16 v[188:191], v[236:239], v[52:55], v[188:191]
    ds_read_b64_tr_b16 v[234:235], v2 offset:6912
    s_waitcnt lgkmcnt(10)
    v_mfma_f32_16x16x32_bf16 v[160:163], v[240:243], v[56:59], v[160:163]
    ds_read_b64_tr_b16 v[236:237], v3 offset:6656
    v_mul_f32 v214, v8, v214
    v_mfma_f32_16x16x32_bf16 v[176:179], v[240:243], v[60:63], v[176:179]
    ds_read_b64_tr_b16 v[238:239], v3 offset:6912
    v_mul_f32 v199, v7, v199
    v_mfma_f32_16x16x32_bf16 v[164:167], v[244:247], v[56:59], v[164:167]
    ds_read_b64_tr_b16 v[240:241], v2 offset:7168
    v_mul_f32 v215, v8, v215
    v_mfma_f32_16x16x32_bf16 v[180:183], v[244:247], v[60:63], v[180:183]
    ds_read_b64_tr_b16 v[242:243], v2 offset:7424
    s_waitcnt lgkmcnt(10)
    v_mfma_f32_16x16x32_bf16 v[168:171], v[248:251], v[56:59], v[168:171]
    ds_read_b64_tr_b16 v[244:245], v3 offset:7168
    v_cvt_pk_bf16_f32 v196, v196, v197
    v_mfma_f32_16x16x32_bf16 v[184:187], v[248:251], v[60:63], v[184:187]
    ds_read_b64_tr_b16 v[246:247], v3 offset:7424
    v_cvt_pk_bf16_f32 v197, v198, v199
    v_mfma_f32_16x16x32_bf16 v[172:175], v[252:255], v[56:59], v[172:175]
    ds_read_b64_tr_b16 v[248:249], v2 offset:7680
    v_cvt_pk_bf16_f32 v198, v212, v213
    v_mfma_f32_16x16x32_bf16 v[188:191], v[252:255], v[60:63], v[188:191]
    ds_read_b64_tr_b16 v[250:251], v2 offset:7936
    s_waitcnt lgkmcnt(10)
    v_mfma_f32_16x16x32_bf16 v[160:163], v[224:227], v[64:67], v[160:163]
    ds_read_b64_tr_b16 v[252:253], v3 offset:7680
    v_cvt_pk_bf16_f32 v199, v214, v215
    v_mfma_f32_16x16x32_bf16 v[176:179], v[224:227], v[68:71], v[176:179]
    ds_read_b64_tr_b16 v[254:255], v3 offset:7936
    s_nop 1
    v_mfma_f32_16x16x32_bf16 v[164:167], v[228:231], v[64:67], v[164:167]
    ds_read_b64_tr_b16 v[224:225], v2 offset:8192
    v_permlane16_swap_b32 v196, v198
    v_mfma_f32_16x16x32_bf16 v[180:183], v[228:231], v[68:71], v[180:183]
    ds_read_b64_tr_b16 v[226:227], v2 offset:8448
    s_waitcnt lgkmcnt(10)
    v_mfma_f32_16x16x32_bf16 v[168:171], v[232:235], v[64:67], v[168:171]
    ds_read_b64_tr_b16 v[228:229], v3 offset:8192
    v_permlane16_swap_b32 v197, v199
    v_mfma_f32_16x16x32_bf16 v[184:187], v[232:235], v[68:71], v[184:187]
    ds_read_b64_tr_b16 v[230:231], v3 offset:8448
    buffer_store_dwordx4 v[196:199], v6, s[32:35], s61 offen offset:1024 sc1
    v_mfma_f32_16x16x32_bf16 v[172:175], v[236:239], v[64:67], v[172:175]
    ds_read_b64_tr_b16 v[232:233], v2 offset:8704
    v_mul_f32 v200, v7, v200
    v_mfma_f32_16x16x32_bf16 v[188:191], v[236:239], v[68:71], v[188:191]
    ds_read_b64_tr_b16 v[234:235], v2 offset:8960
    s_waitcnt lgkmcnt(10)
    v_mfma_f32_16x16x32_bf16 v[160:163], v[240:243], v[72:75], v[160:163]
    ds_read_b64_tr_b16 v[236:237], v3 offset:8704
    v_mul_f32 v216, v8, v216
    v_mfma_f32_16x16x32_bf16 v[176:179], v[240:243], v[76:79], v[176:179]
    ds_read_b64_tr_b16 v[238:239], v3 offset:8960
    v_mul_f32 v201, v7, v201
    v_mfma_f32_16x16x32_bf16 v[164:167], v[244:247], v[72:75], v[164:167]
    ds_read_b64_tr_b16 v[240:241], v2 offset:9216
    v_mul_f32 v217, v8, v217
    v_mfma_f32_16x16x32_bf16 v[180:183], v[244:247], v[76:79], v[180:183]
    ds_read_b64_tr_b16 v[242:243], v2 offset:9472
    s_waitcnt lgkmcnt(10)
    v_mfma_f32_16x16x32_bf16 v[168:171], v[248:251], v[72:75], v[168:171]
    ds_read_b64_tr_b16 v[244:245], v3 offset:9216
    v_mul_f32 v202, v7, v202
    v_mfma_f32_16x16x32_bf16 v[184:187], v[248:251], v[76:79], v[184:187]
    ds_read_b64_tr_b16 v[246:247], v3 offset:9472
    v_mul_f32 v218, v8, v218
    v_mfma_f32_16x16x32_bf16 v[172:175], v[252:255], v[72:75], v[172:175]
    ds_read_b64_tr_b16 v[248:249], v2 offset:9728
    v_mul_f32 v203, v7, v203
    v_mfma_f32_16x16x32_bf16 v[188:191], v[252:255], v[76:79], v[188:191]
    ds_read_b64_tr_b16 v[250:251], v2 offset:9984
    s_waitcnt lgkmcnt(10)
    v_mfma_f32_16x16x32_bf16 v[160:163], v[224:227], v[80:83], v[160:163]
    ds_read_b64_tr_b16 v[252:253], v3 offset:9728
    v_mul_f32 v219, v8, v219
    v_mfma_f32_16x16x32_bf16 v[176:179], v[224:227], v[84:87], v[176:179]
    ds_read_b64_tr_b16 v[254:255], v3 offset:9984
    v_cvt_pk_bf16_f32 v200, v200, v201
    v_mfma_f32_16x16x32_bf16 v[164:167], v[228:231], v[80:83], v[164:167]
    ds_read_b64_tr_b16 v[224:225], v2 offset:10240
    v_cvt_pk_bf16_f32 v201, v202, v203
    v_mfma_f32_16x16x32_bf16 v[180:183], v[228:231], v[84:87], v[180:183]
    ds_read_b64_tr_b16 v[226:227], v2 offset:10496
    s_waitcnt lgkmcnt(10)
    v_mfma_f32_16x16x32_bf16 v[168:171], v[232:235], v[80:83], v[168:171]
    ds_read_b64_tr_b16 v[228:229], v3 offset:10240
    v_cvt_pk_bf16_f32 v202, v216, v217
    v_mfma_f32_16x16x32_bf16 v[184:187], v[232:235], v[84:87], v[184:187]
    ds_read_b64_tr_b16 v[230:231], v3 offset:10496
    v_cvt_pk_bf16_f32 v203, v218, v219
    v_mfma_f32_16x16x32_bf16 v[172:175], v[236:239], v[80:83], v[172:175]
    ds_read_b64_tr_b16 v[232:233], v2 offset:10752
    s_nop 1
    v_mfma_f32_16x16x32_bf16 v[188:191], v[236:239], v[84:87], v[188:191]
    ds_read_b64_tr_b16 v[234:235], v2 offset:11008
    s_waitcnt lgkmcnt(10)
    v_mfma_f32_16x16x32_bf16 v[160:163], v[240:243], v[88:91], v[160:163]
    ds_read_b64_tr_b16 v[236:237], v3 offset:10752
    v_permlane16_swap_b32 v200, v202
    v_mfma_f32_16x16x32_bf16 v[176:179], v[240:243], v[92:95], v[176:179]
    ds_read_b64_tr_b16 v[238:239], v3 offset:11008
    v_permlane16_swap_b32 v201, v203
    v_mfma_f32_16x16x32_bf16 v[164:167], v[244:247], v[88:91], v[164:167]
    ds_read_b64_tr_b16 v[240:241], v2 offset:11264
    buffer_store_dwordx4 v[200:203], v6, s[32:35], s61 offen offset:2048 sc1
    v_mfma_f32_16x16x32_bf16 v[180:183], v[244:247], v[92:95], v[180:183]
    ds_read_b64_tr_b16 v[242:243], v2 offset:11520
    s_waitcnt lgkmcnt(10)
    v_mfma_f32_16x16x32_bf16 v[168:171], v[248:251], v[88:91], v[168:171]
    ds_read_b64_tr_b16 v[244:245], v3 offset:11264
    v_mul_f32 v204, v7, v204
    v_mfma_f32_16x16x32_bf16 v[184:187], v[248:251], v[92:95], v[184:187]
    ds_read_b64_tr_b16 v[246:247], v3 offset:11520
    v_mul_f32 v220, v8, v220
    v_mfma_f32_16x16x32_bf16 v[172:175], v[252:255], v[88:91], v[172:175]
    ds_read_b64_tr_b16 v[248:249], v2 offset:11776
    v_mul_f32 v205, v7, v205
    v_mfma_f32_16x16x32_bf16 v[188:191], v[252:255], v[92:95], v[188:191]
    ds_read_b64_tr_b16 v[250:251], v2 offset:12032
    s_waitcnt lgkmcnt(10)
    v_mfma_f32_16x16x32_bf16 v[160:163], v[224:227], v[96:99], v[160:163]
    ds_read_b64_tr_b16 v[252:253], v3 offset:11776
    v_mul_f32 v221, v8, v221
    v_mfma_f32_16x16x32_bf16 v[176:179], v[224:227], v[100:103], v[176:179]
    ds_read_b64_tr_b16 v[254:255], v3 offset:12032
    v_mul_f32 v206, v7, v206
    s_barrier
    v_mfma_f32_16x16x32_bf16 v[164:167], v[228:231], v[96:99], v[164:167]
    ds_read_b64_tr_b16 v[224:225], v2 offset:12288
    v_mul_f32 v222, v8, v222
    v_mfma_f32_16x16x32_bf16 v[180:183], v[228:231], v[100:103], v[180:183]
    ds_read_b64_tr_b16 v[226:227], v2 offset:12544
    s_waitcnt lgkmcnt(10)
    v_mfma_f32_16x16x32_bf16 v[168:171], v[232:235], v[96:99], v[168:171]
    ds_read_b64_tr_b16 v[228:229], v3 offset:12288
    v_mul_f32 v207, v7, v207
    v_mfma_f32_16x16x32_bf16 v[184:187], v[232:235], v[100:103], v[184:187]
    ds_read_b64_tr_b16 v[230:231], v3 offset:12544
    v_mul_f32 v223, v8, v223
    v_mfma_f32_16x16x32_bf16 v[172:175], v[236:239], v[96:99], v[172:175]
    ds_read_b64_tr_b16 v[232:233], v2 offset:12800
    v_cvt_pk_bf16_f32 v204, v204, v205
    v_mfma_f32_16x16x32_bf16 v[188:191], v[236:239], v[100:103], v[188:191]
    ds_read_b64_tr_b16 v[234:235], v2 offset:13056
    s_waitcnt lgkmcnt(10)
    v_mfma_f32_16x16x32_bf16 v[160:163], v[240:243], v[104:107], v[160:163]
    ds_read_b64_tr_b16 v[236:237], v3 offset:12800
    v_cvt_pk_bf16_f32 v205, v206, v207
    v_mfma_f32_16x16x32_bf16 v[176:179], v[240:243], v[108:111], v[176:179]
    ds_read_b64_tr_b16 v[238:239], v3 offset:13056
    v_cvt_pk_bf16_f32 v206, v220, v221
    v_mfma_f32_16x16x32_bf16 v[164:167], v[244:247], v[104:107], v[164:167]
    ds_read_b64_tr_b16 v[240:241], v2 offset:13312
    v_cvt_pk_bf16_f32 v207, v222, v223
    v_mfma_f32_16x16x32_bf16 v[180:183], v[244:247], v[108:111], v[180:183]
    ds_read_b64_tr_b16 v[242:243], v2 offset:13568
    s_waitcnt lgkmcnt(10)
    v_mfma_f32_16x16x32_bf16 v[168:171], v[248:251], v[104:107], v[168:171]
    ds_read_b64_tr_b16 v[244:245], v3 offset:13312
    s_nop 1
    v_mfma_f32_16x16x32_bf16 v[184:187], v[248:251], v[108:111], v[184:187]
    ds_read_b64_tr_b16 v[246:247], v3 offset:13568
    v_permlane16_swap_b32 v204, v206
    v_mfma_f32_16x16x32_bf16 v[172:175], v[252:255], v[104:107], v[172:175]
    ds_read_b64_tr_b16 v[248:249], v2 offset:13824
    v_permlane16_swap_b32 v205, v207
    v_mfma_f32_16x16x32_bf16 v[188:191], v[252:255], v[108:111], v[188:191]
    ds_read_b64_tr_b16 v[250:251], v2 offset:14080
    s_waitcnt lgkmcnt(10)
    v_mfma_f32_16x16x32_bf16 v[160:163], v[224:227], v[112:115], v[160:163]
    ds_read_b64_tr_b16 v[252:253], v3 offset:13824
    buffer_store_dwordx4 v[204:207], v6, s[32:35], s61 offen offset:3072 sc1
    v_mfma_f32_16x16x32_bf16 v[176:179], v[224:227], v[116:119], v[176:179]
    ds_read_b64_tr_b16 v[254:255], v3 offset:14080
    v_mfma_f32_16x16x32_bf16 v[164:167], v[228:231], v[112:115], v[164:167]
    ds_read_b64_tr_b16 v[224:225], v2 offset:14336
    v_mfma_f32_16x16x32_bf16 v[180:183], v[228:231], v[116:119], v[180:183]
    ds_read_b64_tr_b16 v[226:227], v2 offset:14592
    s_waitcnt lgkmcnt(10)
    v_mfma_f32_16x16x32_bf16 v[168:171], v[232:235], v[112:115], v[168:171]
    ds_read_b64_tr_b16 v[228:229], v3 offset:14336
    v_mfma_f32_16x16x32_bf16 v[184:187], v[232:235], v[116:119], v[184:187]
    ds_read_b64_tr_b16 v[230:231], v3 offset:14592
    v_mfma_f32_16x16x32_bf16 v[172:175], v[236:239], v[112:115], v[172:175]
    ds_read_b64_tr_b16 v[232:233], v2 offset:14848
    v_mfma_f32_16x16x32_bf16 v[188:191], v[236:239], v[116:119], v[188:191]
    ds_read_b64_tr_b16 v[234:235], v2 offset:15104
    s_waitcnt lgkmcnt(10)
    v_mfma_f32_16x16x32_bf16 v[160:163], v[240:243], v[120:123], v[160:163]
    ds_read_b64_tr_b16 v[236:237], v3 offset:14848
    v_mfma_f32_16x16x32_bf16 v[176:179], v[240:243], v[124:127], v[176:179]
    ds_read_b64_tr_b16 v[238:239], v3 offset:15104
    v_mfma_f32_16x16x32_bf16 v[164:167], v[244:247], v[120:123], v[164:167]
    ds_read_b64_tr_b16 v[240:241], v2 offset:15360
    v_mfma_f32_16x16x32_bf16 v[180:183], v[244:247], v[124:127], v[180:183]
    ds_read_b64_tr_b16 v[242:243], v2 offset:15616
    s_waitcnt lgkmcnt(10)
    v_mfma_f32_16x16x32_bf16 v[168:171], v[248:251], v[120:123], v[168:171]
    ds_read_b64_tr_b16 v[244:245], v3 offset:15360
    v_mfma_f32_16x16x32_bf16 v[184:187], v[248:251], v[124:127], v[184:187]
    ds_read_b64_tr_b16 v[246:247], v3 offset:15616
    v_mfma_f32_16x16x32_bf16 v[172:175], v[252:255], v[120:123], v[172:175]
    ds_read_b64_tr_b16 v[248:249], v2 offset:15872
    v_mfma_f32_16x16x32_bf16 v[188:191], v[252:255], v[124:127], v[188:191]
    ds_read_b64_tr_b16 v[250:251], v2 offset:16128
    s_waitcnt lgkmcnt(10)
    v_mfma_f32_16x16x32_bf16 v[160:163], v[224:227], v[128:131], v[160:163]
    ds_read_b64_tr_b16 v[252:253], v3 offset:15872
    v_mfma_f32_16x16x32_bf16 v[176:179], v[224:227], v[132:135], v[176:179]
    ds_read_b64_tr_b16 v[254:255], v3 offset:16128
    v_mfma_f32_16x16x32_bf16 v[164:167], v[228:231], v[128:131], v[164:167]
    ds_read_b64_tr_b16 v[224:225], v2 offset:16384
    v_mfma_f32_16x16x32_bf16 v[180:183], v[228:231], v[132:135], v[180:183]
    ds_read_b64_tr_b16 v[226:227], v2 offset:16640
    s_waitcnt lgkmcnt(10)
    v_mfma_f32_16x16x32_bf16 v[168:171], v[232:235], v[128:131], v[168:171]
    ds_read_b64_tr_b16 v[228:229], v3 offset:16384
    v_mfma_f32_16x16x32_bf16 v[184:187], v[232:235], v[132:135], v[184:187]
    ds_read_b64_tr_b16 v[230:231], v3 offset:16640
    v_mfma_f32_16x16x32_bf16 v[172:175], v[236:239], v[128:131], v[172:175]
    ds_read_b64_tr_b16 v[232:233], v2 offset:16896
    v_mfma_f32_16x16x32_bf16 v[188:191], v[236:239], v[132:135], v[188:191]
    ds_read_b64_tr_b16 v[234:235], v2 offset:17152
    s_waitcnt lgkmcnt(10)
    v_mfma_f32_16x16x32_bf16 v[160:163], v[240:243], v[136:139], v[160:163]
    ds_read_b64_tr_b16 v[236:237], v3 offset:16896
    v_mfma_f32_16x16x32_bf16 v[176:179], v[240:243], v[140:143], v[176:179]
    ds_read_b64_tr_b16 v[238:239], v3 offset:17152
    v_mfma_f32_16x16x32_bf16 v[164:167], v[244:247], v[136:139], v[164:167]
    ds_read_b64_tr_b16 v[240:241], v2 offset:17408
    v_mfma_f32_16x16x32_bf16 v[180:183], v[244:247], v[140:143], v[180:183]
    ds_read_b64_tr_b16 v[242:243], v2 offset:17664
    s_waitcnt lgkmcnt(10)
    v_mfma_f32_16x16x32_bf16 v[168:171], v[248:251], v[136:139], v[168:171]
    ds_read_b64_tr_b16 v[244:245], v3 offset:17408
    v_mfma_f32_16x16x32_bf16 v[184:187], v[248:251], v[140:143], v[184:187]
    ds_read_b64_tr_b16 v[246:247], v3 offset:17664
    v_mfma_f32_16x16x32_bf16 v[172:175], v[252:255], v[136:139], v[172:175]
    ds_read_b64_tr_b16 v[248:249], v2 offset:17920
    v_mfma_f32_16x16x32_bf16 v[188:191], v[252:255], v[140:143], v[188:191]
    ds_read_b64_tr_b16 v[250:251], v2 offset:18176
    s_waitcnt lgkmcnt(10)
    v_mfma_f32_16x16x32_bf16 v[160:163], v[224:227], v[144:147], v[160:163]
    ds_read_b64_tr_b16 v[252:253], v3 offset:17920
    v_mfma_f32_16x16x32_bf16 v[176:179], v[224:227], v[148:151], v[176:179]
    ds_read_b64_tr_b16 v[254:255], v3 offset:18176
    s_barrier
    v_mfma_f32_16x16x32_bf16 v[164:167], v[228:231], v[144:147], v[164:167]
    ds_read_b64_tr_b16 v[224:225], v4 offset:0
    v_mfma_f32_16x16x32_bf16 v[180:183], v[228:231], v[148:151], v[180:183]
    ds_read_b64_tr_b16 v[226:227], v4 offset:256
    s_waitcnt lgkmcnt(10)
    v_mfma_f32_16x16x32_bf16 v[168:171], v[232:235], v[144:147], v[168:171]
    ds_read_b64_tr_b16 v[228:229], v5 offset:0
    v_mfma_f32_16x16x32_bf16 v[184:187], v[232:235], v[148:151], v[184:187]
    ds_read_b64_tr_b16 v[230:231], v5 offset:256
    v_mfma_f32_16x16x32_bf16 v[172:175], v[236:239], v[144:147], v[172:175]
    ds_read_b64_tr_b16 v[232:233], v4 offset:512
    v_mfma_f32_16x16x32_bf16 v[188:191], v[236:239], v[148:151], v[188:191]
    ds_read_b64_tr_b16 v[234:235], v4 offset:768
    s_waitcnt lgkmcnt(10)
    v_mfma_f32_16x16x32_bf16 v[160:163], v[240:243], v[152:155], v[160:163]
    ds_read_b64_tr_b16 v[236:237], v5 offset:512
    v_mfma_f32_16x16x32_bf16 v[176:179], v[240:243], v[156:159], v[176:179]
    ds_read_b64_tr_b16 v[238:239], v5 offset:768
    v_mfma_f32_16x16x32_bf16 v[164:167], v[244:247], v[152:155], v[164:167]
    ds_read_b64_tr_b16 v[240:241], v4 offset:1024
    v_mfma_f32_16x16x32_bf16 v[180:183], v[244:247], v[156:159], v[180:183]
    ds_read_b64_tr_b16 v[242:243], v4 offset:1280
    s_waitcnt lgkmcnt(10)
    v_mfma_f32_16x16x32_bf16 v[168:171], v[248:251], v[152:155], v[168:171]
    ds_read_b64_tr_b16 v[244:245], v5 offset:1024
    v_mfma_f32_16x16x32_bf16 v[184:187], v[248:251], v[156:159], v[184:187]
    ds_read_b64_tr_b16 v[246:247], v5 offset:1280
    v_mfma_f32_16x16x32_bf16 v[172:175], v[252:255], v[152:155], v[172:175]
    ds_read_b64_tr_b16 v[248:249], v4 offset:1536
    v_mfma_f32_16x16x32_bf16 v[188:191], v[252:255], v[156:159], v[188:191]
    ds_read_b64_tr_b16 v[250:251], v4 offset:1792
    s_add_u32 s59, s59, 1
    s_cmp_le_u32 s59, s55
    s_cbranch_scc1 L_wasq0
    s_waitcnt vmcnt(0)
    s_cmp_eq_u32 s59, s70
    s_cbranch_scc1 L_b1l
    s_branch L_b1n
L_b1n:
    s_waitcnt lgkmcnt(10)
    v_mfma_f32_16x16x32_bf16 v[192:195], v[224:227], v[16:19], 0
    ds_read_b64_tr_b16 v[252:253], v5 offset:1536
    v_mfma_f32_16x16x32_bf16 v[208:211], v[224:227], v[20:23], 0
    ds_read_b64_tr_b16 v[254:255], v5 offset:1792
    v_mfma_f32_16x16x32_bf16 v[196:199], v[228:231], v[16:19], 0
    ds_read_b64_tr_b16 v[224:225], v4 offset:2048
    v_mfma_f32_16x16x32_bf16 v[212:215], v[228:231], v[20:23], 0
    ds_read_b64_tr_b16 v[226:227], v4 offset:2304
    s_waitcnt lgkmcnt(10)
    v_mfma_f32_16x16x32_bf16 v[200:203], v[232:235], v[16:19], 0
    ds_read_b64_tr_b16 v[228:229], v5 offset:2048
    v_mfma_f32_16x16x32_bf16 v[216:219], v[232:235], v[20:23], 0
    ds_read_b64_tr_b16 v[230:231], v5 offset:2304
    v_mfma_f32_16x16x32_bf16 v[204:207], v[236:239], v[16:19], 0
    ds_read_b64_tr_b16 v[232:233], v4 offset:2560
    v_mfma_f32_16x16x32_bf16 v[220:223], v[236:239], v[20:23], 0
    ds_read_b64_tr_b16 v[234:235], v4 offset:2816
    s_waitcnt lgkmcnt(10)
    v_mfma_f32_16x16x32_bf16 v[192:195], v[240:243], v[24:27], v[192:195]
    ds_read_b64_tr_b16 v[236:237], v5 offset:2560
    v_mfma_f32_16x16x32_bf16 v[208:211], v[240:243], v[28:31], v[208:211]
    ds_read_b64_tr_b16 v[238:239], v5 offset:2816
    v_mfma_f32_16x16x32_bf16 v[196:199], v[244:247], v[24:27], v[196:199]
    ds_read_b64_tr_b16 v[240:241], v4 offset:3072
    v_mfma_f32_16x16x32_bf16 v[212:215], v[244:247], v[28:31], v[212:215]
    ds_read_b64_tr_b16 v[242:243], v4 offset:3328
    s_waitcnt lgkmcnt(10)
    v_mfma_f32_16x16x32_bf16 v[200:203], v[248:251], v[24:27], v[200:203]
    ds_read_b64_tr_b16 v[244:245], v5 offset:3072
    s_mov_b32 s41, s78
    v_mfma_f32_16x16x32_bf16 v[216:219], v[248:251], v[28:31], v[216:219]
    ds_read_b64_tr_b16 v[246:247], v5 offset:3328
    s_sub_u32 s42, s41, s94
    v_mfma_f32_16x16x32_bf16 v[204:207], v[252:255], v[24:27], v[204:207]
    ds_read_b64_tr_b16 v[248:249], v4 offset:3584
    s_lshl_b32 s43, s53, 1
    v_mfma_f32_16x16x32_bf16 v[220:223], v[252:255], v[28:31], v[220:223]
    ds_read_b64_tr_b16 v[250:251], v4 offset:3840
    s_waitcnt lgkmcnt(10)
    v_mfma_f32_16x16x32_bf16 v[192:195], v[224:227], v[32:35], v[192:195]
    ds_read_b64_tr_b16 v[252:253], v5 offset:3584
    s_add_u32 s43, s43, s42
    v_mfma_f32_16x16x32_bf16 v[208:211], v[224:227], v[36:39], v[208:211]
    ds_read_b64_tr_b16 v[254:255], v5 offset:3840
    s_add_u32 s43, s43, 39
    v_mfma_f32_16x16x32_bf16 v[196:199], v[228:231], v[32:35], v[196:199]
    ds_read_b64_tr_b16 v[224:225], v4 offset:4096
    s_add_u32 s42, s53, 24
    v_mfma_f32_16x16x32_bf16 v[212:215], v[228:231], v[36:39], v[212:215]
    ds_read_b64_tr_b16 v[226:227], v4 offset:4352
    s_waitcnt lgkmcnt(10)
    v_mfma_f32_16x16x32_bf16 v[200:203], v[232:235], v[32:35], v[200:203]
    ds_read_b64_tr_b16 v[228:229], v5 offset:4096
    s_cmp_eq_u32 s41, s94
    v_mfma_f32_16x16x32_bf16 v[216:219], v[232:235], v[36:39], v[216:219]
    ds_read_b64_tr_b16 v[230:231], v5 offset:4352
    s_cselect_b32 s43, s42, s43
    v_mfma_f32_16x16x32_bf16 v[204:207], v[236:239], v[32:35], v[204:207]
    ds_read_b64_tr_b16 v[232:233], v4 offset:4608
    s_add_u32 s42, s41, s58
    v_mfma_f32_16x16x32_bf16 v[220:223], v[236:239], v[36:39], v[220:223]
    ds_read_b64_tr_b16 v[234:235], v4 offset:4864
    s_waitcnt lgkmcnt(10)
    v_mfma_f32_16x16x32_bf16 v[192:195], v[240:243], v[40:43], v[192:195]
    ds_read_b64_tr_b16 v[236:237], v5 offset:4608
    s_cmp_lt_u32 s41, s94
    v_mfma_f32_16x16x32_bf16 v[208:211], v[240:243], v[44:47], v[208:211]
    ds_read_b64_tr_b16 v[238:239], v5 offset:4864
    s_cselect_b32 s41, s42, s43
    v_mfma_f32_16x16x32_bf16 v[196:199], v[244:247], v[40:43], v[196:199]
    ds_read_b64_tr_b16 v[240:241], v4 offset:5120
    s_mul_i32 s41, s41, 10240
    v_mfma_f32_16x16x32_bf16 v[212:215], v[244:247], v[44:47], v[212:215]
    ds_read_b64_tr_b16 v[242:243], v4 offset:5376
    s_waitcnt lgkmcnt(10)
    v_mfma_f32_16x16x32_bf16 v[200:203], v[248:251], v[40:43], v[200:203]
    ds_read_b64_tr_b16 v[244:245], v5 offset:5120
    s_add_u32 s61, s63, s41
    v_mfma_f32_16x16x32_bf16 v[216:219], v[248:251], v[44:47], v[216:219]
    ds_read_b64_tr_b16 v[246:247], v5 offset:5376
    s_add_u32 s62, s64, s41
    v_mfma_f32_16x16x32_bf16 v[204:207], v[252:255], v[40:43], v[204:207]
    ds_read_b64_tr_b16 v[248:249], v4 offset:5632
    v_mul_f32 v160, v9, v160
    v_mfma_f32_16x16x32_bf16 v[220:223], v[252:255], v[44:47], v[220:223]
    ds_read_b64_tr_b16 v[250:251], v4 offset:5888
    s_waitcnt lgkmcnt(10)
    v_mfma_f32_16x16x32_bf16 v[192:195], v[224:227], v[48:51], v[192:195]
    ds_read_b64_tr_b16 v[252:253], v5 offset:5632
    v_mul_f32 v161, v9, v161
    v_mfma_f32_16x16x32_bf16 v[208:211], v[224:227], v[52:55], v[208:211]
    ds_read_b64_tr_b16 v[254:255], v5 offset:5888
    v_mul_f32 v162, v9, v162
    s_barrier
    v_mfma_f32_16x16x32_bf16 v[196:199], v[228:231], v[48:51], v[196:199]
    ds_read_b64_tr_b16 v[224:225], v4 offset:6144
    v_mul_f32 v163, v9, v163
    v_mfma_f32_16x16x32_bf16 v[212:215], v[228:231], v[52:55], v[212:215]
    ds_read_b64_tr_b16 v[226:227], v4 offset:6400
    s_waitcnt lgkmcnt(10)
    v_mfma_f32_16x16x32_bf16 v[200:203], v[232:235], v[48:51], v[200:203]
    ds_read_b64_tr_b16 v[228:229], v5 offset:6144
    v_mul_f32 v164, v9, v164
    v_mfma_f32_16x16x32_bf16 v[216:219], v[232:235], v[52:55], v[216:219]
    ds_read_b64_tr_b16 v[230:231], v5 offset:6400
    v_mul_f32 v165, v9, v165
    v_mfma_f32_16x16x32_bf16 v[204:207], v[236:239], v[48:51], v[204:207]
    ds_read_b64_tr_b16 v[232:233], v4 offset:6656
    v_mul_f32 v166, v9, v166
    v_mfma_f32_16x16x32_bf16 v[220:223], v[236:239], v[52:55], v[220:223]
    ds_read_b64_tr_b16 v[234:235], v4 offset:6912
    s_waitcnt lgkmcnt(10)
    v_mfma_f32_16x16x32_bf16 v[192:195], v[240:243], v[56:59], v[192:195]
    ds_read_b64_tr_b16 v[236:237], v5 offset:6656
    v_mul_f32 v167, v9, v167
    v_mfma_f32_16x16x32_bf16 v[208:211], v[240:243], v[60:63], v[208:211]
    ds_read_b64_tr_b16 v[238:239], v5 offset:6912
    v_mul_f32 v168, v9, v168
    v_mfma_f32_16x16x32_bf16 v[196:199], v[244:247], v[56:59], v[196:199]
    ds_read_b64_tr_b16 v[240:241], v4 offset:7168
    v_mul_f32 v169, v9, v169
    v_mfma_f32_16x16x32_bf16 v[212:215], v[244:247], v[60:63], v[212:215]
    ds_read_b64_tr_b16 v[242:243], v4 offset:7424
    s_waitcnt lgkmcnt(10)
    v_mfma_f32_16x16x32_bf16 v[200:203], v[248:251], v[56:59], v[200:203]
    ds_read_b64_tr_b16 v[244:245], v5 offset:7168
    v_mul_f32 v170, v9, v170
    v_mfma_f32_16x16x32_bf16 v[216:219], v[248:251], v[60:63], v[216:219]
    ds_read_b64_tr_b16 v[246:247], v5 offset:7424
    v_mul_f32 v171, v9, v171
    v_mfma_f32_16x16x32_bf16 v[204:207], v[252:255], v[56:59], v[204:207]
    ds_read_b64_tr_b16 v[248:249], v4 offset:7680
    v_mul_f32 v172, v9, v172
    v_mfma_f32_16x16x32_bf16 v[220:223], v[252:255], v[60:63], v[220:223]
    ds_read_b64_tr_b16 v[250:251], v4 offset:7936
    s_waitcnt lgkmcnt(10)
    v_mfma_f32_16x16x32_bf16 v[192:195], v[224:227], v[64:67], v[192:195]
    ds_read_b64_tr_b16 v[252:253], v5 offset:7680
    v_mul_f32 v173, v9, v173
    v_mfma_f32_16x16x32_bf16 v[208:211], v[224:227], v[68:71], v[208:211]
    ds_read_b64_tr_b16 v[254:255], v5 offset:7936
    v_mul_f32 v174, v9, v174
    v_mfma_f32_16x16x32_bf16 v[196:199], v[228:231], v[64:67], v[196:199]
    ds_read_b64_tr_b16 v[224:225], v4 offset:8192
    v_mul_f32 v175, v9, v175
    v_mfma_f32_16x16x32_bf16 v[212:215], v[228:231], v[68:71], v[212:215]
    ds_read_b64_tr_b16 v[226:227], v4 offset:8448
    s_waitcnt lgkmcnt(10)
    v_mfma_f32_16x16x32_bf16 v[200:203], v[232:235], v[64:67], v[200:203]
    ds_read_b64_tr_b16 v[228:229], v5 offset:8192
    v_mul_f32 v176, v10, v176
    v_mfma_f32_16x16x32_bf16 v[216:219], v[232:235], v[68:71], v[216:219]
    ds_read_b64_tr_b16 v[230:231], v5 offset:8448
    v_mul_f32 v177, v10, v177
    v_mfma_f32_16x16x32_bf16 v[204:207], v[236:239], v[64:67], v[204:207]
    ds_read_b64_tr_b16 v[232:233], v4 offset:8704
    v_mul_f32 v178, v10, v178
    v_mfma_f32_16x16x32_bf16 v[220:223], v[236:239], v[68:71], v[220:223]
    ds_read_b64_tr_b16 v[234:235], v4 offset:8960
    s_waitcnt lgkmcnt(10)
    v_mfma_f32_16x16x32_bf16 v[192:195], v[240:243], v[72:75], v[192:195]
    ds_read_b64_tr_b16 v[236:237], v5 offset:8704
    v_mul_f32 v179, v10, v179
    v_mfma_f32_16x16x32_bf16 v[208:211], v[240:243], v[76:79], v[208:211]
    ds_read_b64_tr_b16 v[238:239], v5 offset:8960
    v_mul_f32 v180, v10, v180
    v_mfma_f32_16x16x32_bf16 v[196:199], v[244:247], v[72:75], v[196:199]
    ds_read_b64_tr_b16 v[240:241], v4 offset:9216
    v_mul_f32 v181, v10, v181
    v_mfma_f32_16x16x32_bf16 v[212:215], v[244:247], v[76:79], v[212:215]
    ds_read_b64_tr_b16 v[242:243], v4 offset:9472
    s_waitcnt lgkmcnt(10)
    v_mfma_f32_16x16x32_bf16 v[200:203], v[248:251], v[72:75], v[200:203]
    ds_read_b64_tr_b16 v[244:245], v5 offset:9216
    v_mul_f32 v182, v10, v182
    v_mfma_f32_16x16x32_bf16 v[216:219], v[248:251], v[76:79], v[216:219]
    ds_read_b64_tr_b16 v[246:247], v5 offset:9472
    v_mul_f32 v183, v10, v183
    v_mfma_f32_16x16x32_bf16 v[204:207], v[252:255], v[72:75], v[204:207]
    ds_read_b64_tr_b16 v[248:249], v4 offset:9728
    v_mul_f32 v184, v10, v184
    v_mfma_f32_16x16x32_bf16 v[220:223], v[252:255], v[76:79], v[220:223]
    ds_read_b64_tr_b16 v[250:251], v4 offset:9984
    s_waitcnt lgkmcnt(10)
    v_mfma_f32_16x16x32_bf16 v[192:195], v[224:227], v[80:83], v[192:195]
    ds_read_b64_tr_b16 v[252:253], v5 offset:9728
    v_mul_f32 v185, v10, v185
    v_mfma_f32_16x16x32_bf16 v[208:211], v[224:227], v[84:87], v[208:211]
    ds_read_b64_tr_b16 v[254:255], v5 offset:9984
    v_mul_f32 v186, v10, v186
    v_mfma_f32_16x16x32_bf16 v[196:199], v[228:231], v[80:83], v[196:199]
    ds_read_b64_tr_b16 v[224:225], v4 offset:10240
    v_mul_f32 v187, v10, v187
    v_mfma_f32_16x16x32_bf16 v[212:215], v[228:231], v[84:87], v[212:215]
    ds_read_b64_tr_b16 v[226:227], v4 offset:10496
    s_waitcnt lgkmcnt(10)
    v_mfma_f32_16x16x32_bf16 v[200:203], v[232:235], v[80:83], v[200:203]
    ds_read_b64_tr_b16 v[228:229], v5 offset:10240
    v_mul_f32 v188, v10, v188
    v_mfma_f32_16x16x32_bf16 v[216:219], v[232:235], v[84:87], v[216:219]
    ds_read_b64_tr_b16 v[230:231], v5 offset:10496
    v_mul_f32 v189, v10, v189
    v_mfma_f32_16x16x32_bf16 v[204:207], v[236:239], v[80:83], v[204:207]
    ds_read_b64_tr_b16 v[232:233], v4 offset:10752
    v_mul_f32 v190, v10, v190
    v_mfma_f32_16x16x32_bf16 v[220:223], v[236:239], v[84:87], v[220:223]
    ds_read_b64_tr_b16 v[234:235], v4 offset:11008
    s_waitcnt lgkmcnt(10)
    v_mfma_f32_16x16x32_bf16 v[192:195], v[240:243], v[88:91], v[192:195]
    ds_read_b64_tr_b16 v[236:237], v5 offset:10752
    v_mul_f32 v191, v10, v191
    v_mfma_f32_16x16x32_bf16 v[208:211], v[240:243], v[92:95], v[208:211]
    ds_read_b64_tr_b16 v[238:239], v5 offset:11008
    v_mfma_f32_16x16x32_bf16 v[196:199], v[244:247], v[88:91], v[196:199]
    ds_read_b64_tr_b16 v[240:241], v4 offset:11264
    v_mfma_f32_16x16x32_bf16 v[212:215], v[244:247], v[92:95], v[212:215]
    ds_read_b64_tr_b16 v[242:243], v4 offset:11520
    s_waitcnt lgkmcnt(10)
    v_mfma_f32_16x16x32_bf16 v[200:203], v[248:251], v[88:91], v[200:203]
    ds_read_b64_tr_b16 v[244:245], v5 offset:11264
    v_mfma_f32_16x16x32_bf16 v[216:219], v[248:251], v[92:95], v[216:219]
    ds_read_b64_tr_b16 v[246:247], v5 offset:11520
    v_mfma_f32_16x16x32_bf16 v[204:207], v[252:255], v[88:91], v[204:207]
    ds_read_b64_tr_b16 v[248:249], v4 offset:11776
    v_mfma_f32_16x16x32_bf16 v[220:223], v[252:255], v[92:95], v[220:223]
    ds_read_b64_tr_b16 v[250:251], v4 offset:12032
    s_waitcnt lgkmcnt(10)
    v_mfma_f32_16x16x32_bf16 v[192:195], v[224:227], v[96:99], v[192:195]
    ds_read_b64_tr_b16 v[252:253], v5 offset:11776
    v_mfma_f32_16x16x32_bf16 v[208:211], v[224:227], v[100:103], v[208:211]
    ds_read_b64_tr_b16 v[254:255], v5 offset:12032
    s_barrier
    v_mfma_f32_16x16x32_bf16 v[196:199], v[228:231], v[96:99], v[196:199]
    ds_read_b64_tr_b16 v[224:225], v4 offset:12288
    v_mfma_f32_16x16x32_bf16 v[212:215], v[228:231], v[100:103], v[212:215]
    ds_read_b64_tr_b16 v[226:227], v4 offset:12544
    s_waitcnt lgkmcnt(10)
    v_mfma_f32_16x16x32_bf16 v[200:203], v[232:235], v[96:99], v[200:203]
    ds_read_b64_tr_b16 v[228:229], v5 offset:12288
    v_mfma_f32_16x16x32_bf16 v[216:219], v[232:235], v[100:103], v[216:219]
    ds_read_b64_tr_b16 v[230:231], v5 offset:12544
    v_mfma_f32_16x16x32_bf16 v[204:207], v[236:239], v[96:99], v[204:207]
    ds_read_b64_tr_b16 v[232:233], v4 offset:12800
    v_mfma_f32_16x16x32_bf16 v[220:223], v[236:239], v[100:103], v[220:223]
    ds_read_b64_tr_b16 v[234:235], v4 offset:13056
    s_waitcnt lgkmcnt(10)
    v_mfma_f32_16x16x32_bf16 v[192:195], v[240:243], v[104:107], v[192:195]
    ds_read_b64_tr_b16 v[236:237], v5 offset:12800
    v_mfma_f32_16x16x32_bf16 v[208:211], v[240:243], v[108:111], v[208:211]
    ds_read_b64_tr_b16 v[238:239], v5 offset:13056
    v_mfma_f32_16x16x32_bf16 v[196:199], v[244:247], v[104:107], v[196:199]
    ds_read_b64_tr_b16 v[240:241], v4 offset:13312
    v_mfma_f32_16x16x32_bf16 v[212:215], v[244:247], v[108:111], v[212:215]
    ds_read_b64_tr_b16 v[242:243], v4 offset:13568
    s_waitcnt lgkmcnt(10)
    v_mfma_f32_16x16x32_bf16 v[200:203], v[248:251], v[104:107], v[200:203]
    ds_read_b64_tr_b16 v[244:245], v5 offset:13312
    v_mfma_f32_16x16x32_bf16 v[216:219], v[248:251], v[108:111], v[216:219]
    ds_read_b64_tr_b16 v[246:247], v5 offset:13568
    v_mfma_f32_16x16x32_bf16 v[204:207], v[252:255], v[104:107], v[204:207]
    ds_read_b64_tr_b16 v[248:249], v4 offset:13824
    v_mfma_f32_16x16x32_bf16 v[220:223], v[252:255], v[108:111], v[220:223]
    ds_read_b64_tr_b16 v[250:251], v4 offset:14080
    s_waitcnt lgkmcnt(10)
    v_mfma_f32_16x16x32_bf16 v[192:195], v[224:227], v[112:115], v[192:195]
    ds_read_b64_tr_b16 v[252:253], v5 offset:13824
    v_mfma_f32_16x16x32_bf16 v[208:211], v[224:227], v[116:119], v[208:211]
    ds_read_b64_tr_b16 v[254:255], v5 offset:14080
    v_mfma_f32_16x16x32_bf16 v[196:199], v[228:231], v[112:115], v[196:199]
    ds_read_b64_tr_b16 v[224:225], v4 offset:14336
    v_mfma_f32_16x16x32_bf16 v[212:215], v[228:231], v[116:119], v[212:215]
    ds_read_b64_tr_b16 v[226:227], v4 offset:14592
    s_waitcnt lgkmcnt(10)
    v_mfma_f32_16x16x32_bf16 v[200:203], v[232:235], v[112:115], v[200:203]
    ds_read_b64_tr_b16 v[228:229], v5 offset:14336
    v_mfma_f32_16x16x32_bf16 v[216:219], v[232:235], v[116:119], v[216:219]
    ds_read_b64_tr_b16 v[230:231], v5 offset:14592
    v_mfma_f32_16x16x32_bf16 v[204:207], v[236:239], v[112:115], v[204:207]
    ds_read_b64_tr_b16 v[232:233], v4 offset:14848
    v_mfma_f32_16x16x32_bf16 v[220:223], v[236:239], v[116:119], v[220:223]
    ds_read_b64_tr_b16 v[234:235], v4 offset:15104
    s_waitcnt lgkmcnt(10)
    v_mfma_f32_16x16x32_bf16 v[192:195], v[240:243], v[120:123], v[192:195]
    ds_read_b64_tr_b16 v[236:237], v5 offset:14848
    v_mfma_f32_16x16x32_bf16 v[208:211], v[240:243], v[124:127], v[208:211]
    ds_read_b64_tr_b16 v[238:239], v5 offset:15104
    v_mfma_f32_16x16x32_bf16 v[196:199], v[244:247], v[120:123], v[196:199]
    ds_read_b64_tr_b16 v[240:241], v4 offset:15360
    v_mfma_f32_16x16x32_bf16 v[212:215], v[244:247], v[124:127], v[212:215]
    ds_read_b64_tr_b16 v[242:243], v4 offset:15616
    s_waitcnt lgkmcnt(10)
    v_mfma_f32_16x16x32_bf16 v[200:203], v[248:251], v[120:123], v[200:203]
    ds_read_b64_tr_b16 v[244:245], v5 offset:15360
    v_mfma_f32_16x16x32_bf16 v[216:219], v[248:251], v[124:127], v[216:219]
    ds_read_b64_tr_b16 v[246:247], v5 offset:15616
    v_mfma_f32_16x16x32_bf16 v[204:207], v[252:255], v[120:123], v[204:207]
    ds_read_b64_tr_b16 v[248:249], v4 offset:15872
    v_mfma_f32_16x16x32_bf16 v[220:223], v[252:255], v[124:127], v[220:223]
    ds_read_b64_tr_b16 v[250:251], v4 offset:16128
    s_waitcnt lgkmcnt(10)
    v_mfma_f32_16x16x32_bf16 v[192:195], v[224:227], v[128:131], v[192:195]
    ds_read_b64_tr_b16 v[252:253], v5 offset:15872
    v_mfma_f32_16x16x32_bf16 v[208:211], v[224:227], v[132:135], v[208:211]
    ds_read_b64_tr_b16 v[254:255], v5 offset:16128
    v_mfma_f32_16x16x32_bf16 v[196:199], v[228:231], v[128:131], v[196:199]
    ds_read_b64_tr_b16 v[224:225], v4 offset:16384
    v_mfma_f32_16x16x32_bf16 v[212:215], v[228:231], v[132:135], v[212:215]
    ds_read_b64_tr_b16 v[226:227], v4 offset:16640
    s_waitcnt lgkmcnt(10)
    v_mfma_f32_16x16x32_bf16 v[200:203], v[232:235], v[128:131], v[200:203]
    ds_read_b64_tr_b16 v[228:229], v5 offset:16384
    v_mfma_f32_16x16x32_bf16 v[216:219], v[232:235], v[132:135], v[216:219]
    ds_read_b64_tr_b16 v[230:231], v5 offset:16640
    v_mfma_f32_16x16x32_bf16 v[204:207], v[236:239], v[128:131], v[204:207]
    ds_read_b64_tr_b16 v[232:233], v4 offset:16896
    v_mfma_f32_16x16x32_bf16 v[220:223], v[236:239], v[132:135], v[220:223]
    ds_read_b64_tr_b16 v[234:235], v4 offset:17152
    s_waitcnt lgkmcnt(10)
    v_mfma_f32_16x16x32_bf16 v[192:195], v[240:243], v[136:139], v[192:195]
    ds_read_b64_tr_b16 v[236:237], v5 offset:16896
    v_mfma_f32_16x16x32_bf16 v[208:211], v[240:243], v[140:143], v[208:211]
    ds_read_b64_tr_b16 v[238:239], v5 offset:17152
    v_mfma_f32_16x16x32_bf16 v[196:199], v[244:247], v[136:139], v[196:199]
    ds_read_b64_tr_b16 v[240:241], v4 offset:17408
    v_mfma_f32_16x16x32_bf16 v[212:215], v[244:247], v[140:143], v[212:215]
    ds_read_b64_tr_b16 v[242:243], v4 offset:17664
    s_waitcnt lgkmcnt(10)
    v_mfma_f32_16x16x32_bf16 v[200:203], v[248:251], v[136:139], v[200:203]
    ds_read_b64_tr_b16 v[244:245], v5 offset:17408
    v_mfma_f32_16x16x32_bf16 v[216:219], v[248:251], v[140:143], v[216:219]
    ds_read_b64_tr_b16 v[246:247], v5 offset:17664
    v_mfma_f32_16x16x32_bf16 v[204:207], v[252:255], v[136:139], v[204:207]
    ds_read_b64_tr_b16 v[248:249], v4 offset:17920
    v_mfma_f32_16x16x32_bf16 v[220:223], v[252:255], v[140:143], v[220:223]
    ds_read_b64_tr_b16 v[250:251], v4 offset:18176
    s_waitcnt lgkmcnt(10)
    v_mfma_f32_16x16x32_bf16 v[192:195], v[224:227], v[144:147], v[192:195]
    ds_read_b64_tr_b16 v[252:253], v5 offset:17920
    v_mfma_f32_16x16x32_bf16 v[208:211], v[224:227], v[148:151], v[208:211]
    ds_read_b64_tr_b16 v[254:255], v5 offset:18176
    s_barrier
    v_mfma_f32_16x16x32_bf16 v[196:199], v[228:231], v[144:147], v[196:199]
    ds_read_b64_tr_b16 v[224:225], v2 offset:0
    v_mfma_f32_16x16x32_bf16 v[212:215], v[228:231], v[148:151], v[212:215]
    ds_read_b64_tr_b16 v[226:227], v2 offset:256
    s_waitcnt lgkmcnt(10)
    v_mfma_f32_16x16x32_bf16 v[200:203], v[232:235], v[144:147], v[200:203]
    ds_read_b64_tr_b16 v[228:229], v3 offset:0
    v_mfma_f32_16x16x32_bf16 v[216:219], v[232:235], v[148:151], v[216:219]
    ds_read_b64_tr_b16 v[230:231], v3 offset:256
    v_mfma_f32_16x16x32_bf16 v[204:207], v[236:239], v[144:147], v[204:207]
    ds_read_b64_tr_b16 v[232:233], v2 offset:512
    v_mfma_f32_16x16x32_bf16 v[220:223], v[236:239], v[148:151], v[220:223]
    ds_read_b64_tr_b16 v[234:235], v2 offset:768
    s_waitcnt lgkmcnt(10)
    v_mfma_f32_16x16x32_bf16 v[192:195], v[240:243], v[152:155], v[192:195]
    ds_read_b64_tr_b16 v[236:237], v3 offset:512
    v_mfma_f32_16x16x32_bf16 v[208:211], v[240:243], v[156:159], v[208:211]
    ds_read_b64_tr_b16 v[238:239], v3 offset:768
    v_mfma_f32_16x16x32_bf16 v[196:199], v[244:247], v[152:155], v[196:199]
    ds_read_b64_tr_b16 v[240:241], v2 offset:1024
    v_mfma_f32_16x16x32_bf16 v[212:215], v[244:247], v[156:159], v[212:215]
    ds_read_b64_tr_b16 v[242:243], v2 offset:1280
    s_waitcnt lgkmcnt(10)
    v_mfma_f32_16x16x32_bf16 v[200:203], v[248:251], v[152:155], v[200:203]
    ds_read_b64_tr_b16 v[244:245], v3 offset:1024
    v_mfma_f32_16x16x32_bf16 v[216:219], v[248:251], v[156:159], v[216:219]
    ds_read_b64_tr_b16 v[246:247], v3 offset:1280
    v_mfma_f32_16x16x32_bf16 v[204:207], v[252:255], v[152:155], v[204:207]
    ds_read_b64_tr_b16 v[248:249], v2 offset:1536
    v_mfma_f32_16x16x32_bf16 v[220:223], v[252:255], v[156:159], v[220:223]
    ds_read_b64_tr_b16 v[250:251], v2 offset:1792
    s_add_u32 s59, s59, 1
    s_cmp_le_u32 s59, s55
    s_cbranch_scc1 L_wasq1
    s_waitcnt vmcnt(0)
    s_add_u32 s78, s78, 1
L_b0u:
    s_waitcnt lgkmcnt(10)
    v_pk_mul_f32 v[192:193], v[160:161], v[192:193]
    v_pk_mul_f32 v[194:195], v[162:163], v[194:195]
    v_mfma_f32_16x16x32_bf16 v[160:163], v[224:227], v[16:19], 0
    ds_read_b64_tr_b16 v[252:253], v3 offset:1536
    v_pk_mul_f32 v[208:209], v[176:177], v[208:209]
    v_pk_mul_f32 v[210:211], v[178:179], v[210:211]
    v_mfma_f32_16x16x32_bf16 v[176:179], v[224:227], v[20:23], 0
    ds_read_b64_tr_b16 v[254:255], v3 offset:1792
    v_pk_mul_f32 v[196:197], v[164:165], v[196:197]
    v_pk_mul_f32 v[198:199], v[166:167], v[198:199]
    v_mfma_f32_16x16x32_bf16 v[164:167], v[228:231], v[16:19], 0
    ds_read_b64_tr_b16 v[224:225], v2 offset:2048
    v_pk_mul_f32 v[212:213], v[180:181], v[212:213]
    v_pk_mul_f32 v[214:215], v[182:183], v[214:215]
    v_mfma_f32_16x16x32_bf16 v[180:183], v[228:231], v[20:23], 0
    ds_read_b64_tr_b16 v[226:227], v2 offset:2304
    s_waitcnt lgkmcnt(10)
    v_pk_mul_f32 v[200:201], v[168:169], v[200:201]
    v_pk_mul_f32 v[202:203], v[170:171], v[202:203]
    v_mfma_f32_16x16x32_bf16 v[168:171], v[232:235], v[16:19], 0
    ds_read_b64_tr_b16 v[228:229], v3 offset:2048
    v_pk_mul_f32 v[216:217], v[184:185], v[216:217]
    v_pk_mul_f32 v[218:219], v[186:187], v[218:219]
    v_mfma_f32_16x16x32_bf16 v[184:187], v[232:235], v[20:23], 0
    ds_read_b64_tr_b16 v[230:231], v3 offset:2304
    v_pk_mul_f32 v[204:205], v[172:173], v[204:205]
    v_pk_mul_f32 v[206:207], v[174:175], v[206:207]
    v_mfma_f32_16x16x32_bf16 v[172:175], v[236:239], v[16:19], 0
    ds_read_b64_tr_b16 v[232:233], v2 offset:2560
    v_pk_mul_f32 v[220:221], v[188:189], v[220:221]
    v_pk_mul_f32 v[222:223], v[190:191], v[222:223]
    v_mfma_f32_16x16x32_bf16 v[188:191], v[236:239], v[20:23], 0
    ds_read_b64_tr_b16 v[234:235], v2 offset:2816
    s_waitcnt lgkmcnt(10)
    v_mfma_f32_16x16x32_bf16 v[160:163], v[240:243], v[24:27], v[160:163]
    ds_read_b64_tr_b16 v[236:237], v3 offset:2560
    v_mfma_f32_16x16x32_bf16 v[176:179], v[240:243], v[28:31], v[176:179]
    ds_read_b64_tr_b16 v[238:239], v3 offset:2816
    v_mfma_f32_16x16x32_bf16 v[164:167], v[244:247], v[24:27], v[164:167]
    ds_read_b64_tr_b16 v[240:241], v2 offset:3072
    v_mfma_f32_16x16x32_bf16 v[180:183], v[244:247], v[28:31], v[180:183]
    ds_read_b64_tr_b16 v[242:243], v2 offset:3328
    s_waitcnt lgkmcnt(10)
    v_mfma_f32_16x16x32_bf16 v[168:171], v[248:251], v[24:27], v[168:171]
    ds_read_b64_tr_b16 v[244:245], v3 offset:3072
    v_cvt_pk_bf16_f32 v192, v192, v193
    v_mfma_f32_16x16x32_bf16 v[184:187], v[248:251], v[28:31], v[184:187]
    ds_read_b64_tr_b16 v[246:247], v3 offset:3328
    v_cvt_pk_bf16_f32 v193, v194, v195
    v_mfma_f32_16x16x32_bf16 v[172:175], v[252:255], v[24:27], v[172:175]
    ds_read_b64_tr_b16 v[248:249], v2 offset:3584
    v_cvt_pk_bf16_f32 v194, v196, v197
    v_mfma_f32_16x16x32_bf16 v[188:191], v[252:255], v[28:31], v[188:191]
    ds_read_b64_tr_b16 v[250:251], v2 offset:3840
    s_waitcnt lgkmcnt(10)
    v_mfma_f32_16x16x32_bf16 v[160:163], v[224:227], v[32:35], v[160:163]
    ds_read_b64_tr_b16 v[252:253], v3 offset:3584
    v_cvt_pk_bf16_f32 v195, v198, v199
    v_mfma_f32_16x16x32_bf16 v[176:179], v[224:227], v[36:39], v[176:179]
    ds_read_b64_tr_b16 v[254:255], v3 offset:3840
    buffer_store_dwordx4 v[192:195], v6, s[32:35], s61 offen sc1
    v_mfma_f32_16x16x32_bf16 v[164:167], v[228:231], v[32:35], v[164:167]
    ds_read_b64_tr_b16 v[224:225], v2 offset:4096
    v_cvt_pk_bf16_f32 v200, v200, v201
    v_mfma_f32_16x16x32_bf16 v[180:183], v[228:231], v[36:39], v[180:183]
    ds_read_b64_tr_b16 v[226:227], v2 offset:4352
    s_waitcnt lgkmcnt(10)
    v_mfma_f32_16x16x32_bf16 v[168:171], v[232:235], v[32:35], v[168:171]
    ds_read_b64_tr_b16 v[228:229], v3 offset:4096
    v_cvt_pk_bf16_f32 v201, v202, v203
    v_mfma_f32_16x16x32_bf16 v[184:187], v[232:235], v[36:39], v[184:187]
    ds_read_b64_tr_b16 v[230:231], v3 offset:4352
    v_cvt_pk_bf16_f32 v202, v204, v205
    v_mfma_f32_16x16x32_bf16 v[172:175], v[236:239], v[32:35], v[172:175]
    ds_read_b64_tr_b16 v[232:233], v2 offset:4608
    v_cvt_pk_bf16_f32 v203, v206, v207
    v_mfma_f32_16x16x32_bf16 v[188:191], v[236:239], v[36:39], v[188:191]
    ds_read_b64_tr_b16 v[234:235], v2 offset:4864
    s_waitcnt lgkmcnt(10)
    v_mfma_f32_16x16x32_bf16 v[160:163], v[240:243], v[40:43], v[160:163]
    ds_read_b64_tr_b16 v[236:237], v3 offset:4608
    s_add_u32 s66, s61, 5120
    v_mfma_f32_16x16x32_bf16 v[176:179], v[240:243], v[44:47], v[176:179]
    ds_read_b64_tr_b16 v[238:239], v3 offset:4864
    buffer_store_dwordx4 v[200:203], v6, s[32:35], s66 offen sc1
    v_mfma_f32_16x16x32_bf16 v[164:167], v[244:247], v[40:43], v[164:167]
    ds_read_b64_tr_b16 v[240:241], v2 offset:5120
    v_cvt_pk_bf16_f32 v208, v208, v209
    v_mfma_f32_16x16x32_bf16 v[180:183], v[244:247], v[44:47], v[180:183]
    ds_read_b64_tr_b16 v[242:243], v2 offset:5376
    s_waitcnt lgkmcnt(10)
    v_mfma_f32_16x16x32_bf16 v[168:171], v[248:251], v[40:43], v[168:171]
    ds_read_b64_tr_b16 v[244:245], v3 offset:5120
    v_cvt_pk_bf16_f32 v209, v210, v211
    v_mfma_f32_16x16x32_bf16 v[184:187], v[248:251], v[44:47], v[184:187]
    ds_read_b64_tr_b16 v[246:247], v3 offset:5376
    v_cvt_pk_bf16_f32 v210, v212, v213
    v_mfma_f32_16x16x32_bf16 v[172:175], v[252:255], v[40:43], v[172:175]
    ds_read_b64_tr_b16 v[248:249], v2 offset:5632
    v_cvt_pk_bf16_f32 v211, v214, v215
    v_mfma_f32_16x16x32_bf16 v[188:191], v[252:255], v[44:47], v[188:191]
    ds_read_b64_tr_b16 v[250:251], v2 offset:5888
    s_waitcnt lgkmcnt(10)
    v_mfma_f32_16x16x32_bf16 v[160:163], v[224:227], v[48:51], v[160:163]
    ds_read_b64_tr_b16 v[252:253], v3 offset:5632
    buffer_store_dwordx4 v[208:211], v6, s[32:35], s62 offen sc1
    v_mfma_f32_16x16x32_bf16 v[176:179], v[224:227], v[52:55], v[176:179]
    ds_read_b64_tr_b16 v[254:255], v3 offset:5888
    v_cvt_pk_bf16_f32 v216, v216, v217
    s_barrier
    v_mfma_f32_16x16x32_bf16 v[164:167], v[228:231], v[48:51], v[164:167]
    ds_read_b64_tr_b16 v[224:225], v2 offset:6144
    v_cvt_pk_bf16_f32 v217, v218, v219
    v_mfma_f32_16x16x32_bf16 v[180:183], v[228:231], v[52:55], v[180:183]
    ds_read_b64_tr_b16 v[226:227], v2 offset:6400
    s_waitcnt lgkmcnt(10)
    v_mfma_f32_16x16x32_bf16 v[168:171], v[232:235], v[48:51], v[168:171]
    ds_read_b64_tr_b16 v[228:229], v3 offset:6144
    v_cvt_pk_bf16_f32 v218, v220, v221
    v_mfma_f32_16x16x32_bf16 v[184:187], v[232:235], v[52:55], v[184:187]
    ds_read_b64_tr_b16 v[230:231], v3 offset:6400
    v_cvt_pk_bf16_f32 v219, v222, v223
    v_mfma_f32_16x16x32_bf16 v[172:175], v[236:239], v[48:51], v[172:175]
    ds_read_b64_tr_b16 v[232:233], v2 offset:6656
    s_add_u32 s66, s62, 5120
    v_mfma_f32_16x16x32_bf16 v[188:191], v[236:239], v[52:55], v[188:191]
    ds_read_b64_tr_b16 v[234:235], v2 offset:6912
    s_waitcnt lgkmcnt(10)
    v_mfma_f32_16x16x32_bf16 v[160:163], v[240:243], v[56:59], v[160:163]
    ds_read_b64_tr_b16 v[236:237], v3 offset:6656
    buffer_store_dwordx4 v[216:219], v6, s[32:35], s66 offen sc1
    v_mfma_f32_16x16x32_bf16 v[176:179], v[240:243], v[60:63], v[176:179]
    ds_read_b64_tr_b16 v[238:239], v3 offset:6912
    v_mfma_f32_16x16x32_bf16 v[164:167], v[244:247], v[56:59], v[164:167]
    ds_read_b64_tr_b16 v[240:241], v2 offset:7168
    v_mfma_f32_16x16x32_bf16 v[180:183], v[244:247], v[60:63], v[180:183]
    ds_read_b64_tr_b16 v[242:243], v2 offset:7424
    s_waitcnt lgkmcnt(10)
    v_mfma_f32_16x16x32_bf16 v[168:171], v[248:251], v[56:59], v[168:171]
    ds_read_b64_tr_b16 v[244:245], v3 offset:7168
    v_mfma_f32_16x16x32_bf16 v[184:187], v[248:251], v[60:63], v[184:187]
    ds_read_b64_tr_b16 v[246:247], v3 offset:7424
    v_mfma_f32_16x16x32_bf16 v[172:175], v[252:255], v[56:59], v[172:175]
    ds_read_b64_tr_b16 v[248:249], v2 offset:7680
    v_mfma_f32_16x16x32_bf16 v[188:191], v[252:255], v[60:63], v[188:191]
    ds_read_b64_tr_b16 v[250:251], v2 offset:7936
    s_waitcnt lgkmcnt(10)
    v_mfma_f32_16x16x32_bf16 v[160:163], v[224:227], v[64:67], v[160:163]
    ds_read_b64_tr_b16 v[252:253], v3 offset:7680
    v_mfma_f32_16x16x32_bf16 v[176:179], v[224:227], v[68:71], v[176:179]
    ds_read_b64_tr_b16 v[254:255], v3 offset:7936
    v_mfma_f32_16x16x32_bf16 v[164:167], v[228:231], v[64:67], v[164:167]
    ds_read_b64_tr_b16 v[224:225], v2 offset:8192
    v_mfma_f32_16x16x32_bf16 v[180:183], v[228:231], v[68:71], v[180:183]
    ds_read_b64_tr_b16 v[226:227], v2 offset:8448
    s_waitcnt lgkmcnt(10)
    v_mfma_f32_16x16x32_bf16 v[168:171], v[232:235], v[64:67], v[168:171]
    ds_read_b64_tr_b16 v[228:229], v3 offset:8192
    v_mfma_f32_16x16x32_bf16 v[184:187], v[232:235], v[68:71], v[184:187]
    ds_read_b64_tr_b16 v[230:231], v3 offset:8448
    v_mfma_f32_16x16x32_bf16 v[172:175], v[236:239], v[64:67], v[172:175]
    ds_read_b64_tr_b16 v[232:233], v2 offset:8704
    v_mfma_f32_16x16x32_bf16 v[188:191], v[236:239], v[68:71], v[188:191]
    ds_read_b64_tr_b16 v[234:235], v2 offset:8960
    s_waitcnt lgkmcnt(10)
    v_mfma_f32_16x16x32_bf16 v[160:163], v[240:243], v[72:75], v[160:163]
    ds_read_b64_tr_b16 v[236:237], v3 offset:8704
    v_mfma_f32_16x16x32_bf16 v[176:179], v[240:243], v[76:79], v[176:179]
    ds_read_b64_tr_b16 v[238:239], v3 offset:8960
    v_mfma_f32_16x16x32_bf16 v[164:167], v[244:247], v[72:75], v[164:167]
    ds_read_b64_tr_b16 v[240:241], v2 offset:9216
    v_mfma_f32_16x16x32_bf16 v[180:183], v[244:247], v[76:79], v[180:183]
    ds_read_b64_tr_b16 v[242:243], v2 offset:9472
    s_waitcnt lgkmcnt(10)
    v_mfma_f32_16x16x32_bf16 v[168:171], v[248:251], v[72:75], v[168:171]
    ds_read_b64_tr_b16 v[244:245], v3 offset:9216
    v_mfma_f32_16x16x32_bf16 v[184:187], v[248:251], v[76:79], v[184:187]
    ds_read_b64_tr_b16 v[246:247], v3 offset:9472
    v_mfma_f32_16x16x32_bf16 v[172:175], v[252:255], v[72:75], v[172:175]
    ds_read_b64_tr_b16 v[248:249], v2 offset:9728
    v_mfma_f32_16x16x32_bf16 v[188:191], v[252:255], v[76:79], v[188:191]
    ds_read_b64_tr_b16 v[250:251], v2 offset:9984
    s_waitcnt lgkmcnt(10)
    v_mfma_f32_16x16x32_bf16 v[160:163], v[224:227], v[80:83], v[160:163]
    ds_read_b64_tr_b16 v[252:253], v3 offset:9728
    v_mfma_f32_16x16x32_bf16 v[176:179], v[224:227], v[84:87], v[176:179]
    ds_read_b64_tr_b16 v[254:255], v3 offset:9984
    v_mfma_f32_16x16x32_bf16 v[164:167], v[228:231], v[80:83], v[164:167]
    ds_read_b64_tr_b16 v[224:225], v2 offset:10240
    v_mfma_f32_16x16x32_bf16 v[180:183], v[228:231], v[84:87], v[180:183]
    ds_read_b64_tr_b16 v[226:227], v2 offset:10496
    s_waitcnt lgkmcnt(10)
    v_mfma_f32_16x16x32_bf16 v[168:171], v[232:235], v[80:83], v[168:171]
    ds_read_b64_tr_b16 v[228:229], v3 offset:10240
    v_mfma_f32_16x16x32_bf16 v[184:187], v[232:235], v[84:87], v[184:187]
    ds_read_b64_tr_b16 v[230:231], v3 offset:10496
    v_mfma_f32_16x16x32_bf16 v[172:175], v[236:239], v[80:83], v[172:175]
    ds_read_b64_tr_b16 v[232:233], v2 offset:10752
    v_mfma_f32_16x16x32_bf16 v[188:191], v[236:239], v[84:87], v[188:191]
    ds_read_b64_tr_b16 v[234:235], v2 offset:11008
    s_waitcnt lgkmcnt(10)
    v_mfma_f32_16x16x32_bf16 v[160:163], v[240:243], v[88:91], v[160:163]
    ds_read_b64_tr_b16 v[236:237], v3 offset:10752
    v_mfma_f32_16x16x32_bf16 v[176:179], v[240:243], v[92:95], v[176:179]
    ds_read_b64_tr_b16 v[238:239], v3 offset:11008
    v_mfma_f32_16x16x32_bf16 v[164:167], v[244:247], v[88:91], v[164:167]
    ds_read_b64_tr_b16 v[240:241], v2 offset:11264
    v_mfma_f32_16x16x32_bf16 v[180:183], v[244:247], v[92:95], v[180:183]
    ds_read_b64_tr_b16 v[242:243], v2 offset:11520
    s_waitcnt lgkmcnt(10)
    v_mfma_f32_16x16x32_bf16 v[168:171], v[248:251], v[88:91], v[168:171]
    ds_read_b64_tr_b16 v[244:245], v3 offset:11264
    v_mfma_f32_16x16x32_bf16 v[184:187], v[248:251], v[92:95], v[184:187]
    ds_read_b64_tr_b16 v[246:247], v3 offset:11520
    v_mfma_f32_16x16x32_bf16 v[172:175], v[252:255], v[88:91], v[172:175]
    ds_read_b64_tr_b16 v[248:249], v2 offset:11776
    v_mfma_f32_16x16x32_bf16 v[188:191], v[252:255], v[92:95], v[188:191]
    ds_read_b64_tr_b16 v[250:251], v2 offset:12032
    s_waitcnt lgkmcnt(10)
    v_mfma_f32_16x16x32_bf16 v[160:163], v[224:227], v[96:99], v[160:163]
    ds_read_b64_tr_b16 v[252:253], v3 offset:11776
    v_mfma_f32_16x16x32_bf16 v[176:179], v[224:227], v[100:103], v[176:179]
    ds_read_b64_tr_b16 v[254:255], v3 offset:12032
    s_barrier
    v_mfma_f32_16x16x32_bf16 v[164:167], v[228:231], v[96:99], v[164:167]
    ds_read_b64_tr_b16 v[224:225], v2 offset:12288
    v_mfma_f32_16x16x32_bf16 v[180:183], v[228:231], v[100:103], v[180:183]
    ds_read_b64_tr_b16 v[226:227], v2 offset:12544
    s_waitcnt lgkmcnt(10)
    v_mfma_f32_16x16x32_bf16 v[168:171], v[232:235], v[96:99], v[168:171]
    ds_read_b64_tr_b16 v[228:229], v3 offset:12288
    v_mfma_f32_16x16x32_bf16 v[184:187], v[232:235], v[100:103], v[184:187]
    ds_read_b64_tr_b16 v[230:231], v3 offset:12544
    v_mfma_f32_16x16x32_bf16 v[172:175], v[236:239], v[96:99], v[172:175]
    ds_read_b64_tr_b16 v[232:233], v2 offset:12800
    v_mfma_f32_16x16x32_bf16 v[188:191], v[236:239], v[100:103], v[188:191]
    ds_read_b64_tr_b16 v[234:235], v2 offset:13056
    s_waitcnt lgkmcnt(10)
    v_mfma_f32_16x16x32_bf16 v[160:163], v[240:243], v[104:107], v[160:163]
    ds_read_b64_tr_b16 v[236:237], v3 offset:12800
    v_mfma_f32_16x16x32_bf16 v[176:179], v[240:243], v[108:111], v[176:179]
    ds_read_b64_tr_b16 v[238:239], v3 offset:13056
    v_mfma_f32_16x16x32_bf16 v[164:167], v[244:247], v[104:107], v[164:167]
    ds_read_b64_tr_b16 v[240:241], v2 offset:13312
    v_mfma_f32_16x16x32_bf16 v[180:183], v[244:247], v[108:111], v[180:183]
    ds_read_b64_tr_b16 v[242:243], v2 offset:13568
    s_waitcnt lgkmcnt(10)
    v_mfma_f32_16x16x32_bf16 v[168:171], v[248:251], v[104:107], v[168:171]
    ds_read_b64_tr_b16 v[244:245], v3 offset:13312
    v_mfma_f32_16x16x32_bf16 v[184:187], v[248:251], v[108:111], v[184:187]
    ds_read_b64_tr_b16 v[246:247], v3 offset:13568
    v_mfma_f32_16x16x32_bf16 v[172:175], v[252:255], v[104:107], v[172:175]
    ds_read_b64_tr_b16 v[248:249], v2 offset:13824
    v_mfma_f32_16x16x32_bf16 v[188:191], v[252:255], v[108:111], v[188:191]
    ds_read_b64_tr_b16 v[250:251], v2 offset:14080
    s_waitcnt lgkmcnt(10)
    v_mfma_f32_16x16x32_bf16 v[160:163], v[224:227], v[112:115], v[160:163]
    ds_read_b64_tr_b16 v[252:253], v3 offset:13824
    v_mfma_f32_16x16x32_bf16 v[176:179], v[224:227], v[116:119], v[176:179]
    ds_read_b64_tr_b16 v[254:255], v3 offset:14080
    v_mfma_f32_16x16x32_bf16 v[164:167], v[228:231], v[112:115], v[164:167]
    ds_read_b64_tr_b16 v[224:225], v2 offset:14336
    v_mfma_f32_16x16x32_bf16 v[180:183], v[228:231], v[116:119], v[180:183]
    ds_read_b64_tr_b16 v[226:227], v2 offset:14592
    s_waitcnt lgkmcnt(10)
    v_mfma_f32_16x16x32_bf16 v[168:171], v[232:235], v[112:115], v[168:171]
    ds_read_b64_tr_b16 v[228:229], v3 offset:14336
    v_mfma_f32_16x16x32_bf16 v[184:187], v[232:235], v[116:119], v[184:187]
    ds_read_b64_tr_b16 v[230:231], v3 offset:14592
    v_mfma_f32_16x16x32_bf16 v[172:175], v[236:239], v[112:115], v[172:175]
    ds_read_b64_tr_b16 v[232:233], v2 offset:14848
    v_mfma_f32_16x16x32_bf16 v[188:191], v[236:239], v[116:119], v[188:191]
    ds_read_b64_tr_b16 v[234:235], v2 offset:15104
    s_waitcnt lgkmcnt(10)
    v_mfma_f32_16x16x32_bf16 v[160:163], v[240:243], v[120:123], v[160:163]
    ds_read_b64_tr_b16 v[236:237], v3 offset:14848
    v_mfma_f32_16x16x32_bf16 v[176:179], v[240:243], v[124:127], v[176:179]
    ds_read_b64_tr_b16 v[238:239], v3 offset:15104
    v_mfma_f32_16x16x32_bf16 v[164:167], v[244:247], v[120:123], v[164:167]
    ds_read_b64_tr_b16 v[240:241], v2 offset:15360
    v_mfma_f32_16x16x32_bf16 v[180:183], v[244:247], v[124:127], v[180:183]
    ds_read_b64_tr_b16 v[242:243], v2 offset:15616
    s_waitcnt lgkmcnt(10)
    v_mfma_f32_16x16x32_bf16 v[168:171], v[248:251], v[120:123], v[168:171]
    ds_read_b64_tr_b16 v[244:245], v3 offset:15360
    v_mfma_f32_16x16x32_bf16 v[184:187], v[248:251], v[124:127], v[184:187]
    ds_read_b64_tr_b16 v[246:247], v3 offset:15616
    v_mfma_f32_16x16x32_bf16 v[172:175], v[252:255], v[120:123], v[172:175]
    ds_read_b64_tr_b16 v[248:249], v2 offset:15872
    v_mfma_f32_16x16x32_bf16 v[188:191], v[252:255], v[124:127], v[188:191]
    ds_read_b64_tr_b16 v[250:251], v2 offset:16128
    s_waitcnt lgkmcnt(10)
    v_mfma_f32_16x16x32_bf16 v[160:163], v[224:227], v[128:131], v[160:163]
    ds_read_b64_tr_b16 v[252:253], v3 offset:15872
    v_mfma_f32_16x16x32_bf16 v[176:179], v[224:227], v[132:135], v[176:179]
    ds_read_b64_tr_b16 v[254:255], v3 offset:16128
    v_mfma_f32_16x16x32_bf16 v[164:167], v[228:231], v[128:131], v[164:167]
    ds_read_b64_tr_b16 v[224:225], v2 offset:16384
    v_mfma_f32_16x16x32_bf16 v[180:183], v[228:231], v[132:135], v[180:183]
    ds_read_b64_tr_b16 v[226:227], v2 offset:16640
    s_waitcnt lgkmcnt(10)
    v_mfma_f32_16x16x32_bf16 v[168:171], v[232:235], v[128:131], v[168:171]
    ds_read_b64_tr_b16 v[228:229], v3 offset:16384
    v_mfma_f32_16x16x32_bf16 v[184:187], v[232:235], v[132:135], v[184:187]
    ds_read_b64_tr_b16 v[230:231], v3 offset:16640
    v_mfma_f32_16x16x32_bf16 v[172:175], v[236:239], v[128:131], v[172:175]
    ds_read_b64_tr_b16 v[232:233], v2 offset:16896
    v_mfma_f32_16x16x32_bf16 v[188:191], v[236:239], v[132:135], v[188:191]
    ds_read_b64_tr_b16 v[234:235], v2 offset:17152
    s_waitcnt lgkmcnt(10)
    v_mfma_f32_16x16x32_bf16 v[160:163], v[240:243], v[136:139], v[160:163]
    ds_read_b64_tr_b16 v[236:237], v3 offset:16896
    v_mfma_f32_16x16x32_bf16 v[176:179], v[240:243], v[140:143], v[176:179]
    ds_read_b64_tr_b16 v[238:239], v3 offset:17152
    v_mfma_f32_16x16x32_bf16 v[164:167], v[244:247], v[136:139], v[164:167]
    ds_read_b64_tr_b16 v[240:241], v2 offset:17408
    v_mfma_f32_16x16x32_bf16 v[180:183], v[244:247], v[140:143], v[180:183]
    ds_read_b64_tr_b16 v[242:243], v2 offset:17664
    s_waitcnt lgkmcnt(10)
    v_mfma_f32_16x16x32_bf16 v[168:171], v[248:251], v[136:139], v[168:171]
    ds_read_b64_tr_b16 v[244:245], v3 offset:17408
    v_mfma_f32_16x16x32_bf16 v[184:187], v[248:251], v[140:143], v[184:187]
    ds_read_b64_tr_b16 v[246:247], v3 offset:17664
    v_mfma_f32_16x16x32_bf16 v[172:175], v[252:255], v[136:139], v[172:175]
    ds_read_b64_tr_b16 v[248:249], v2 offset:17920
    v_mfma_f32_16x16x32_bf16 v[188:191], v[252:255], v[140:143], v[188:191]
    ds_read_b64_tr_b16 v[250:251], v2 offset:18176
    s_waitcnt lgkmcnt(10)
    v_mfma_f32_16x16x32_bf16 v[160:163], v[224:227], v[144:147], v[160:163]
    ds_read_b64_tr_b16 v[252:253], v3 offset:17920
    v_mfma_f32_16x16x32_bf16 v[176:179], v[224:227], v[148:151], v[176:179]
    ds_read_b64_tr_b16 v[254:255], v3 offset:18176
    s_barrier
    v_mfma_f32_16x16x32_bf16 v[164:167], v[228:231], v[144:147], v[164:167]
    ds_read_b64_tr_b16 v[224:225], v4 offset:0
    v_mfma_f32_16x16x32_bf16 v[180:183], v[228:231], v[148:151], v[180:183]
    ds_read_b64_tr_b16 v[226:227], v4 offset:256
    s_waitcnt lgkmcnt(10)
    v_mfma_f32_16x16x32_bf16 v[168:171], v[232:235], v[144:147], v[168:171]
    ds_read_b64_tr_b16 v[228:229], v5 offset:0
    v_mfma_f32_16x16x32_bf16 v[184:187], v[232:235], v[148:151], v[184:187]
    ds_read_b64_tr_b16 v[230:231], v5 offset:256
    v_mfma_f32_16x16x32_bf16 v[172:175], v[236:239], v[144:147], v[172:175]
    ds_read_b64_tr_b16 v[232:233], v4 offset:512
    v_mfma_f32_16x16x32_bf16 v[188:191], v[236:239], v[148:151], v[188:191]
    ds_read_b64_tr_b16 v[234:235], v4 offset:768
    s_waitcnt lgkmcnt(10)
    v_mfma_f32_16x16x32_bf16 v[160:163], v[240:243], v[152:155], v[160:163]
    ds_read_b64_tr_b16 v[236:237], v5 offset:512
    v_mfma_f32_16x16x32_bf16 v[176:179], v[240:243], v[156:159], v[176:179]
    ds_read_b64_tr_b16 v[238:239], v5 offset:768
    v_mfma_f32_16x16x32_bf16 v[164:167], v[244:247], v[152:155], v[164:167]
    ds_read_b64_tr_b16 v[240:241], v4 offset:1024
    v_mfma_f32_16x16x32_bf16 v[180:183], v[244:247], v[156:159], v[180:183]
    ds_read_b64_tr_b16 v[242:243], v4 offset:1280
    s_waitcnt lgkmcnt(10)
    v_mfma_f32_16x16x32_bf16 v[168:171], v[248:251], v[152:155], v[168:171]
    ds_read_b64_tr_b16 v[244:245], v5 offset:1024
    v_mfma_f32_16x16x32_bf16 v[184:187], v[248:251], v[156:159], v[184:187]
    ds_read_b64_tr_b16 v[246:247], v5 offset:1280
    v_mfma_f32_16x16x32_bf16 v[172:175], v[252:255], v[152:155], v[172:175]
    ds_read_b64_tr_b16 v[248:249], v4 offset:1536
    v_mfma_f32_16x16x32_bf16 v[188:191], v[252:255], v[156:159], v[188:191]
    ds_read_b64_tr_b16 v[250:251], v4 offset:1792
    s_add_u32 s59, s59, 1
    s_cmp_eq_u32 s59, s70
    s_cbranch_scc1 L_b1l
    s_branch L_b1n
L_wasq0:
    s_mov_b32 s61, s65
    s_add_u32 s65, s65, 4096
    s_branch L_b1q
L_wasq1:
    s_mov_b32 s61, s65
    s_add_u32 s65, s65, 4096
    s_branch L_b0q
L_b1l:
    s_waitcnt lgkmcnt(10)
    v_mfma_f32_16x16x32_bf16 v[192:195], v[224:227], v[16:19], 0
    ds_read_b64_tr_b16 v[252:253], v5 offset:1536
    v_mfma_f32_16x16x32_bf16 v[208:211], v[224:227], v[20:23], 0
    ds_read_b64_tr_b16 v[254:255], v5 offset:1792
    v_mfma_f32_16x16x32_bf16 v[196:199], v[228:231], v[16:19], 0
    ds_read_b64_tr_b16 v[224:225], v4 offset:2048
    v_mfma_f32_16x16x32_bf16 v[212:215], v[228:231], v[20:23], 0
    ds_read_b64_tr_b16 v[226:227], v4 offset:2304
    s_waitcnt lgkmcnt(10)
    v_mfma_f32_16x16x32_bf16 v[200:203], v[232:235], v[16:19], 0
    ds_read_b64_tr_b16 v[228:229], v5 offset:2048
    v_mfma_f32_16x16x32_bf16 v[216:219], v[232:235], v[20:23], 0
    ds_read_b64_tr_b16 v[230:231], v5 offset:2304
    v_mfma_f32_16x16x32_bf16 v[204:207], v[236:239], v[16:19], 0
    ds_read_b64_tr_b16 v[232:233], v4 offset:2560
    v_mfma_f32_16x16x32_bf16 v[220:223], v[236:239], v[20:23], 0
    ds_read_b64_tr_b16 v[234:235], v4 offset:2816
    s_waitcnt lgkmcnt(10)
    v_mfma_f32_16x16x32_bf16 v[192:195], v[240:243], v[24:27], v[192:195]
    ds_read_b64_tr_b16 v[236:237], v5 offset:2560
    v_mfma_f32_16x16x32_bf16 v[208:211], v[240:243], v[28:31], v[208:211]
    ds_read_b64_tr_b16 v[238:239], v5 offset:2816
    v_mfma_f32_16x16x32_bf16 v[196:199], v[244:247], v[24:27], v[196:199]
    ds_read_b64_tr_b16 v[240:241], v4 offset:3072
    v_mfma_f32_16x16x32_bf16 v[212:215], v[244:247], v[28:31], v[212:215]
    ds_read_b64_tr_b16 v[242:243], v4 offset:3328
    s_waitcnt lgkmcnt(10)
    v_mfma_f32_16x16x32_bf16 v[200:203], v[248:251], v[24:27], v[200:203]
    ds_read_b64_tr_b16 v[244:245], v5 offset:3072
    s_mov_b32 s41, s78
    v_mfma_f32_16x16x32_bf16 v[216:219], v[248:251], v[28:31], v[216:219]
    ds_read_b64_tr_b16 v[246:247], v5 offset:3328
    s_sub_u32 s42, s41, s94
    v_mfma_f32_16x16x32_bf16 v[204:207], v[252:255], v[24:27], v[204:207]
    ds_read_b64_tr_b16 v[248:249], v4 offset:3584
    s_lshl_b32 s43, s53, 1
    v_mfma_f32_16x16x32_bf16 v[220:223], v[252:255], v[28:31], v[220:223]
    ds_read_b64_tr_b16 v[250:251], v4 offset:3840
    s_waitcnt lgkmcnt(10)
    v_mfma_f32_16x16x32_bf16 v[192:195], v[224:227], v[32:35], v[192:195]
    ds_read_b64_tr_b16 v[252:253], v5 offset:3584
    s_add_u32 s43, s43, s42
    v_mfma_f32_16x16x32_bf16 v[208:211], v[224:227], v[36:39], v[208:211]
    ds_read_b64_tr_b16 v[254:255], v5 offset:3840
    s_add_u32 s43, s43, 39
    v_mfma_f32_16x16x32_bf16 v[196:199], v[228:231], v[32:35], v[196:199]
    ds_read_b64_tr_b16 v[224:225], v4 offset:4096
    s_add_u32 s42, s53, 24
    v_mfma_f32_16x16x32_bf16 v[212:215], v[228:231], v[36:39], v[212:215]
    ds_read_b64_tr_b16 v[226:227], v4 offset:4352
    s_waitcnt lgkmcnt(10)
    v_mfma_f32_16x16x32_bf16 v[200:203], v[232:235], v[32:35], v[200:203]
    ds_read_b64_tr_b16 v[228:229], v5 offset:4096
    s_cmp_eq_u32 s41, s94
    v_mfma_f32_16x16x32_bf16 v[216:219], v[232:235], v[36:39], v[216:219]
    ds_read_b64_tr_b16 v[230:231], v5 offset:4352
    s_cselect_b32 s43, s42, s43
    v_mfma_f32_16x16x32_bf16 v[204:207], v[236:239], v[32:35], v[204:207]
    ds_read_b64_tr_b16 v[232:233], v4 offset:4608
    s_add_u32 s42, s41, s58
    v_mfma_f32_16x16x32_bf16 v[220:223], v[236:239], v[36:39], v[220:223]
    ds_read_b64_tr_b16 v[234:235], v4 offset:4864
    s_waitcnt lgkmcnt(10)
    v_mfma_f32_16x16x32_bf16 v[192:195], v[240:243], v[40:43], v[192:195]
    ds_read_b64_tr_b16 v[236:237], v5 offset:4608
    s_cmp_lt_u32 s41, s94
    v_mfma_f32_16x16x32_bf16 v[208:211], v[240:243], v[44:47], v[208:211]
    ds_read_b64_tr_b16 v[238:239], v5 offset:4864
    s_cselect_b32 s41, s42, s43
    v_mfma_f32_16x16x32_bf16 v[196:199], v[244:247], v[40:43], v[196:199]
    ds_read_b64_tr_b16 v[240:241], v4 offset:5120
    s_mul_i32 s41, s41, 10240
    v_mfma_f32_16x16x32_bf16 v[212:215], v[244:247], v[44:47], v[212:215]
    ds_read_b64_tr_b16 v[242:243], v4 offset:5376
    s_waitcnt lgkmcnt(10)
    v_mfma_f32_16x16x32_bf16 v[200:203], v[248:251], v[40:43], v[200:203]
    ds_read_b64_tr_b16 v[244:245], v5 offset:5120
    s_add_u32 s61, s63, s41
    v_mfma_f32_16x16x32_bf16 v[216:219], v[248:251], v[44:47], v[216:219]
    ds_read_b64_tr_b16 v[246:247], v5 offset:5376
    s_add_u32 s62, s64, s41
    v_mfma_f32_16x16x32_bf16 v[204:207], v[252:255], v[40:43], v[204:207]
    ds_read_b64_tr_b16 v[248:249], v4 offset:5632
    v_mul_f32 v160, v9, v160
    v_mfma_f32_16x16x32_bf16 v[220:223], v[252:255], v[44:47], v[220:223]
    ds_read_b64_tr_b16 v[250:251], v4 offset:5888
    s_waitcnt lgkmcnt(10)
    v_mfma_f32_16x16x32_bf16 v[192:195], v[224:227], v[48:51], v[192:195]
    ds_read_b64_tr_b16 v[252:253], v5 offset:5632
    v_mul_f32 v161, v9, v161
    v_mfma_f32_16x16x32_bf16 v[208:211], v[224:227], v[52:55], v[208:211]
    ds_read_b64_tr_b16 v[254:255], v5 offset:5888
    v_mul_f32 v162, v9, v162
    v_mfma_f32_16x16x32_bf16 v[196:199], v[228:231], v[48:51], v[196:199]
    ds_read_b64_tr_b16 v[224:225], v4 offset:6144
    v_mul_f32 v163, v9, v163
    v_mfma_f32_16x16x32_bf16 v[212:215], v[228:231], v[52:55], v[212:215]
    ds_read_b64_tr_b16 v[226:227], v4 offset:6400
    s_waitcnt lgkmcnt(10)
    v_mfma_f32_16x16x32_bf16 v[200:203], v[232:235], v[48:51], v[200:203]
    ds_read_b64_tr_b16 v[228:229], v5 offset:6144
    v_mul_f32 v164, v9, v164
    v_mfma_f32_16x16x32_bf16 v[216:219], v[232:235], v[52:55], v[216:219]
    ds_read_b64_tr_b16 v[230:231], v5 offset:6400
    v_mul_f32 v165, v9, v165
    v_mfma_f32_16x16x32_bf16 v[204:207], v[236:239], v[48:51], v[204:207]
    ds_read_b64_tr_b16 v[232:233], v4 offset:6656
    v_mul_f32 v166, v9, v166
    v_mfma_f32_16x16x32_bf16 v[220:223], v[236:239], v[52:55], v[220:223]
    ds_read_b64_tr_b16 v[234:235], v4 offset:6912
    s_waitcnt lgkmcnt(10)
    v_mfma_f32_16x16x32_bf16 v[192:195], v[240:243], v[56:59], v[192:195]
    ds_read_b64_tr_b16 v[236:237], v5 offset:6656
    v_mul_f32 v167, v9, v167
    v_mfma_f32_16x16x32_bf16 v[208:211], v[240:243], v[60:63], v[208:211]
    ds_read_b64_tr_b16 v[238:239], v5 offset:6912
    v_mul_f32 v168, v9, v168
    v_mfma_f32_16x16x32_bf16 v[196:199], v[244:247], v[56:59], v[196:199]
    ds_read_b64_tr_b16 v[240:241], v4 offset:7168
    v_mul_f32 v169, v9, v169
    v_mfma_f32_16x16x32_bf16 v[212:215], v[244:247], v[60:63], v[212:215]
    ds_read_b64_tr_b16 v[242:243], v4 offset:7424
    s_waitcnt lgkmcnt(10)
    v_mfma_f32_16x16x32_bf16 v[200:203], v[248:251], v[56:59], v[200:203]
    ds_read_b64_tr_b16 v[244:245], v5 offset:7168
    v_mul_f32 v170, v9, v170
    v_mfma_f32_16x16x32_bf16 v[216:219], v[248:251], v[60:63], v[216:219]
    ds_read_b64_tr_b16 v[246:247], v5 offset:7424
    v_mul_f32 v171, v9, v171
    v_mfma_f32_16x16x32_bf16 v[204:207], v[252:255], v[56:59], v[204:207]
    ds_read_b64_tr_b16 v[248:249], v4 offset:7680
    v_mul_f32 v172, v9, v172
    v_mfma_f32_16x16x32_bf16 v[220:223], v[252:255], v[60:63], v[220:223]
    ds_read_b64_tr_b16 v[250:251], v4 offset:7936
    s_waitcnt lgkmcnt(10)
    v_mfma_f32_16x16x32_bf16 v[192:195], v[224:227], v[64:67], v[192:195]
    ds_read_b64_tr_b16 v[252:253], v5 offset:7680
    v_mul_f32 v173, v9, v173
    v_mfma_f32_16x16x32_bf16 v[208:211], v[224:227], v[68:71], v[208:211]
    ds_read_b64_tr_b16 v[254:255], v5 offset:7936
    v_mul_f32 v174, v9, v174
    v_mfma_f32_16x16x32_bf16 v[196:199], v[228:231], v[64:67], v[196:199]
    ds_read_b64_tr_b16 v[224:225], v4 offset:8192
    v_mul_f32 v175, v9, v175
    v_mfma_f32_16x16x32_bf16 v[212:215], v[228:231], v[68:71], v[212:215]
    ds_read_b64_tr_b16 v[226:227], v4 offset:8448
    s_waitcnt lgkmcnt(10)
    v_mfma_f32_16x16x32_bf16 v[200:203], v[232:235], v[64:67], v[200:203]
    ds_read_b64_tr_b16 v[228:229], v5 offset:8192
    v_mul_f32 v176, v10, v176
    v_mfma_f32_16x16x32_bf16 v[216:219], v[232:235], v[68:71], v[216:219]
    ds_read_b64_tr_b16 v[230:231], v5 offset:8448
    v_mul_f32 v177, v10, v177
    v_mfma_f32_16x16x32_bf16 v[204:207], v[236:239], v[64:67], v[204:207]
    ds_read_b64_tr_b16 v[232:233], v4 offset:8704
    v_mul_f32 v178, v10, v178
    v_mfma_f32_16x16x32_bf16 v[220:223], v[236:239], v[68:71], v[220:223]
    ds_read_b64_tr_b16 v[234:235], v4 offset:8960
    s_waitcnt lgkmcnt(10)
    v_mfma_f32_16x16x32_bf16 v[192:195], v[240:243], v[72:75], v[192:195]
    ds_read_b64_tr_b16 v[236:237], v5 offset:8704
    v_mul_f32 v179, v10, v179
    v_mfma_f32_16x16x32_bf16 v[208:211], v[240:243], v[76:79], v[208:211]
    ds_read_b64_tr_b16 v[238:239], v5 offset:8960
    v_mul_f32 v180, v10, v180
    v_mfma_f32_16x16x32_bf16 v[196:199], v[244:247], v[72:75], v[196:199]
    ds_read_b64_tr_b16 v[240:241], v4 offset:9216
    v_mul_f32 v181, v10, v181
    v_mfma_f32_16x16x32_bf16 v[212:215], v[244:247], v[76:79], v[212:215]
    ds_read_b64_tr_b16 v[242:243], v4 offset:9472
    s_waitcnt lgkmcnt(10)
    v_mfma_f32_16x16x32_bf16 v[200:203], v[248:251], v[72:75], v[200:203]
    ds_read_b64_tr_b16 v[244:245], v5 offset:9216
    v_mul_f32 v182, v10, v182
    v_mfma_f32_16x16x32_bf16 v[216:219], v[248:251], v[76:79], v[216:219]
    ds_read_b64_tr_b16 v[246:247], v5 offset:9472
    v_mul_f32 v183, v10, v183
    v_mfma_f32_16x16x32_bf16 v[204:207], v[252:255], v[72:75], v[204:207]
    ds_read_b64_tr_b16 v[248:249], v4 offset:9728
    v_mul_f32 v184, v10, v184
    v_mfma_f32_16x16x32_bf16 v[220:223], v[252:255], v[76:79], v[220:223]
    ds_read_b64_tr_b16 v[250:251], v4 offset:9984
    s_waitcnt lgkmcnt(10)
    v_mfma_f32_16x16x32_bf16 v[192:195], v[224:227], v[80:83], v[192:195]
    ds_read_b64_tr_b16 v[252:253], v5 offset:9728
    v_mul_f32 v185, v10, v185
    v_mfma_f32_16x16x32_bf16 v[208:211], v[224:227], v[84:87], v[208:211]
    ds_read_b64_tr_b16 v[254:255], v5 offset:9984
    v_mul_f32 v186, v10, v186
    v_mfma_f32_16x16x32_bf16 v[196:199], v[228:231], v[80:83], v[196:199]
    ds_read_b64_tr_b16 v[224:225], v4 offset:10240
    v_mul_f32 v187, v10, v187
    v_mfma_f32_16x16x32_bf16 v[212:215], v[228:231], v[84:87], v[212:215]
    ds_read_b64_tr_b16 v[226:227], v4 offset:10496
    s_waitcnt lgkmcnt(10)
    v_mfma_f32_16x16x32_bf16 v[200:203], v[232:235], v[80:83], v[200:203]
    ds_read_b64_tr_b16 v[228:229], v5 offset:10240
    v_mul_f32 v188, v10, v188
    v_mfma_f32_16x16x32_bf16 v[216:219], v[232:235], v[84:87], v[216:219]
    ds_read_b64_tr_b16 v[230:231], v5 offset:10496
    v_mul_f32 v189, v10, v189
    v_mfma_f32_16x16x32_bf16 v[204:207], v[236:239], v[80:83], v[204:207]
    ds_read_b64_tr_b16 v[232:233], v4 offset:10752
    v_mul_f32 v190, v10, v190
    v_mfma_f32_16x16x32_bf16 v[220:223], v[236:239], v[84:87], v[220:223]
    ds_read_b64_tr_b16 v[234:235], v4 offset:11008
    s_waitcnt lgkmcnt(10)
    v_mfma_f32_16x16x32_bf16 v[192:195], v[240:243], v[88:91], v[192:195]
    ds_read_b64_tr_b16 v[236:237], v5 offset:10752
    v_mul_f32 v191, v10, v191
    v_mfma_f32_16x16x32_bf16 v[208:211], v[240:243], v[92:95], v[208:211]
    ds_read_b64_tr_b16 v[238:239], v5 offset:11008
    v_mfma_f32_16x16x32_bf16 v[196:199], v[244:247], v[88:91], v[196:199]
    ds_read_b64_tr_b16 v[240:241], v4 offset:11264
    v_mfma_f32_16x16x32_bf16 v[212:215], v[244:247], v[92:95], v[212:215]
    ds_read_b64_tr_b16 v[242:243], v4 offset:11520
    s_waitcnt lgkmcnt(10)
    v_mfma_f32_16x16x32_bf16 v[200:203], v[248:251], v[88:91], v[200:203]
    ds_read_b64_tr_b16 v[244:245], v5 offset:11264
    v_mfma_f32_16x16x32_bf16 v[216:219], v[248:251], v[92:95], v[216:219]
    ds_read_b64_tr_b16 v[246:247], v5 offset:11520
    v_mfma_f32_16x16x32_bf16 v[204:207], v[252:255], v[88:91], v[204:207]
    ds_read_b64_tr_b16 v[248:249], v4 offset:11776
    v_mfma_f32_16x16x32_bf16 v[220:223], v[252:255], v[92:95], v[220:223]
    ds_read_b64_tr_b16 v[250:251], v4 offset:12032
    s_waitcnt lgkmcnt(10)
    v_mfma_f32_16x16x32_bf16 v[192:195], v[224:227], v[96:99], v[192:195]
    ds_read_b64_tr_b16 v[252:253], v5 offset:11776
    v_mfma_f32_16x16x32_bf16 v[208:211], v[224:227], v[100:103], v[208:211]
    ds_read_b64_tr_b16 v[254:255], v5 offset:12032
    v_mfma_f32_16x16x32_bf16 v[196:199], v[228:231], v[96:99], v[196:199]
    ds_read_b64_tr_b16 v[224:225], v4 offset:12288
    v_mfma_f32_16x16x32_bf16 v[212:215], v[228:231], v[100:103], v[212:215]
    ds_read_b64_tr_b16 v[226:227], v4 offset:12544
    s_waitcnt lgkmcnt(10)
    v_mfma_f32_16x16x32_bf16 v[200:203], v[232:235], v[96:99], v[200:203]
    ds_read_b64_tr_b16 v[228:229], v5 offset:12288
    v_mfma_f32_16x16x32_bf16 v[216:219], v[232:235], v[100:103], v[216:219]
    ds_read_b64_tr_b16 v[230:231], v5 offset:12544
    v_mfma_f32_16x16x32_bf16 v[204:207], v[236:239], v[96:99], v[204:207]
    ds_read_b64_tr_b16 v[232:233], v4 offset:12800
    v_mfma_f32_16x16x32_bf16 v[220:223], v[236:239], v[100:103], v[220:223]
    ds_read_b64_tr_b16 v[234:235], v4 offset:13056
    s_waitcnt lgkmcnt(10)
    v_mfma_f32_16x16x32_bf16 v[192:195], v[240:243], v[104:107], v[192:195]
    ds_read_b64_tr_b16 v[236:237], v5 offset:12800
    v_mfma_f32_16x16x32_bf16 v[208:211], v[240:243], v[108:111], v[208:211]
    ds_read_b64_tr_b16 v[238:239], v5 offset:13056
    v_mfma_f32_16x16x32_bf16 v[196:199], v[244:247], v[104:107], v[196:199]
    ds_read_b64_tr_b16 v[240:241], v4 offset:13312
    v_mfma_f32_16x16x32_bf16 v[212:215], v[244:247], v[108:111], v[212:215]
    ds_read_b64_tr_b16 v[242:243], v4 offset:13568
    s_waitcnt lgkmcnt(10)
    v_mfma_f32_16x16x32_bf16 v[200:203], v[248:251], v[104:107], v[200:203]
    ds_read_b64_tr_b16 v[244:245], v5 offset:13312
    v_mfma_f32_16x16x32_bf16 v[216:219], v[248:251], v[108:111], v[216:219]
    ds_read_b64_tr_b16 v[246:247], v5 offset:13568
    v_mfma_f32_16x16x32_bf16 v[204:207], v[252:255], v[104:107], v[204:207]
    ds_read_b64_tr_b16 v[248:249], v4 offset:13824
    v_mfma_f32_16x16x32_bf16 v[220:223], v[252:255], v[108:111], v[220:223]
    ds_read_b64_tr_b16 v[250:251], v4 offset:14080
    s_waitcnt lgkmcnt(10)
    v_mfma_f32_16x16x32_bf16 v[192:195], v[224:227], v[112:115], v[192:195]
    ds_read_b64_tr_b16 v[252:253], v5 offset:13824
    v_mfma_f32_16x16x32_bf16 v[208:211], v[224:227], v[116:119], v[208:211]
    ds_read_b64_tr_b16 v[254:255], v5 offset:14080
    v_mfma_f32_16x16x32_bf16 v[196:199], v[228:231], v[112:115], v[196:199]
    ds_read_b64_tr_b16 v[224:225], v4 offset:14336
    v_mfma_f32_16x16x32_bf16 v[212:215], v[228:231], v[116:119], v[212:215]
    ds_read_b64_tr_b16 v[226:227], v4 offset:14592
    s_waitcnt lgkmcnt(10)
    v_mfma_f32_16x16x32_bf16 v[200:203], v[232:235], v[112:115], v[200:203]
    ds_read_b64_tr_b16 v[228:229], v5 offset:14336
    v_mfma_f32_16x16x32_bf16 v[216:219], v[232:235], v[116:119], v[216:219]
    ds_read_b64_tr_b16 v[230:231], v5 offset:14592
    v_mfma_f32_16x16x32_bf16 v[204:207], v[236:239], v[112:115], v[204:207]
    ds_read_b64_tr_b16 v[232:233], v4 offset:14848
    v_mfma_f32_16x16x32_bf16 v[220:223], v[236:239], v[116:119], v[220:223]
    ds_read_b64_tr_b16 v[234:235], v4 offset:15104
    s_waitcnt lgkmcnt(10)
    v_mfma_f32_16x16x32_bf16 v[192:195], v[240:243], v[120:123], v[192:195]
    ds_read_b64_tr_b16 v[236:237], v5 offset:14848
    v_mfma_f32_16x16x32_bf16 v[208:211], v[240:243], v[124:127], v[208:211]
    ds_read_b64_tr_b16 v[238:239], v5 offset:15104
    v_mfma_f32_16x16x32_bf16 v[196:199], v[244:247], v[120:123], v[196:199]
    ds_read_b64_tr_b16 v[240:241], v4 offset:15360
    v_mfma_f32_16x16x32_bf16 v[212:215], v[244:247], v[124:127], v[212:215]
    ds_read_b64_tr_b16 v[242:243], v4 offset:15616
    s_waitcnt lgkmcnt(10)
    v_mfma_f32_16x16x32_bf16 v[200:203], v[248:251], v[120:123], v[200:203]
    ds_read_b64_tr_b16 v[244:245], v5 offset:15360
    v_mfma_f32_16x16x32_bf16 v[216:219], v[248:251], v[124:127], v[216:219]
    ds_read_b64_tr_b16 v[246:247], v5 offset:15616
    v_mfma_f32_16x16x32_bf16 v[204:207], v[252:255], v[120:123], v[204:207]
    ds_read_b64_tr_b16 v[248:249], v4 offset:15872
    v_mfma_f32_16x16x32_bf16 v[220:223], v[252:255], v[124:127], v[220:223]
    ds_read_b64_tr_b16 v[250:251], v4 offset:16128
    s_waitcnt lgkmcnt(10)
    v_mfma_f32_16x16x32_bf16 v[192:195], v[224:227], v[128:131], v[192:195]
    ds_read_b64_tr_b16 v[252:253], v5 offset:15872
    v_mfma_f32_16x16x32_bf16 v[208:211], v[224:227], v[132:135], v[208:211]
    ds_read_b64_tr_b16 v[254:255], v5 offset:16128
    v_mfma_f32_16x16x32_bf16 v[196:199], v[228:231], v[128:131], v[196:199]
    ds_read_b64_tr_b16 v[224:225], v4 offset:16384
    v_mfma_f32_16x16x32_bf16 v[212:215], v[228:231], v[132:135], v[212:215]
    ds_read_b64_tr_b16 v[226:227], v4 offset:16640
    s_waitcnt lgkmcnt(10)
    v_mfma_f32_16x16x32_bf16 v[200:203], v[232:235], v[128:131], v[200:203]
    ds_read_b64_tr_b16 v[228:229], v5 offset:16384
    v_mfma_f32_16x16x32_bf16 v[216:219], v[232:235], v[132:135], v[216:219]
    ds_read_b64_tr_b16 v[230:231], v5 offset:16640
    v_mfma_f32_16x16x32_bf16 v[204:207], v[236:239], v[128:131], v[204:207]
    ds_read_b64_tr_b16 v[232:233], v4 offset:16896
    v_mfma_f32_16x16x32_bf16 v[220:223], v[236:239], v[132:135], v[220:223]
    ds_read_b64_tr_b16 v[234:235], v4 offset:17152
    s_waitcnt lgkmcnt(10)
    v_mfma_f32_16x16x32_bf16 v[192:195], v[240:243], v[136:139], v[192:195]
    ds_read_b64_tr_b16 v[236:237], v5 offset:16896
    v_mfma_f32_16x16x32_bf16 v[208:211], v[240:243], v[140:143], v[208:211]
    ds_read_b64_tr_b16 v[238:239], v5 offset:17152
    v_mfma_f32_16x16x32_bf16 v[196:199], v[244:247], v[136:139], v[196:199]
    ds_read_b64_tr_b16 v[240:241], v4 offset:17408
    v_mfma_f32_16x16x32_bf16 v[212:215], v[244:247], v[140:143], v[212:215]
    ds_read_b64_tr_b16 v[242:243], v4 offset:17664
    s_waitcnt lgkmcnt(10)
    v_mfma_f32_16x16x32_bf16 v[200:203], v[248:251], v[136:139], v[200:203]
    ds_read_b64_tr_b16 v[244:245], v5 offset:17408
    v_mfma_f32_16x16x32_bf16 v[216:219], v[248:251], v[140:143], v[216:219]
    ds_read_b64_tr_b16 v[246:247], v5 offset:17664
    v_mfma_f32_16x16x32_bf16 v[204:207], v[252:255], v[136:139], v[204:207]
    ds_read_b64_tr_b16 v[248:249], v4 offset:17920
    v_mfma_f32_16x16x32_bf16 v[220:223], v[252:255], v[140:143], v[220:223]
    ds_read_b64_tr_b16 v[250:251], v4 offset:18176
    s_waitcnt lgkmcnt(10)
    v_mfma_f32_16x16x32_bf16 v[192:195], v[224:227], v[144:147], v[192:195]
    ds_read_b64_tr_b16 v[252:253], v5 offset:17920
    v_mfma_f32_16x16x32_bf16 v[208:211], v[224:227], v[148:151], v[208:211]
    ds_read_b64_tr_b16 v[254:255], v5 offset:18176
    ds_append v14 offset:64
    v_mfma_f32_16x16x32_bf16 v[196:199], v[228:231], v[144:147], v[196:199]
    v_mfma_f32_16x16x32_bf16 v[212:215], v[228:231], v[148:151], v[212:215]
    s_waitcnt lgkmcnt(9)
    v_mfma_f32_16x16x32_bf16 v[200:203], v[232:235], v[144:147], v[200:203]
    v_mfma_f32_16x16x32_bf16 v[216:219], v[232:235], v[148:151], v[216:219]
    v_mfma_f32_16x16x32_bf16 v[204:207], v[236:239], v[144:147], v[204:207]
    v_mfma_f32_16x16x32_bf16 v[220:223], v[236:239], v[148:151], v[220:223]
    s_waitcnt lgkmcnt(5)
    v_mfma_f32_16x16x32_bf16 v[192:195], v[240:243], v[152:155], v[192:195]
    v_mfma_f32_16x16x32_bf16 v[208:211], v[240:243], v[156:159], v[208:211]
    v_mfma_f32_16x16x32_bf16 v[196:199], v[244:247], v[152:155], v[196:199]
    v_mfma_f32_16x16x32_bf16 v[212:215], v[244:247], v[156:159], v[212:215]
    s_waitcnt lgkmcnt(1)
    v_mfma_f32_16x16x32_bf16 v[200:203], v[248:251], v[152:155], v[200:203]
    v_mfma_f32_16x16x32_bf16 v[216:219], v[248:251], v[156:159], v[216:219]
    v_mfma_f32_16x16x32_bf16 v[204:207], v[252:255], v[152:155], v[204:207]
    v_mfma_f32_16x16x32_bf16 v[220:223], v[252:255], v[156:159], v[220:223]
    s_load_dword s3, s[12:13], 0
    v_lshrrev_b32 v2, 4, v1
    s_lshl_b32 s40, s38, 1
    s_sub_u32 s40, s40, 2
    v_add_u32 v2, s40, v2
    v_max_i32 v2, 0, v2
    v_and_b32 v3, 15, v1
    v_lshl_add_u32 v2, v2, 6, v3
    v_lshlrev_b32 v2, 2, v2
    v_add_u32 v2, 29454336, v2
    s_setprio 3
    buffer_load_dword v3, v2, s[32:35], 0 offen sc1
    v_mul_f32 v192, v160, v192
    v_mul_f32 v193, v161, v193
    v_mul_f32 v194, v162, v194
    v_mul_f32 v195, v163, v195
    v_mul_f32 v196, v164, v196
    v_mul_f32 v197, v165, v197
    v_mul_f32 v198, v166, v198
    v_mul_f32 v199, v167, v199
    v_mul_f32 v200, v168, v200
    v_mul_f32 v201, v169, v201
    v_mul_f32 v202, v170, v202
    v_mul_f32 v203, v171, v203
    v_mul_f32 v204, v172, v204
    v_mul_f32 v205, v173, v205
    v_mul_f32 v206, v174, v206
    v_mul_f32 v207, v175, v207
    v_mul_f32 v208, v176, v208
    v_mul_f32 v209, v177, v209
    v_mul_f32 v210, v178, v210
    v_mul_f32 v211, v179, v211
    v_mul_f32 v212, v180, v212
    v_mul_f32 v213, v181, v213
    v_mul_f32 v214, v182, v214
    v_mul_f32 v215, v183, v215
    v_mul_f32 v216, v184, v216
    v_mul_f32 v217, v185, v217
    v_mul_f32 v218, v186, v218
    v_mul_f32 v219, v187, v219
    v_mul_f32 v220, v188, v220
    v_mul_f32 v221, v189, v221
    v_mul_f32 v222, v190, v222
    v_mul_f32 v223, v191, v223
    v_cvt_pk_bf16_f32 v192, v192, v193
    v_cvt_pk_bf16_f32 v193, v194, v195
    v_cvt_pk_bf16_f32 v194, v196, v197
    v_cvt_pk_bf16_f32 v195, v198, v199
    buffer_store_dwordx4 v[192:195], v6, s[32:35], s61 offen sc1
    v_cvt_pk_bf16_f32 v200, v200, v201
    v_cvt_pk_bf16_f32 v201, v202, v203
    v_cvt_pk_bf16_f32 v202, v204, v205
    v_cvt_pk_bf16_f32 v203, v206, v207
    s_add_u32 s66, s61, 5120
    buffer_store_dwordx4 v[200:203], v6, s[32:35], s66 offen sc1
    v_cvt_pk_bf16_f32 v208, v208, v209
    v_cvt_pk_bf16_f32 v209, v210, v211
    v_cvt_pk_bf16_f32 v210, v212, v213
    v_cvt_pk_bf16_f32 v211, v214, v215
    buffer_store_dwordx4 v[208:211], v6, s[32:35], s62 offen sc1
    v_cvt_pk_bf16_f32 v216, v216, v217
    v_cvt_pk_bf16_f32 v217, v218, v219
    v_cvt_pk_bf16_f32 v218, v220, v221
    v_cvt_pk_bf16_f32 v219, v222, v223
    s_add_u32 s66, s62, 5120
    buffer_store_dwordx4 v[216:219], v6, s[32:35], s66 offen sc1
    s_mov_b32 s69, 77824
    s_branch L_attn
L_b0l:
    s_waitcnt lgkmcnt(10)
    v_mfma_f32_16x16x32_bf16 v[160:163], v[224:227], v[16:19], 0
    ds_read_b64_tr_b16 v[252:253], v3 offset:1536
    v_mfma_f32_16x16x32_bf16 v[176:179], v[224:227], v[20:23], 0
    ds_read_b64_tr_b16 v[254:255], v3 offset:1792
    v_mfma_f32_16x16x32_bf16 v[164:167], v[228:231], v[16:19], 0
    ds_read_b64_tr_b16 v[224:225], v2 offset:2048
    v_mfma_f32_16x16x32_bf16 v[180:183], v[228:231], v[20:23], 0
    ds_read_b64_tr_b16 v[226:227], v2 offset:2304
    s_waitcnt lgkmcnt(10)
    v_mfma_f32_16x16x32_bf16 v[168:171], v[232:235], v[16:19], 0
    ds_read_b64_tr_b16 v[228:229], v3 offset:2048
    v_mfma_f32_16x16x32_bf16 v[184:187], v[232:235], v[20:23], 0
    ds_read_b64_tr_b16 v[230:231], v3 offset:2304
    v_mfma_f32_16x16x32_bf16 v[172:175], v[236:239], v[16:19], 0
    ds_read_b64_tr_b16 v[232:233], v2 offset:2560
    v_mfma_f32_16x16x32_bf16 v[188:191], v[236:239], v[20:23], 0
    ds_read_b64_tr_b16 v[234:235], v2 offset:2816
    s_waitcnt lgkmcnt(10)
    v_mfma_f32_16x16x32_bf16 v[160:163], v[240:243], v[24:27], v[160:163]
    ds_read_b64_tr_b16 v[236:237], v3 offset:2560
    v_mfma_f32_16x16x32_bf16 v[176:179], v[240:243], v[28:31], v[176:179]
    ds_read_b64_tr_b16 v[238:239], v3 offset:2816
    v_mfma_f32_16x16x32_bf16 v[164:167], v[244:247], v[24:27], v[164:167]
    ds_read_b64_tr_b16 v[240:241], v2 offset:3072
    v_mfma_f32_16x16x32_bf16 v[180:183], v[244:247], v[28:31], v[180:183]
    ds_read_b64_tr_b16 v[242:243], v2 offset:3328
    s_waitcnt lgkmcnt(10)
    v_mfma_f32_16x16x32_bf16 v[168:171], v[248:251], v[24:27], v[168:171]
    ds_read_b64_tr_b16 v[244:245], v3 offset:3072
    s_mov_b32 s41, s78
    v_mfma_f32_16x16x32_bf16 v[184:187], v[248:251], v[28:31], v[184:187]
    ds_read_b64_tr_b16 v[246:247], v3 offset:3328
    s_sub_u32 s42, s41, s94
    v_mfma_f32_16x16x32_bf16 v[172:175], v[252:255], v[24:27], v[172:175]
    ds_read_b64_tr_b16 v[248:249], v2 offset:3584
    s_lshl_b32 s43, s53, 1
    v_mfma_f32_16x16x32_bf16 v[188:191], v[252:255], v[28:31], v[188:191]
    ds_read_b64_tr_b16 v[250:251], v2 offset:3840
    s_waitcnt lgkmcnt(10)
    v_mfma_f32_16x16x32_bf16 v[160:163], v[224:227], v[32:35], v[160:163]
    ds_read_b64_tr_b16 v[252:253], v3 offset:3584
    s_add_u32 s43, s43, s42
    v_mfma_f32_16x16x32_bf16 v[176:179], v[224:227], v[36:39], v[176:179]
    ds_read_b64_tr_b16 v[254:255], v3 offset:3840
    s_add_u32 s43, s43, 39
    v_mfma_f32_16x16x32_bf16 v[164:167], v[228:231], v[32:35], v[164:167]
    ds_read_b64_tr_b16 v[224:225], v2 offset:4096
    s_add_u32 s42, s53, 24
    v_mfma_f32_16x16x32_bf16 v[180:183], v[228:231], v[36:39], v[180:183]
    ds_read_b64_tr_b16 v[226:227], v2 offset:4352
    s_waitcnt lgkmcnt(10)
    v_mfma_f32_16x16x32_bf16 v[168:171], v[232:235], v[32:35], v[168:171]
    ds_read_b64_tr_b16 v[228:229], v3 offset:4096
    s_cmp_eq_u32 s41, s94
    v_mfma_f32_16x16x32_bf16 v[184:187], v[232:235], v[36:39], v[184:187]
    ds_read_b64_tr_b16 v[230:231], v3 offset:4352
    s_cselect_b32 s43, s42, s43
    v_mfma_f32_16x16x32_bf16 v[172:175], v[236:239], v[32:35], v[172:175]
    ds_read_b64_tr_b16 v[232:233], v2 offset:4608
    s_add_u32 s42, s41, s58
    v_mfma_f32_16x16x32_bf16 v[188:191], v[236:239], v[36:39], v[188:191]
    ds_read_b64_tr_b16 v[234:235], v2 offset:4864
    s_waitcnt lgkmcnt(10)
    v_mfma_f32_16x16x32_bf16 v[160:163], v[240:243], v[40:43], v[160:163]
    ds_read_b64_tr_b16 v[236:237], v3 offset:4608
    s_cmp_lt_u32 s41, s94
    v_mfma_f32_16x16x32_bf16 v[176:179], v[240:243], v[44:47], v[176:179]
    ds_read_b64_tr_b16 v[238:239], v3 offset:4864
    s_cselect_b32 s41, s42, s43
    v_mfma_f32_16x16x32_bf16 v[164:167], v[244:247], v[40:43], v[164:167]
    ds_read_b64_tr_b16 v[240:241], v2 offset:5120
    s_mul_i32 s41, s41, 10240
    v_mfma_f32_16x16x32_bf16 v[180:183], v[244:247], v[44:47], v[180:183]
    ds_read_b64_tr_b16 v[242:243], v2 offset:5376
    s_waitcnt lgkmcnt(10)
    v_mfma_f32_16x16x32_bf16 v[168:171], v[248:251], v[40:43], v[168:171]
    ds_read_b64_tr_b16 v[244:245], v3 offset:5120
    s_add_u32 s61, s63, s41
    v_mfma_f32_16x16x32_bf16 v[184:187], v[248:251], v[44:47], v[184:187]
    ds_read_b64_tr_b16 v[246:247], v3 offset:5376
    s_add_u32 s62, s64, s41
    v_mfma_f32_16x16x32_bf16 v[172:175], v[252:255], v[40:43], v[172:175]
    ds_read_b64_tr_b16 v[248:249], v2 offset:5632
    v_mul_f32 v192, v9, v192
    v_mfma_f32_16x16x32_bf16 v[188:191], v[252:255], v[44:47], v[188:191]
    ds_read_b64_tr_b16 v[250:251], v2 offset:5888
    s_waitcnt lgkmcnt(10)
    v_mfma_f32_16x16x32_bf16 v[160:163], v[224:227], v[48:51], v[160:163]
    ds_read_b64_tr_b16 v[252:253], v3 offset:5632
    v_mul_f32 v193, v9, v193
    v_mfma_f32_16x16x32_bf16 v[176:179], v[224:227], v[52:55], v[176:179]
    ds_read_b64_tr_b16 v[254:255], v3 offset:5888
    v_mul_f32 v194, v9, v194
    v_mfma_f32_16x16x32_bf16 v[164:167], v[228:231], v[48:51], v[164:167]
    ds_read_b64_tr_b16 v[224:225], v2 offset:6144
    v_mul_f32 v195, v9, v195
    v_mfma_f32_16x16x32_bf16 v[180:183], v[228:231], v[52:55], v[180:183]
    ds_read_b64_tr_b16 v[226:227], v2 offset:6400
    s_waitcnt lgkmcnt(10)
    v_mfma_f32_16x16x32_bf16 v[168:171], v[232:235], v[48:51], v[168:171]
    ds_read_b64_tr_b16 v[228:229], v3 offset:6144
    v_mul_f32 v196, v9, v196
    v_mfma_f32_16x16x32_bf16 v[184:187], v[232:235], v[52:55], v[184:187]
    ds_read_b64_tr_b16 v[230:231], v3 offset:6400
    v_mul_f32 v197, v9, v197
    v_mfma_f32_16x16x32_bf16 v[172:175], v[236:239], v[48:51], v[172:175]
    ds_read_b64_tr_b16 v[232:233], v2 offset:6656
    v_mul_f32 v198, v9, v198
    v_mfma_f32_16x16x32_bf16 v[188:191], v[236:239], v[52:55], v[188:191]
    ds_read_b64_tr_b16 v[234:235], v2 offset:6912
    s_waitcnt lgkmcnt(10)
    v_mfma_f32_16x16x32_bf16 v[160:163], v[240:243], v[56:59], v[160:163]
    ds_read_b64_tr_b16 v[236:237], v3 offset:6656
    v_mul_f32 v199, v9, v199
    v_mfma_f32_16x16x32_bf16 v[176:179], v[240:243], v[60:63], v[176:179]
    ds_read_b64_tr_b16 v[238:239], v3 offset:6912
    v_mul_f32 v200, v9, v200
    v_mfma_f32_16x16x32_bf16 v[164:167], v[244:247], v[56:59], v[164:167]
    ds_read_b64_tr_b16 v[240:241], v2 offset:7168
    v_mul_f32 v201, v9, v201
    v_mfma_f32_16x16x32_bf16 v[180:183], v[244:247], v[60:63], v[180:183]
    ds_read_b64_tr_b16 v[242:243], v2 offset:7424
    s_waitcnt lgkmcnt(10)
    v_mfma_f32_16x16x32_bf16 v[168:171], v[248:251], v[56:59], v[168:171]
    ds_read_b64_tr_b16 v[244:245], v3 offset:7168
    v_mul_f32 v202, v9, v202
    v_mfma_f32_16x16x32_bf16 v[184:187], v[248:251], v[60:63], v[184:187]
    ds_read_b64_tr_b16 v[246:247], v3 offset:7424
    v_mul_f32 v203, v9, v203
    v_mfma_f32_16x16x32_bf16 v[172:175], v[252:255], v[56:59], v[172:175]
    ds_read_b64_tr_b16 v[248:249], v2 offset:7680
    v_mul_f32 v204, v9, v204
    v_mfma_f32_16x16x32_bf16 v[188:191], v[252:255], v[60:63], v[188:191]
    ds_read_b64_tr_b16 v[250:251], v2 offset:7936
    s_waitcnt lgkmcnt(10)
    v_mfma_f32_16x16x32_bf16 v[160:163], v[224:227], v[64:67], v[160:163]
    ds_read_b64_tr_b16 v[252:253], v3 offset:7680
    v_mul_f32 v205, v9, v205
    v_mfma_f32_16x16x32_bf16 v[176:179], v[224:227], v[68:71], v[176:179]
    ds_read_b64_tr_b16 v[254:255], v3 offset:7936
    v_mul_f32 v206, v9, v206
    v_mfma_f32_16x16x32_bf16 v[164:167], v[228:231], v[64:67], v[164:167]
    ds_read_b64_tr_b16 v[224:225], v2 offset:8192
    v_mul_f32 v207, v9, v207
    v_mfma_f32_16x16x32_bf16 v[180:183], v[228:231], v[68:71], v[180:183]
    ds_read_b64_tr_b16 v[226:227], v2 offset:8448
    s_waitcnt lgkmcnt(10)
    v_mfma_f32_16x16x32_bf16 v[168:171], v[232:235], v[64:67], v[168:171]
    ds_read_b64_tr_b16 v[228:229], v3 offset:8192
    v_mul_f32 v208, v10, v208
    v_mfma_f32_16x16x32_bf16 v[184:187], v[232:235], v[68:71], v[184:187]
    ds_read_b64_tr_b16 v[230:231], v3 offset:8448
    v_mul_f32 v209, v10, v209
    v_mfma_f32_16x16x32_bf16 v[172:175], v[236:239], v[64:67], v[172:175]
    ds_read_b64_tr_b16 v[232:233], v2 offset:8704
    v_mul_f32 v210, v10, v210
    v_mfma_f32_16x16x32_bf16 v[188:191], v[236:239], v[68:71], v[188:191]
    ds_read_b64_tr_b16 v[234:235], v2 offset:8960
    s_waitcnt lgkmcnt(10)
    v_mfma_f32_16x16x32_bf16 v[160:163], v[240:243], v[72:75], v[160:163]
    ds_read_b64_tr_b16 v[236:237], v3 offset:8704
    v_mul_f32 v211, v10, v211
    v_mfma_f32_16x16x32_bf16 v[176:179], v[240:243], v[76:79], v[176:179]
    ds_read_b64_tr_b16 v[238:239], v3 offset:8960
    v_mul_f32 v212, v10, v212
    v_mfma_f32_16x16x32_bf16 v[164:167], v[244:247], v[72:75], v[164:167]
    ds_read_b64_tr_b16 v[240:241], v2 offset:9216
    v_mul_f32 v213, v10, v213
    v_mfma_f32_16x16x32_bf16 v[180:183], v[244:247], v[76:79], v[180:183]
    ds_read_b64_tr_b16 v[242:243], v2 offset:9472
    s_waitcnt lgkmcnt(10)
    v_mfma_f32_16x16x32_bf16 v[168:171], v[248:251], v[72:75], v[168:171]
    ds_read_b64_tr_b16 v[244:245], v3 offset:9216
    v_mul_f32 v214, v10, v214
    v_mfma_f32_16x16x32_bf16 v[184:187], v[248:251], v[76:79], v[184:187]
    ds_read_b64_tr_b16 v[246:247], v3 offset:9472
    v_mul_f32 v215, v10, v215
    v_mfma_f32_16x16x32_bf16 v[172:175], v[252:255], v[72:75], v[172:175]
    ds_read_b64_tr_b16 v[248:249], v2 offset:9728
    v_mul_f32 v216, v10, v216
    v_mfma_f32_16x16x32_bf16 v[188:191], v[252:255], v[76:79], v[188:191]
    ds_read_b64_tr_b16 v[250:251], v2 offset:9984
    s_waitcnt lgkmcnt(10)
    v_mfma_f32_16x16x32_bf16 v[160:163], v[224:227], v[80:83], v[160:163]
    ds_read_b64_tr_b16 v[252:253], v3 offset:9728
    v_mul_f32 v217, v10, v217
    v_mfma_f32_16x16x32_bf16 v[176:179], v[224:227], v[84:87], v[176:179]
    ds_read_b64_tr_b16 v[254:255], v3 offset:9984
    v_mul_f32 v218, v10, v218
    v_mfma_f32_16x16x32_bf16 v[164:167], v[228:231], v[80:83], v[164:167]
    ds_read_b64_tr_b16 v[224:225], v2 offset:10240
    v_mul_f32 v219, v10, v219
    v_mfma_f32_16x16x32_bf16 v[180:183], v[228:231], v[84:87], v[180:183]
    ds_read_b64_tr_b16 v[226:227], v2 offset:10496
    s_waitcnt lgkmcnt(10)
    v_mfma_f32_16x16x32_bf16 v[168:171], v[232:235], v[80:83], v[168:171]
    ds_read_b64_tr_b16 v[228:229], v3 offset:10240
    v_mul_f32 v220, v10, v220
    v_mfma_f32_16x16x32_bf16 v[184:187], v[232:235], v[84:87], v[184:187]
    ds_read_b64_tr_b16 v[230:231], v3 offset:10496
    v_mul_f32 v221, v10, v221
    v_mfma_f32_16x16x32_bf16 v[172:175], v[236:239], v[80:83], v[172:175]
    ds_read_b64_tr_b16 v[232:233], v2 offset:10752
    v_mul_f32 v222, v10, v222
    v_mfma_f32_16x16x32_bf16 v[188:191], v[236:239], v[84:87], v[188:191]
    ds_read_b64_tr_b16 v[234:235], v2 offset:11008
    s_waitcnt lgkmcnt(10)
    v_mfma_f32_16x16x32_bf16 v[160:163], v[240:243], v[88:91], v[160:163]
    ds_read_b64_tr_b16 v[236:237], v3 offset:10752
    v_mul_f32 v223, v10, v223
    v_mfma_f32_16x16x32_bf16 v[176:179], v[240:243], v[92:95], v[176:179]
    ds_read_b64_tr_b16 v[238:239], v3 offset:11008
    v_mfma_f32_16x16x32_bf16 v[164:167], v[244:247], v[88:91], v[164:167]
    ds_read_b64_tr_b16 v[240:241], v2 offset:11264
    v_mfma_f32_16x16x32_bf16 v[180:183], v[244:247], v[92:95], v[180:183]
    ds_read_b64_tr_b16 v[242:243], v2 offset:11520
    s_waitcnt lgkmcnt(10)
    v_mfma_f32_16x16x32_bf16 v[168:171], v[248:251], v[88:91], v[168:171]
    ds_read_b64_tr_b16 v[244:245], v3 offset:11264
    v_mfma_f32_16x16x32_bf16 v[184:187], v[248:251], v[92:95], v[184:187]
    ds_read_b64_tr_b16 v[246:247], v3 offset:11520
    v_mfma_f32_16x16x32_bf16 v[172:175], v[252:255], v[88:91], v[172:175]
    ds_read_b64_tr_b16 v[248:249], v2 offset:11776
    v_mfma_f32_16x16x32_bf16 v[188:191], v[252:255], v[92:95], v[188:191]
    ds_read_b64_tr_b16 v[250:251], v2 offset:12032
    s_waitcnt lgkmcnt(10)
    v_mfma_f32_16x16x32_bf16 v[160:163], v[224:227], v[96:99], v[160:163]
    ds_read_b64_tr_b16 v[252:253], v3 offset:11776
    v_mfma_f32_16x16x32_bf16 v[176:179], v[224:227], v[100:103], v[176:179]
    ds_read_b64_tr_b16 v[254:255], v3 offset:12032
    v_mfma_f32_16x16x32_bf16 v[164:167], v[228:231], v[96:99], v[164:167]
    ds_read_b64_tr_b16 v[224:225], v2 offset:12288
    v_mfma_f32_16x16x32_bf16 v[180:183], v[228:231], v[100:103], v[180:183]
    ds_read_b64_tr_b16 v[226:227], v2 offset:12544
    s_waitcnt lgkmcnt(10)
    v_mfma_f32_16x16x32_bf16 v[168:171], v[232:235], v[96:99], v[168:171]
    ds_read_b64_tr_b16 v[228:229], v3 offset:12288
    v_mfma_f32_16x16x32_bf16 v[184:187], v[232:235], v[100:103], v[184:187]
    ds_read_b64_tr_b16 v[230:231], v3 offset:12544
    v_mfma_f32_16x16x32_bf16 v[172:175], v[236:239], v[96:99], v[172:175]
    ds_read_b64_tr_b16 v[232:233], v2 offset:12800
    v_mfma_f32_16x16x32_bf16 v[188:191], v[236:239], v[100:103], v[188:191]
    ds_read_b64_tr_b16 v[234:235], v2 offset:13056
    s_waitcnt lgkmcnt(10)
    v_mfma_f32_16x16x32_bf16 v[160:163], v[240:243], v[104:107], v[160:163]
    ds_read_b64_tr_b16 v[236:237], v3 offset:12800
    v_mfma_f32_16x16x32_bf16 v[176:179], v[240:243], v[108:111], v[176:179]
    ds_read_b64_tr_b16 v[238:239], v3 offset:13056
    v_mfma_f32_16x16x32_bf16 v[164:167], v[244:247], v[104:107], v[164:167]
    ds_read_b64_tr_b16 v[240:241], v2 offset:13312
    v_mfma_f32_16x16x32_bf16 v[180:183], v[244:247], v[108:111], v[180:183]
    ds_read_b64_tr_b16 v[242:243], v2 offset:13568
    s_waitcnt lgkmcnt(10)
    v_mfma_f32_16x16x32_bf16 v[168:171], v[248:251], v[104:107], v[168:171]
    ds_read_b64_tr_b16 v[244:245], v3 offset:13312
    v_mfma_f32_16x16x32_bf16 v[184:187], v[248:251], v[108:111], v[184:187]
    ds_read_b64_tr_b16 v[246:247], v3 offset:13568
    v_mfma_f32_16x16x32_bf16 v[172:175], v[252:255], v[104:107], v[172:175]
    ds_read_b64_tr_b16 v[248:249], v2 offset:13824
    v_mfma_f32_16x16x32_bf16 v[188:191], v[252:255], v[108:111], v[188:191]
    ds_read_b64_tr_b16 v[250:251], v2 offset:14080
    s_waitcnt lgkmcnt(10)
    v_mfma_f32_16x16x32_bf16 v[160:163], v[224:227], v[112:115], v[160:163]
    ds_read_b64_tr_b16 v[252:253], v3 offset:13824
    v_mfma_f32_16x16x32_bf16 v[176:179], v[224:227], v[116:119], v[176:179]
    ds_read_b64_tr_b16 v[254:255], v3 offset:14080
    v_mfma_f32_16x16x32_bf16 v[164:167], v[228:231], v[112:115], v[164:167]
    ds_read_b64_tr_b16 v[224:225], v2 offset:14336
    v_mfma_f32_16x16x32_bf16 v[180:183], v[228:231], v[116:119], v[180:183]
    ds_read_b64_tr_b16 v[226:227], v2 offset:14592
    s_waitcnt lgkmcnt(10)
    v_mfma_f32_16x16x32_bf16 v[168:171], v[232:235], v[112:115], v[168:171]
    ds_read_b64_tr_b16 v[228:229], v3 offset:14336
    v_mfma_f32_16x16x32_bf16 v[184:187], v[232:235], v[116:119], v[184:187]
    ds_read_b64_tr_b16 v[230:231], v3 offset:14592
    v_mfma_f32_16x16x32_bf16 v[172:175], v[236:239], v[112:115], v[172:175]
    ds_read_b64_tr_b16 v[232:233], v2 offset:14848
    v_mfma_f32_16x16x32_bf16 v[188:191], v[236:239], v[116:119], v[188:191]
    ds_read_b64_tr_b16 v[234:235], v2 offset:15104
    s_waitcnt lgkmcnt(10)
    v_mfma_f32_16x16x32_bf16 v[160:163], v[240:243], v[120:123], v[160:163]
    ds_read_b64_tr_b16 v[236:237], v3 offset:14848
    v_mfma_f32_16x16x32_bf16 v[176:179], v[240:243], v[124:127], v[176:179]
    ds_read_b64_tr_b16 v[238:239], v3 offset:15104
    v_mfma_f32_16x16x32_bf16 v[164:167], v[244:247], v[120:123], v[164:167]
    ds_read_b64_tr_b16 v[240:241], v2 offset:15360
    v_mfma_f32_16x16x32_bf16 v[180:183], v[244:247], v[124:127], v[180:183]
    ds_read_b64_tr_b16 v[242:243], v2 offset:15616
    s_waitcnt lgkmcnt(10)
    v_mfma_f32_16x16x32_bf16 v[168:171], v[248:251], v[120:123], v[168:171]
    ds_read_b64_tr_b16 v[244:245], v3 offset:15360
    v_mfma_f32_16x16x32_bf16 v[184:187], v[248:251], v[124:127], v[184:187]
    ds_read_b64_tr_b16 v[246:247], v3 offset:15616
    v_mfma_f32_16x16x32_bf16 v[172:175], v[252:255], v[120:123], v[172:175]
    ds_read_b64_tr_b16 v[248:249], v2 offset:15872
    v_mfma_f32_16x16x32_bf16 v[188:191], v[252:255], v[124:127], v[188:191]
    ds_read_b64_tr_b16 v[250:251], v2 offset:16128
    s_waitcnt lgkmcnt(10)
    v_mfma_f32_16x16x32_bf16 v[160:163], v[224:227], v[128:131], v[160:163]
    ds_read_b64_tr_b16 v[252:253], v3 offset:15872
    v_mfma_f32_16x16x32_bf16 v[176:179], v[224:227], v[132:135], v[176:179]
    ds_read_b64_tr_b16 v[254:255], v3 offset:16128
    v_mfma_f32_16x16x32_bf16 v[164:167], v[228:231], v[128:131], v[164:167]
    ds_read_b64_tr_b16 v[224:225], v2 offset:16384
    v_mfma_f32_16x16x32_bf16 v[180:183], v[228:231], v[132:135], v[180:183]
    ds_read_b64_tr_b16 v[226:227], v2 offset:16640
    s_waitcnt lgkmcnt(10)
    v_mfma_f32_16x16x32_bf16 v[168:171], v[232:235], v[128:131], v[168:171]
    ds_read_b64_tr_b16 v[228:229], v3 offset:16384
    v_mfma_f32_16x16x32_bf16 v[184:187], v[232:235], v[132:135], v[184:187]
    ds_read_b64_tr_b16 v[230:231], v3 offset:16640
    v_mfma_f32_16x16x32_bf16 v[172:175], v[236:239], v[128:131], v[172:175]
    ds_read_b64_tr_b16 v[232:233], v2 offset:16896
    v_mfma_f32_16x16x32_bf16 v[188:191], v[236:239], v[132:135], v[188:191]
    ds_read_b64_tr_b16 v[234:235], v2 offset:17152
    s_waitcnt lgkmcnt(10)
    v_mfma_f32_16x16x32_bf16 v[160:163], v[240:243], v[136:139], v[160:163]
    ds_read_b64_tr_b16 v[236:237], v3 offset:16896
    v_mfma_f32_16x16x32_bf16 v[176:179], v[240:243], v[140:143], v[176:179]
    ds_read_b64_tr_b16 v[238:239], v3 offset:17152
    v_mfma_f32_16x16x32_bf16 v[164:167], v[244:247], v[136:139], v[164:167]
    ds_read_b64_tr_b16 v[240:241], v2 offset:17408
    v_mfma_f32_16x16x32_bf16 v[180:183], v[244:247], v[140:143], v[180:183]
    ds_read_b64_tr_b16 v[242:243], v2 offset:17664
    s_waitcnt lgkmcnt(10)
    v_mfma_f32_16x16x32_bf16 v[168:171], v[248:251], v[136:139], v[168:171]
    ds_read_b64_tr_b16 v[244:245], v3 offset:17408
    v_mfma_f32_16x16x32_bf16 v[184:187], v[248:251], v[140:143], v[184:187]
    ds_read_b64_tr_b16 v[246:247], v3 offset:17664
    v_mfma_f32_16x16x32_bf16 v[172:175], v[252:255], v[136:139], v[172:175]
    ds_read_b64_tr_b16 v[248:249], v2 offset:17920
    v_mfma_f32_16x16x32_bf16 v[188:191], v[252:255], v[140:143], v[188:191]
    ds_read_b64_tr_b16 v[250:251], v2 offset:18176
    s_waitcnt lgkmcnt(10)
    v_mfma_f32_16x16x32_bf16 v[160:163], v[224:227], v[144:147], v[160:163]
    ds_read_b64_tr_b16 v[252:253], v3 offset:17920
    v_mfma_f32_16x16x32_bf16 v[176:179], v[224:227], v[148:151], v[176:179]
    ds_read_b64_tr_b16 v[254:255], v3 offset:18176
    ds_append v14 offset:64
    v_mfma_f32_16x16x32_bf16 v[164:167], v[228:231], v[144:147], v[164:167]
    v_mfma_f32_16x16x32_bf16 v[180:183], v[228:231], v[148:151], v[180:183]
    s_waitcnt lgkmcnt(9)
    v_mfma_f32_16x16x32_bf16 v[168:171], v[232:235], v[144:147], v[168:171]
    v_mfma_f32_16x16x32_bf16 v[184:187], v[232:235], v[148:151], v[184:187]
    v_mfma_f32_16x16x32_bf16 v[172:175], v[236:239], v[144:147], v[172:175]
    v_mfma_f32_16x16x32_bf16 v[188:191], v[236:239], v[148:151], v[188:191]
    s_waitcnt lgkmcnt(5)
    v_mfma_f32_16x16x32_bf16 v[160:163], v[240:243], v[152:155], v[160:163]
    v_mfma_f32_16x16x32_bf16 v[176:179], v[240:243], v[156:159], v[176:179]
    v_mfma_f32_16x16x32_bf16 v[164:167], v[244:247], v[152:155], v[164:167]
    v_mfma_f32_16x16x32_bf16 v[180:183], v[244:247], v[156:159], v[180:183]
    s_waitcnt lgkmcnt(1)
    v_mfma_f32_16x16x32_bf16 v[168:171], v[248:251], v[152:155], v[168:171]
    v_mfma_f32_16x16x32_bf16 v[184:187], v[248:251], v[156:159], v[184:187]
    v_mfma_f32_16x16x32_bf16 v[172:175], v[252:255], v[152:155], v[172:175]
    v_mfma_f32_16x16x32_bf16 v[188:191], v[252:255], v[156:159], v[188:191]
    s_load_dword s3, s[12:13], 0
    v_lshrrev_b32 v2, 4, v1
    s_lshl_b32 s40, s38, 1
    s_sub_u32 s40, s40, 2
    v_add_u32 v2, s40, v2
    v_max_i32 v2, 0, v2
    v_and_b32 v3, 15, v1
    v_lshl_add_u32 v2, v2, 6, v3
    v_lshlrev_b32 v2, 2, v2
    v_add_u32 v2, 29454336, v2
    s_setprio 3
    buffer_load_dword v3, v2, s[32:35], 0 offen sc1
    v_mul_f32 v160, v192, v160
    v_mul_f32 v161, v193, v161
    v_mul_f32 v162, v194, v162
    v_mul_f32 v163, v195, v163
    v_mul_f32 v164, v196, v164
    v_mul_f32 v165, v197, v165
    v_mul_f32 v166, v198, v166
    v_mul_f32 v167, v199, v167
    v_mul_f32 v168, v200, v168
    v_mul_f32 v169, v201, v169
    v_mul_f32 v170, v202, v170
    v_mul_f32 v171, v203, v171
    v_mul_f32 v172, v204, v172
    v_mul_f32 v173, v205, v173
    v_mul_f32 v174, v206, v174
    v_mul_f32 v175, v207, v175
    v_mul_f32 v176, v208, v176
    v_mul_f32 v177, v209, v177
    v_mul_f32 v178, v210, v178
    v_mul_f32 v179, v211, v179
    v_mul_f32 v180, v212, v180
    v_mul_f32 v181, v213, v181
    v_mul_f32 v182, v214, v182
    v_mul_f32 v183, v215, v183
    v_mul_f32 v184, v216, v184
    v_mul_f32 v185, v217, v185
    v_mul_f32 v186, v218, v186
    v_mul_f32 v187, v219, v187
    v_mul_f32 v188, v220, v188
    v_mul_f32 v189, v221, v189
    v_mul_f32 v190, v222, v190
    v_mul_f32 v191, v223, v191
    v_cvt_pk_bf16_f32 v160, v160, v161
    v_cvt_pk_bf16_f32 v161, v162, v163
    v_cvt_pk_bf16_f32 v162, v164, v165
    v_cvt_pk_bf16_f32 v163, v166, v167
    buffer_store_dwordx4 v[160:163], v6, s[32:35], s61 offen sc1
    v_cvt_pk_bf16_f32 v168, v168, v169
    v_cvt_pk_bf16_f32 v169, v170, v171
    v_cvt_pk_bf16_f32 v170, v172, v173
    v_cvt_pk_bf16_f32 v171, v174, v175
    s_add_u32 s66, s61, 5120
    buffer_store_dwordx4 v[168:171], v6, s[32:35], s66 offen sc1
    v_cvt_pk_bf16_f32 v176, v176, v177
    v_cvt_pk_bf16_f32 v177, v178, v179
    v_cvt_pk_bf16_f32 v178, v180, v181
    v_cvt_pk_bf16_f32 v179, v182, v183
    buffer_store_dwordx4 v[176:179], v6, s[32:35], s62 offen sc1
    v_cvt_pk_bf16_f32 v184, v184, v185
    v_cvt_pk_bf16_f32 v185, v186, v187
    v_cvt_pk_bf16_f32 v186, v188, v189
    v_cvt_pk_bf16_f32 v187, v190, v191
    s_add_u32 s66, s62, 5120
    buffer_store_dwordx4 v[184:187], v6, s[32:35], s66 offen sc1
    s_mov_b32 s69, 4096
    s_branch L_attn
L_attn:
    s_mov_b32 s8, s69
    s_add_u32 s11, s91, 8192
    s_waitcnt lgkmcnt(0)
    s_mov_b32 s47, 100000
    s_sub_u32 s40, s92, s3
    s_cmp_gt_i32 s40, 2000
    s_cselect_b32 s3, 0, s3
L_tg2:
    s_cmp_lg_u32 s3, 0
    s_cbranch_scc1 L_tg2_ok
    s_sub_u32 s47, s47, 1
    s_cbranch_scc1 L_tg2_ok
    s_load_dword s3, s[12:13], 0 glc
    s_waitcnt lgkmcnt(0)
    s_sleep 8
    s_branch L_tg2
L_tg2_ok:
    v_mov_b32 v10, 64
    s_movk_i32 s41, 256
L_w1:
    ds_read_b32 v11, v10
    s_waitcnt lgkmcnt(0)
    v_cmp_gt_u32 vcc, s41, v11
    s_cbranch_vccz L_w1_ok
    s_branch L_w1
L_w1_ok:
    s_waitcnt vmcnt(4)
    s_mov_b32 s47, 100000
L_fq:
    v_cmp_ne_u32 vcc, s3, v3
    s_cbranch_vccz L_fq_ok
    s_sub_u32 s47, s47, 1
    s_cbranch_scc1 L_fq_ok
    s_sleep 16
    buffer_load_dword v3, v2, s[32:35], 0 offen sc1
    s_waitcnt vmcnt(0)
    s_branch L_fq
L_fq_ok:
    s_mul_i32 s40, s39, 18
    s_lshr_b32 s4, s40, 4
    s_and_b32 s5, s40, 15
    v_lshlrev_b32 v2, 4, v1
    s_lshr_b32 s7, s5, 3
    s_lshl_b32 s7, s7, 9
    s_add_u32 s6, s8, s7
    s_lshl_b32 s40, s38, 3
    s_lshl_b32 s41, s37, 2
    s_add_u32 s41, s41, 0
    s_add_u32 s40, s40, s41
    s_sub_i32 s40, s40, 8
    s_max_i32 s40, s40, 0
    s_mul_i32 s40, s40, 108
    s_add_u32 s40, s40, s4
    s_lshl_b32 s40, s40, 10
    s_add_u32 s40, s40, s7
    s_add_u32 s42, s40, 22401024
    s_add_u32 s43, s40, 22437888
    s_lshl_b32 s41, s41, 12
    s_add_u32 m0, s41, s6
    s_add_u32 s41, s41, 2048
    buffer_load_dwordx4 v2, s[32:35], s42 offen sc1 lds
    s_mov_b32 exec_hi, 0
    buffer_load_dwordx4 v2, s[32:35], s42 offen offset:1024 sc1 lds
    s_add_u32 m0, s41, s6
    s_nop 0
    buffer_load_dwordx4 v2, s[32:35], s43 offen offset:1024 sc1 lds
    s_mov_b32 exec_hi, -1
    buffer_load_dwordx4 v2, s[32:35], s43 offen sc1 lds
    s_lshl_b32 s40, s38, 3
    s_lshl_b32 s41, s37, 2
    s_add_u32 s41, s41, 1
    s_add_u32 s40, s40, s41
    s_sub_i32 s40, s40, 8
    s_max_i32 s40, s40, 0
    s_mul_i32 s40, s40, 108
    s_add_u32 s40, s40, s4
    s_lshl_b32 s40, s40, 10
    s_add_u32 s40, s40, s7
    s_add_u32 s42, s40, 22401024
    s_add_u32 s43, s40, 22437888
    s_lshl_b32 s41, s41, 12
    s_add_u32 m0, s41, s6
    s_add_u32 s41, s41, 2048
    buffer_load_dwordx4 v2, s[32:35], s42 offen sc1 lds
    s_mov_b32 exec_hi, 0
    buffer_load_dwordx4 v2, s[32:35], s42 offen offset:1024 sc1 lds
    s_add_u32 m0, s41, s6
    s_nop 0
    buffer_load_dwordx4 v2, s[32:35], s43 offen offset:1024 sc1 lds
    s_mov_b32 exec_hi, -1
    buffer_load_dwordx4 v2, s[32:35], s43 offen sc1 lds
    s_lshl_b32 s40, s38, 3
    s_lshl_b32 s41, s37, 2
    s_add_u32 s41, s41, 2
    s_add_u32 s40, s40, s41
    s_sub_i32 s40, s40, 8
    s_max_i32 s40, s40, 0
    s_mul_i32 s40, s40, 108
    s_add_u32 s40, s40, s4
    s_lshl_b32 s40, s40, 10
    s_add_u32 s40, s40, s7
    s_add_u32 s42, s40, 22401024
    s_add_u32 s43, s40, 22437888
    s_lshl_b32 s41, s41, 12
    s_add_u32 m0, s41, s6
    s_add_u32 s41, s41, 2048
    buffer_load_dwordx4 v2, s[32:35], s42 offen sc1 lds
    s_mov_b32 exec_hi, 0
    buffer_load_dwordx4 v2, s[32:35], s42 offen offset:1024 sc1 lds
    s_add_u32 m0, s41, s6
    s_nop 0
    buffer_load_dwordx4 v2, s[32:35], s43 offen offset:1024 sc1 lds
    s_mov_b32 exec_hi, -1
    buffer_load_dwordx4 v2, s[32:35], s43 offen sc1 lds
    s_lshl_b32 s40, s38, 3
    s_lshl_b32 s41, s37, 2
    s_add_u32 s41, s41, 3
    s_add_u32 s40, s40, s41
    s_sub_i32 s40, s40, 8
    s_max_i32 s40, s40, 0
    s_mul_i32 s40, s40, 108
    s_add_u32 s40, s40, s4
    s_lshl_b32 s40, s40, 10
    s_add_u32 s40, s40, s7
    s_add_u32 s42, s40, 22401024
    s_add_u32 s43, s40, 22437888
    s_lshl_b32 s41, s41, 12
    s_add_u32 m0, s41, s6
    s_add_u32 s41, s41, 2048
    buffer_load_dwordx4 v2, s[32:35], s42 offen sc1 lds
    s_mov_b32 exec_hi, 0
    buffer_load_dwordx4 v2, s[32:35], s42 offen offset:1024 sc1 lds
    s_add_u32 m0, s41, s6
    s_nop 0
    buffer_load_dwordx4 v2, s[32:35], s43 offen offset:1024 sc1 lds
    s_mov_b32 exec_hi, -1
    buffer_load_dwordx4 v2, s[32:35], s43 offen sc1 lds
    s_lshl_b32 s40, s38, 3
    s_lshl_b32 s41, s37, 1
    s_add_u32 s40, s40, s41
    s_lshl_b32 s10, s40, 1
    s_mul_i32 s40, s40, 108
    s_add_u32 s40, s40, s4
    s_lshl_b32 s40, s40, 10
    s_add_u32 s40, s40, 22364160
    s_add_u32 s41, s40, 110592
    buffer_load_dwordx4 v[176:179], v2, s[32:35], s40 offen offset:0 sc1
    buffer_load_dwordx4 v[180:183], v2, s[32:35], s40 offen offset:1024 sc1
    buffer_load_dwordx4 v[184:187], v2, s[32:35], s41 offen offset:0 sc1
    buffer_load_dwordx4 v[188:191], v2, s[32:35], s41 offen offset:1024 sc1
    v_lshrrev_b32 v10, 5, v1
    v_lshlrev_b32 v10, 2, v10
    v_and_b32 v11, 31, v1
    v_sub_u32 v12, v11, v10
    v_cmp_le_i32 s[52:53], 0, v12
    v_cmp_le_i32 s[54:55], 1, v12
    v_cmp_le_i32 s[56:57], 2, v12
    v_cmp_le_i32 s[58:59], 3, v12
    v_cmp_le_i32 s[60:61], 8, v12
    v_cmp_le_i32 s[62:63], 9, v12
    v_cmp_le_i32 s[64:65], 10, v12
    v_cmp_le_i32 s[66:67], 11, v12
    v_cmp_le_i32 s[68:69], 16, v12
    v_cmp_le_i32 s[70:71], 17, v12
    v_cmp_le_i32 s[72:73], 18, v12
    v_cmp_le_i32 s[74:75], 19, v12
    v_cmp_le_i32 s[76:77], 24, v12
    v_cmp_le_i32 s[78:79], 25, v12
    v_cmp_le_i32 s[80:81], 26, v12
    v_cmp_le_i32 s[82:83], 27, v12
    v_lshlrev_b32 v12, 1, v10
    v_subrev_u32 v12, s5, v12
    v_add_u32 v13, 0, v12
    v_cmp_gt_u32 s[84:85], 18, v13
    v_add_u32 v13, 2, v12
    v_cmp_gt_u32 s[86:87], 18, v13
    v_add_u32 v13, 4, v12
    v_cmp_gt_u32 s[88:89], 18, v13
    v_add_u32 v13, 6, v12
    v_cmp_gt_u32 s[90:91], 18, v13
    v_add_u32 v13, 16, v12
    v_cmp_gt_u32 s[92:93], 18, v13
    v_add_u32 v13, 18, v12
    v_cmp_gt_u32 s[94:95], 18, v13
    v_add_u32 v13, 20, v12
    v_cmp_gt_u32 s[96:97], 18, v13
    v_add_u32 v13, 22, v12
    v_cmp_gt_u32 s[98:99], 18, v13
    s_lshl_b32 s42, s37, 13
    s_add_u32 s42, s42, s8
    v_add_u32 v3, s42, v2
    s_lshr_b32 s43, s5, 2
    v_bfe_u32 v13, v1, 4, 1
    v_and_b32 v14, 3, v1
    v_lshl_add_u32 v13, v13, 2, v14
    v_min_u32 v13, 5, v13
    v_add_u32 v13, s43, v13
    v_bfe_u32 v14, v13, 1, 2
    v_lshlrev_b32 v14, 9, v14
    v_and_b32 v13, 1, v13
    v_lshl_add_u32 v13, v13, 3, v14
    v_bfe_u32 v14, v1, 2, 2
    v_add_u32 v14, v14, v10
    v_lshl_add_u32 v13, v14, 4, v13
    v_add_u32 v4, s42, v13
    s_mul_i32 s40, s39, 3
    v_lshrrev_b32 v13, 5, v1
    v_add_u32 v13, s40, v13
    v_lshrrev_b32 v14, 2, v13
    v_mul_u32_u24 v14, 5120, v14
    v_and_b32 v13, 3, v13
    v_lshl_add_u32 v13, v13, 8, v14
    v_and_b32 v14, 15, v1
    v_lshl_add_u32 v7, v14, 4, v13
    s_add_u32 s41, s40, 2
    s_lshr_b32 s7, s41, 2
    s_lshr_b32 s6, s40, 2
    s_sub_u32 s7, s7, s6
    s_mul_i32 s7, s7, 4096
    s_add_u32 s7, s7, 737792
    v_mov_b32 v6, 0xff800000
    v_mov_b32 v228, 0x3eae1a93
    s_add_u32 s43, s43, 5
    s_bfe_u32 s40, s43, 0x20001
    s_lshl_b32 s40, s40, 9
    s_and_b32 s41, s43, 1
    s_lshl_b32 s41, s41, 3
    s_add_u32 s40, s40, s41
    s_lshl_b32 s41, s37, 14
    s_add_u32 s40, s40, s41
    s_add_u32 s40, s40, s8
    s_add_u32 s40, s40, 2048
    v_lshlrev_b32 v13, 4, v11
    v_add3_u32 v13, v13, v10, s40
    v_mov_b32 v14, 0x3f803f80
    v_mov_b32 v9, 40
    v_mov_b32 v224, 1
    s_lshl_b32 s6, s37, 1
    s_sub_u32 s6, 8, s6
    s_cmp_lg_u32 s38, 0
    s_cselect_b32 s6, 0, s6
    s_waitcnt vmcnt(0)
    ds_write_b32 v13, v14 offset:0
    ds_write_b32 v13, v14 offset:4096
    ds_write_b32 v13, v14 offset:8192
    ds_write_b32 v13, v14 offset:12288
    v_mov_b32 v13, s11
    v_mov_b32 v12, s3
    s_mov_b64 exec, 1
    ds_add_rtn_u32 v226, v9, v224
    s_waitcnt lgkmcnt(0)
    v_readfirstlane_b32 s40, v226
    s_cmp_lg_u32 s40, 3
    s_cbranch_scc1 L_nol3
    buffer_store_dword v12, v13, s[32:35], 0 offen sc1
L_nol3:
    s_mov_b64 exec, -1
    v_cndmask_b32 v176, 0, v176, s[84:85]
    v_cndmask_b32 v177, 0, v177, s[86:87]
    v_cndmask_b32 v178, 0, v178, s[88:89]
    v_cndmask_b32 v179, 0, v179, s[90:91]
    v_cndmask_b32 v180, 0, v180, s[92:93]
    v_cndmask_b32 v181, 0, v181, s[94:95]
    v_cndmask_b32 v182, 0, v182, s[96:97]
    v_cndmask_b32 v183, 0, v183, s[98:99]
    v_cndmask_b32 v184, 0, v184, s[84:85]
    v_cndmask_b32 v185, 0, v185, s[86:87]
    v_cndmask_b32 v186, 0, v186, s[88:89]
    v_cndmask_b32 v187, 0, v187, s[90:91]
    v_cndmask_b32 v188, 0, v188, s[92:93]
    v_cndmask_b32 v189, 0, v189, s[94:95]
    v_cndmask_b32 v190, 0, v190, s[96:97]
    v_cndmask_b32 v191, 0, v191, s[98:99]
    s_bitcmp1_b32 s39, 0
    s_cselect_b32 s84, 0, -1
    s_mov_b32 s85, -1
    s_cselect_b64 s[86:87], -1, 0
    s_mov_b32 s9, 0
L_wa:
    ds_read_b32 v224, v9
    s_waitcnt lgkmcnt(0)
    v_cmp_gt_u32 vcc, 4, v224
    s_cbranch_vccz L_wa_ok
    s_sleep 1
    s_branch L_wa
L_wa_ok:
    s_setprio 3
L_aq:
    ds_read_b128 v[192:195], v3 offset:0
    ds_read_b128 v[196:199], v3 offset:1024
    ds_read_b128 v[200:203], v3 offset:4096
    ds_read_b128 v[204:207], v3 offset:5120
    ds_read_b128 v[232:235], v3 offset:8192
    ds_read_b128 v[236:239], v3 offset:9216
    s_waitcnt lgkmcnt(4)
    v_mfma_f32_32x32x16_bf16 v[16:31], v[192:195], v[176:179], 0
    v_mfma_f32_32x32x16_bf16 v[16:31], v[196:199], v[180:183], v[16:31]
    ds_read_b128 v[192:195], v3 offset:12288
    ds_read_b128 v[196:199], v3 offset:13312
    s_waitcnt lgkmcnt(4)
    v_mfma_f32_32x32x16_bf16 v[32:47], v[200:203], v[176:179], 0
    v_mfma_f32_32x32x16_bf16 v[32:47], v[204:207], v[180:183], v[32:47]
    ds_read_b128 v[200:203], v3 offset:16384
    ds_read_b128 v[204:207], v3 offset:17408
    s_waitcnt lgkmcnt(4)
    v_mfma_f32_32x32x16_bf16 v[48:63], v[232:235], v[176:179], 0
    v_mfma_f32_32x32x16_bf16 v[48:63], v[236:239], v[180:183], v[48:63]
    s_nop 1
    v_cndmask_b32 v16, v16, v6, s[52:53]
    v_cndmask_b32 v17, v17, v6, s[54:55]
    v_cndmask_b32 v18, v18, v6, s[56:57]
    v_cndmask_b32 v19, v19, v6, s[58:59]
    v_cndmask_b32 v20, v20, v6, s[60:61]
    v_cndmask_b32 v21, v21, v6, s[62:63]
    v_cndmask_b32 v22, v22, v6, s[64:65]
    v_cndmask_b32 v23, v23, v6, s[66:67]
    v_cndmask_b32 v24, v24, v6, s[68:69]
    v_cndmask_b32 v25, v25, v6, s[70:71]
    v_cndmask_b32 v26, v26, v6, s[72:73]
    v_cndmask_b32 v27, v27, v6, s[74:75]
    v_cndmask_b32 v28, v28, v6, s[76:77]
    v_cndmask_b32 v29, v29, v6, s[78:79]
    v_cndmask_b32 v30, v30, v6, s[80:81]
    v_cndmask_b32 v31, v31, v6, s[82:83]
    s_cmp_le_u32 s6, 0
    s_cbranch_scc1 L_inv_1
    v_mov_b32 v16, v6
    v_mov_b32 v17, v6
    v_mov_b32 v18, v6
    v_mov_b32 v19, v6
    v_mov_b32 v20, v6
    v_mov_b32 v21, v6
    v_mov_b32 v22, v6
    v_mov_b32 v23, v6
    v_mov_b32 v24, v6
    v_mov_b32 v25, v6
    v_mov_b32 v26, v6
    v_mov_b32 v27, v6
    v_mov_b32 v28, v6
    v_mov_b32 v29, v6
    v_mov_b32 v30, v6
    v_mov_b32 v31, v6
L_inv_1:
    v_max_f32 v224, v16, v17
    v_max_f32 v226, v18, v19
    v_max3_f32 v224, v20, v21, v224
    v_max3_f32 v226, v22, v23, v226
    v_max3_f32 v224, v24, v25, v224
    v_max3_f32 v226, v26, v27, v226
    v_max3_f32 v224, v28, v29, v224
    v_max3_f32 v226, v30, v31, v226
    ds_read_b128 v[232:235], v3 offset:20480
    ds_read_b128 v[236:239], v3 offset:21504
    s_waitcnt lgkmcnt(4)
    v_mfma_f32_32x32x16_bf16 v[64:79], v[192:195], v[176:179], 0
    v_mfma_f32_32x32x16_bf16 v[64:79], v[196:199], v[180:183], v[64:79]
    s_cmp_le_u32 s6, 1
    s_cbranch_scc1 L_inv_2
    v_mov_b32 v32, v6
    v_mov_b32 v33, v6
    v_mov_b32 v34, v6
    v_mov_b32 v35, v6
    v_mov_b32 v36, v6
    v_mov_b32 v37, v6
    v_mov_b32 v38, v6
    v_mov_b32 v39, v6
    v_mov_b32 v40, v6
    v_mov_b32 v41, v6
    v_mov_b32 v42, v6
    v_mov_b32 v43, v6
    v_mov_b32 v44, v6
    v_mov_b32 v45, v6
    v_mov_b32 v46, v6
    v_mov_b32 v47, v6
L_inv_2:
    v_max3_f32 v224, v32, v33, v224
    v_max3_f32 v226, v34, v35, v226
    v_max3_f32 v224, v36, v37, v224
    v_max3_f32 v226, v38, v39, v226
    v_max3_f32 v224, v40, v41, v224
    v_max3_f32 v226, v42, v43, v226
    v_max3_f32 v224, v44, v45, v224
    v_max3_f32 v226, v46, v47, v226
    ds_read_b128 v[192:195], v3 offset:24576
    ds_read_b128 v[196:199], v3 offset:25600
    s_waitcnt lgkmcnt(4)
    v_mfma_f32_32x32x16_bf16 v[80:95], v[200:203], v[176:179], 0
    v_mfma_f32_32x32x16_bf16 v[80:95], v[204:207], v[180:183], v[80:95]
    s_cmp_le_u32 s6, 2
    s_cbranch_scc1 L_inv_3
    v_mov_b32 v48, v6
    v_mov_b32 v49, v6
    v_mov_b32 v50, v6
    v_mov_b32 v51, v6
    v_mov_b32 v52, v6
    v_mov_b32 v53, v6
    v_mov_b32 v54, v6
    v_mov_b32 v55, v6
    v_mov_b32 v56, v6
    v_mov_b32 v57, v6
    v_mov_b32 v58, v6
    v_mov_b32 v59, v6
    v_mov_b32 v60, v6
    v_mov_b32 v61, v6
    v_mov_b32 v62, v6
    v_mov_b32 v63, v6
L_inv_3:
    v_max3_f32 v224, v48, v49, v224
    v_max3_f32 v226, v50, v51, v226
    v_max3_f32 v224, v52, v53, v224
    v_max3_f32 v226, v54, v55, v226
    v_max3_f32 v224, v56, v57, v224
    v_max3_f32 v226, v58, v59, v226
    v_max3_f32 v224, v60, v61, v224
    v_max3_f32 v226, v62, v63, v226
    ds_read_b128 v[200:203], v3 offset:28672
    ds_read_b128 v[204:207], v3 offset:29696
    s_waitcnt lgkmcnt(4)
    v_mfma_f32_32x32x16_bf16 v[96:111], v[232:235], v[176:179], 0
    v_mfma_f32_32x32x16_bf16 v[96:111], v[236:239], v[180:183], v[96:111]
    s_cmp_le_u32 s6, 3
    s_cbranch_scc1 L_inv_4
    v_mov_b32 v64, v6
    v_mov_b32 v65, v6
    v_mov_b32 v66, v6
    v_mov_b32 v67, v6
    v_mov_b32 v68, v6
    v_mov_b32 v69, v6
    v_mov_b32 v70, v6
    v_mov_b32 v71, v6
    v_mov_b32 v72, v6
    v_mov_b32 v73, v6
    v_mov_b32 v74, v6
    v_mov_b32 v75, v6
    v_mov_b32 v76, v6
    v_mov_b32 v77, v6
    v_mov_b32 v78, v6
    v_mov_b32 v79, v6
L_inv_4:
    v_max3_f32 v224, v64, v65, v224
    v_max3_f32 v226, v66, v67, v226
    v_max3_f32 v224, v68, v69, v224
    v_max3_f32 v226, v70, v71, v226
    v_max3_f32 v224, v72, v73, v224
    v_max3_f32 v226, v74, v75, v226
    v_max3_f32 v224, v76, v77, v224
    v_max3_f32 v226, v78, v79, v226
    ds_read_b128 v[232:235], v3 offset:32768
    ds_read_b128 v[236:239], v3 offset:33792
    s_waitcnt lgkmcnt(4)
    v_mfma_f32_32x32x16_bf16 v[112:127], v[192:195], v[176:179], 0
    v_mfma_f32_32x32x16_bf16 v[112:127], v[196:199], v[180:183], v[112:127]
    s_cmp_le_u32 s6, 4
    s_cbranch_scc1 L_inv_5
    v_mov_b32 v80, v6
    v_mov_b32 v81, v6
    v_mov_b32 v82, v6
    v_mov_b32 v83, v6
    v_mov_b32 v84, v6
    v_mov_b32 v85, v6
    v_mov_b32 v86, v6
    v_mov_b32 v87, v6
    v_mov_b32 v88, v6
    v_mov_b32 v89, v6
    v_mov_b32 v90, v6
    v_mov_b32 v91, v6
    v_mov_b32 v92, v6
    v_mov_b32 v93, v6
    v_mov_b32 v94, v6
    v_mov_b32 v95, v6
L_inv_5:
    v_max3_f32 v224, v80, v81, v224
    v_max3_f32 v226, v82, v83, v226
    v_max3_f32 v224, v84, v85, v224
    v_max3_f32 v226, v86, v87, v226
    v_max3_f32 v224, v88, v89, v224
    v_max3_f32 v226, v90, v91, v226
    v_max3_f32 v224, v92, v93, v224
    v_max3_f32 v226, v94, v95, v226
    s_waitcnt lgkmcnt(2)
    v_mfma_f32_32x32x16_bf16 v[128:143], v[200:203], v[176:179], 0
    v_mfma_f32_32x32x16_bf16 v[128:143], v[204:207], v[180:183], v[128:143]
    s_cmp_le_u32 s6, 5
    s_cbranch_scc1 L_inv_6
    v_mov_b32 v96, v6
    v_mov_b32 v97, v6
    v_mov_b32 v98, v6
    v_mov_b32 v99, v6
    v_mov_b32 v100, v6
    v_mov_b32 v101, v6
    v_mov_b32 v102, v6
    v_mov_b32 v103, v6
    v_mov_b32 v104, v6
    v_mov_b32 v105, v6
    v_mov_b32 v106, v6
    v_mov_b32 v107, v6
    v_mov_b32 v108, v6
    v_mov_b32 v109, v6
    v_mov_b32 v110, v6
    v_mov_b32 v111, v6
L_inv_6:
    v_max3_f32 v224, v96, v97, v224
    v_max3_f32 v226, v98, v99, v226
    v_max3_f32 v224, v100, v101, v224
    v_max3_f32 v226, v102, v103, v226
    v_max3_f32 v224, v104, v105, v224
    v_max3_f32 v226, v106, v107, v226
    v_max3_f32 v224, v108, v109, v224
    v_max3_f32 v226, v110, v111, v226
    s_waitcnt lgkmcnt(0)
    v_mfma_f32_32x32x16_bf16 v[144:159], v[232:235], v[176:179], 0
    v_mfma_f32_32x32x16_bf16 v[144:159], v[236:239], v[180:183], v[144:159]
    s_cmp_le_u32 s6, 6
    s_cbranch_scc1 L_inv_7
    v_mov_b32 v112, v6
    v_mov_b32 v113, v6
    v_mov_b32 v114, v6
    v_mov_b32 v115, v6
    v_mov_b32 v116, v6
    v_mov_b32 v117, v6
    v_mov_b32 v118, v6
    v_mov_b32 v119, v6
    v_mov_b32 v120, v6
    v_mov_b32 v121, v6
    v_mov_b32 v122, v6
    v_mov_b32 v123, v6
    v_mov_b32 v124, v6
    v_mov_b32 v125, v6
    v_mov_b32 v126, v6
    v_mov_b32 v127, v6
L_inv_7:
    v_max3_f32 v224, v112, v113, v224
    v_max3_f32 v226, v114, v115, v226
    v_max3_f32 v224, v116, v117, v224
    v_max3_f32 v226, v118, v119, v226
    v_max3_f32 v224, v120, v121, v224
    v_max3_f32 v226, v122, v123, v226
    v_max3_f32 v224, v124, v125, v224
    v_max3_f32 v226, v126, v127, v226
    ds_read_b64_tr_b16 v[208:209], v4 offset:2048
    ds_read_b64_tr_b16 v[210:211], v4 offset:2176
    ds_read_b64_tr_b16 v[212:213], v4 offset:2304
    ds_read_b64_tr_b16 v[214:215], v4 offset:2432
    ds_read_b64_tr_b16 v[216:217], v4 offset:6144
    ds_read_b64_tr_b16 v[218:219], v4 offset:6272
    ds_read_b64_tr_b16 v[220:221], v4 offset:6400
    ds_read_b64_tr_b16 v[222:223], v4 offset:6528
    s_cmp_le_u32 s6, 7
    s_cbranch_scc1 L_inv_8
    v_mov_b32 v128, v6
    v_mov_b32 v129, v6
    v_mov_b32 v130, v6
    v_mov_b32 v131, v6
    v_mov_b32 v132, v6
    v_mov_b32 v133, v6
    v_mov_b32 v134, v6
    v_mov_b32 v135, v6
    v_mov_b32 v136, v6
    v_mov_b32 v137, v6
    v_mov_b32 v138, v6
    v_mov_b32 v139, v6
    v_mov_b32 v140, v6
    v_mov_b32 v141, v6
    v_mov_b32 v142, v6
    v_mov_b32 v143, v6
L_inv_8:
    v_max3_f32 v224, v128, v129, v224
    v_max3_f32 v226, v130, v131, v226
    v_max3_f32 v224, v132, v133, v224
    v_max3_f32 v226, v134, v135, v226
    v_max3_f32 v224, v136, v137, v224
    v_max3_f32 v226, v138, v139, v226
    v_max3_f32 v224, v140, v141, v224
    v_max3_f32 v226, v142, v143, v226
    v_cndmask_b32 v144, v6, v144, s[52:53]
    v_cndmask_b32 v145, v6, v145, s[54:55]
    v_cndmask_b32 v146, v6, v146, s[56:57]
    v_cndmask_b32 v147, v6, v147, s[58:59]
    v_cndmask_b32 v148, v6, v148, s[60:61]
    v_cndmask_b32 v149, v6, v149, s[62:63]
    v_cndmask_b32 v150, v6, v150, s[64:65]
    v_cndmask_b32 v151, v6, v151, s[66:67]
    v_cndmask_b32 v152, v6, v152, s[68:69]
    v_cndmask_b32 v153, v6, v153, s[70:71]
    v_cndmask_b32 v154, v6, v154, s[72:73]
    v_cndmask_b32 v155, v6, v155, s[74:75]
    v_cndmask_b32 v156, v6, v156, s[76:77]
    v_cndmask_b32 v157, v6, v157, s[78:79]
    v_cndmask_b32 v158, v6, v158, s[80:81]
    v_cndmask_b32 v159, v6, v159, s[82:83]
    v_max3_f32 v224, v144, v145, v224
    v_max3_f32 v226, v146, v147, v226
    v_max3_f32 v224, v148, v149, v224
    v_max3_f32 v226, v150, v151, v226
    v_max3_f32 v224, v152, v153, v224
    v_max3_f32 v226, v154, v155, v226
    v_max3_f32 v224, v156, v157, v224
    v_max3_f32 v226, v158, v159, v226
    v_max_f32 v224, v224, v226
    v_mov_b32 v226, v224
    s_nop 1
    v_permlane32_swap_b32 v224, v226
    s_nop 1
    v_max_f32 v224, v224, v226
    v_mul_f32 v224, -v228, v224
    v_fma_f32 v16, v16, v228, v224
    v_fma_f32 v17, v17, v228, v224
    v_fma_f32 v18, v18, v228, v224
    v_fma_f32 v19, v19, v228, v224
    v_fma_f32 v20, v20, v228, v224
    v_fma_f32 v21, v21, v228, v224
    v_fma_f32 v22, v22, v228, v224
    v_fma_f32 v23, v23, v228, v224
    v_fma_f32 v24, v24, v228, v224
    v_fma_f32 v25, v25, v228, v224
    v_fma_f32 v26, v26, v228, v224
    v_fma_f32 v27, v27, v228, v224
    v_fma_f32 v28, v28, v228, v224
    v_fma_f32 v29, v29, v228, v224
    v_fma_f32 v30, v30, v228, v224
    v_fma_f32 v31, v31, v228, v224
    v_exp_f32 v16, v16
    v_exp_f32 v17, v17
    v_exp_f32 v18, v18
    v_exp_f32 v19, v19
    v_exp_f32 v20, v20
    v_exp_f32 v21, v21
    v_exp_f32 v22, v22
    v_exp_f32 v23, v23
    v_exp_f32 v24, v24
    v_exp_f32 v25, v25
    v_exp_f32 v26, v26
    v_exp_f32 v27, v27
    v_exp_f32 v28, v28
    v_exp_f32 v29, v29
    v_exp_f32 v30, v30
    v_exp_f32 v31, v31
    v_cvt_pk_bf16_f32 v16, v16, v17
    v_cvt_pk_bf16_f32 v17, v18, v19
    v_cvt_pk_bf16_f32 v18, v20, v21
    v_cvt_pk_bf16_f32 v19, v22, v23
    v_cvt_pk_bf16_f32 v20, v24, v25
    v_cvt_pk_bf16_f32 v21, v26, v27
    v_cvt_pk_bf16_f32 v22, v28, v29
    v_cvt_pk_bf16_f32 v23, v30, v31
    s_waitcnt lgkmcnt(4)
    v_mfma_f32_32x32x16_bf16 v[160:175], v[208:211], v[16:19], 0
    v_fma_f32 v32, v32, v228, v224
    v_fma_f32 v33, v33, v228, v224
    v_fma_f32 v34, v34, v228, v224
    v_fma_f32 v35, v35, v228, v224
    v_fma_f32 v36, v36, v228, v224
    v_fma_f32 v37, v37, v228, v224
    v_fma_f32 v38, v38, v228, v224
    v_fma_f32 v39, v39, v228, v224
    v_fma_f32 v40, v40, v228, v224
    v_fma_f32 v41, v41, v228, v224
    v_fma_f32 v42, v42, v228, v224
    v_fma_f32 v43, v43, v228, v224
    v_mfma_f32_32x32x16_bf16 v[160:175], v[212:215], v[20:23], v[160:175]
    v_fma_f32 v44, v44, v228, v224
    v_fma_f32 v45, v45, v228, v224
    v_fma_f32 v46, v46, v228, v224
    v_fma_f32 v47, v47, v228, v224
    v_exp_f32 v32, v32
    v_exp_f32 v33, v33
    ds_read_b64_tr_b16 v[208:209], v4 offset:10240
    ds_read_b64_tr_b16 v[210:211], v4 offset:10368
    ds_read_b64_tr_b16 v[212:213], v4 offset:10496
    ds_read_b64_tr_b16 v[214:215], v4 offset:10624
    v_exp_f32 v34, v34
    v_exp_f32 v35, v35
    v_exp_f32 v36, v36
    v_exp_f32 v37, v37
    v_exp_f32 v38, v38
    v_exp_f32 v39, v39
    v_exp_f32 v40, v40
    v_exp_f32 v41, v41
    v_exp_f32 v42, v42
    v_exp_f32 v43, v43
    v_exp_f32 v44, v44
    v_exp_f32 v45, v45
    v_exp_f32 v46, v46
    v_exp_f32 v47, v47
    v_cvt_pk_bf16_f32 v32, v32, v33
    v_cvt_pk_bf16_f32 v33, v34, v35
    v_cvt_pk_bf16_f32 v34, v36, v37
    v_cvt_pk_bf16_f32 v35, v38, v39
    v_cvt_pk_bf16_f32 v36, v40, v41
    v_cvt_pk_bf16_f32 v37, v42, v43
    v_cvt_pk_bf16_f32 v38, v44, v45
    v_cvt_pk_bf16_f32 v39, v46, v47
    s_waitcnt lgkmcnt(4)
    v_mfma_f32_32x32x16_bf16 v[160:175], v[216:219], v[32:35], v[160:175]
    v_fma_f32 v48, v48, v228, v224
    v_fma_f32 v49, v49, v228, v224
    v_fma_f32 v50, v50, v228, v224
    v_fma_f32 v51, v51, v228, v224
    v_fma_f32 v52, v52, v228, v224
    v_fma_f32 v53, v53, v228, v224
    v_fma_f32 v54, v54, v228, v224
    v_fma_f32 v55, v55, v228, v224
    v_fma_f32 v56, v56, v228, v224
    v_fma_f32 v57, v57, v228, v224
    v_fma_f32 v58, v58, v228, v224
    v_fma_f32 v59, v59, v228, v224
    v_mfma_f32_32x32x16_bf16 v[160:175], v[220:223], v[36:39], v[160:175]
    v_fma_f32 v60, v60, v228, v224
    v_fma_f32 v61, v61, v228, v224
    v_fma_f32 v62, v62, v228, v224
    v_fma_f32 v63, v63, v228, v224
    v_exp_f32 v48, v48
    v_exp_f32 v49, v49
    ds_read_b64_tr_b16 v[216:217], v4 offset:14336
    ds_read_b64_tr_b16 v[218:219], v4 offset:14464
    ds_read_b64_tr_b16 v[220:221], v4 offset:14592
    ds_read_b64_tr_b16 v[222:223], v4 offset:14720
    v_exp_f32 v50, v50
    v_exp_f32 v51, v51
    v_exp_f32 v52, v52
    v_exp_f32 v53, v53
    v_exp_f32 v54, v54
    v_exp_f32 v55, v55
    v_exp_f32 v56, v56
    v_exp_f32 v57, v57
    v_exp_f32 v58, v58
    v_exp_f32 v59, v59
    v_exp_f32 v60, v60
    v_exp_f32 v61, v61
    v_exp_f32 v62, v62
    v_exp_f32 v63, v63
    v_cvt_pk_bf16_f32 v48, v48, v49
    v_cvt_pk_bf16_f32 v49, v50, v51
    v_cvt_pk_bf16_f32 v50, v52, v53
    v_cvt_pk_bf16_f32 v51, v54, v55
    v_cvt_pk_bf16_f32 v52, v56, v57
    v_cvt_pk_bf16_f32 v53, v58, v59
    v_cvt_pk_bf16_f32 v54, v60, v61
    v_cvt_pk_bf16_f32 v55, v62, v63
    s_waitcnt lgkmcnt(4)
    v_mfma_f32_32x32x16_bf16 v[160:175], v[208:211], v[48:51], v[160:175]
    v_fma_f32 v64, v64, v228, v224
    v_fma_f32 v65, v65, v228, v224
    v_fma_f32 v66, v66, v228, v224
    v_fma_f32 v67, v67, v228, v224
    v_fma_f32 v68, v68, v228, v224
    v_fma_f32 v69, v69, v228, v224
    v_fma_f32 v70, v70, v228, v224
    v_fma_f32 v71, v71, v228, v224
    v_fma_f32 v72, v72, v228, v224
    v_fma_f32 v73, v73, v228, v224
    v_fma_f32 v74, v74, v228, v224
    v_fma_f32 v75, v75, v228, v224
    v_mfma_f32_32x32x16_bf16 v[160:175], v[212:215], v[52:55], v[160:175]
    v_fma_f32 v76, v76, v228, v224
    v_fma_f32 v77, v77, v228, v224
    v_fma_f32 v78, v78, v228, v224
    v_fma_f32 v79, v79, v228, v224
    v_exp_f32 v64, v64
    v_exp_f32 v65, v65
    ds_read_b64_tr_b16 v[208:209], v4 offset:18432
    ds_read_b64_tr_b16 v[210:211], v4 offset:18560
    ds_read_b64_tr_b16 v[212:213], v4 offset:18688
    ds_read_b64_tr_b16 v[214:215], v4 offset:18816
    v_exp_f32 v66, v66
    v_exp_f32 v67, v67
    v_exp_f32 v68, v68
    v_exp_f32 v69, v69
    v_exp_f32 v70, v70
    v_exp_f32 v71, v71
    v_exp_f32 v72, v72
    v_exp_f32 v73, v73
    v_exp_f32 v74, v74
    v_exp_f32 v75, v75
    v_exp_f32 v76, v76
    v_exp_f32 v77, v77
    v_exp_f32 v78, v78
    v_exp_f32 v79, v79
    v_cvt_pk_bf16_f32 v64, v64, v65
    v_cvt_pk_bf16_f32 v65, v66, v67
    v_cvt_pk_bf16_f32 v66, v68, v69
    v_cvt_pk_bf16_f32 v67, v70, v71
    v_cvt_pk_bf16_f32 v68, v72, v73
    v_cvt_pk_bf16_f32 v69, v74, v75
    v_cvt_pk_bf16_f32 v70, v76, v77
    v_cvt_pk_bf16_f32 v71, v78, v79
    s_waitcnt lgkmcnt(4)
    v_mfma_f32_32x32x16_bf16 v[160:175], v[216:219], v[64:67], v[160:175]
    v_fma_f32 v80, v80, v228, v224
    v_fma_f32 v81, v81, v228, v224
    v_fma_f32 v82, v82, v228, v224
    v_fma_f32 v83, v83, v228, v224
    v_fma_f32 v84, v84, v228, v224
    v_fma_f32 v85, v85, v228, v224
    v_fma_f32 v86, v86, v228, v224
    v_fma_f32 v87, v87, v228, v224
    v_fma_f32 v88, v88, v228, v224
    v_fma_f32 v89, v89, v228, v224
    v_fma_f32 v90, v90, v228, v224
    v_fma_f32 v91, v91, v228, v224
    v_mfma_f32_32x32x16_bf16 v[160:175], v[220:223], v[68:71], v[160:175]
    v_fma_f32 v92, v92, v228, v224
    v_fma_f32 v93, v93, v228, v224
    v_fma_f32 v94, v94, v228, v224
    v_fma_f32 v95, v95, v228, v224
    v_exp_f32 v80, v80
    v_exp_f32 v81, v81
    ds_read_b64_tr_b16 v[216:217], v4 offset:22528
    ds_read_b64_tr_b16 v[218:219], v4 offset:22656
    ds_read_b64_tr_b16 v[220:221], v4 offset:22784
    ds_read_b64_tr_b16 v[222:223], v4 offset:22912
    v_exp_f32 v82, v82
    v_exp_f32 v83, v83
    v_exp_f32 v84, v84
    v_exp_f32 v85, v85
    v_exp_f32 v86, v86
    v_exp_f32 v87, v87
    v_exp_f32 v88, v88
    v_exp_f32 v89, v89
    v_exp_f32 v90, v90
    v_exp_f32 v91, v91
    v_exp_f32 v92, v92
    v_exp_f32 v93, v93
    v_exp_f32 v94, v94
    v_exp_f32 v95, v95
    v_cvt_pk_bf16_f32 v80, v80, v81
    v_cvt_pk_bf16_f32 v81, v82, v83
    v_cvt_pk_bf16_f32 v82, v84, v85
    v_cvt_pk_bf16_f32 v83, v86, v87
    v_cvt_pk_bf16_f32 v84, v88, v89
    v_cvt_pk_bf16_f32 v85, v90, v91
    v_cvt_pk_bf16_f32 v86, v92, v93
    v_cvt_pk_bf16_f32 v87, v94, v95
    s_waitcnt lgkmcnt(4)
    v_mfma_f32_32x32x16_bf16 v[160:175], v[208:211], v[80:83], v[160:175]
    v_fma_f32 v96, v96, v228, v224
    v_fma_f32 v97, v97, v228, v224
    v_fma_f32 v98, v98, v228, v224
    v_fma_f32 v99, v99, v228, v224
    v_fma_f32 v100, v100, v228, v224
    v_fma_f32 v101, v101, v228, v224
    v_fma_f32 v102, v102, v228, v224
    v_fma_f32 v103, v103, v228, v224
    v_fma_f32 v104, v104, v228, v224
    v_fma_f32 v105, v105, v228, v224
    v_fma_f32 v106, v106, v228, v224
    v_fma_f32 v107, v107, v228, v224
    v_mfma_f32_32x32x16_bf16 v[160:175], v[212:215], v[84:87], v[160:175]
    v_fma_f32 v108, v108, v228, v224
    v_fma_f32 v109, v109, v228, v224
    v_fma_f32 v110, v110, v228, v224
    v_fma_f32 v111, v111, v228, v224
    v_exp_f32 v96, v96
    v_exp_f32 v97, v97
    ds_read_b64_tr_b16 v[208:209], v4 offset:26624
    ds_read_b64_tr_b16 v[210:211], v4 offset:26752
    ds_read_b64_tr_b16 v[212:213], v4 offset:26880
    ds_read_b64_tr_b16 v[214:215], v4 offset:27008
    v_exp_f32 v98, v98
    v_exp_f32 v99, v99
    v_exp_f32 v100, v100
    v_exp_f32 v101, v101
    v_exp_f32 v102, v102
    v_exp_f32 v103, v103
    v_exp_f32 v104, v104
    v_exp_f32 v105, v105
    v_exp_f32 v106, v106
    v_exp_f32 v107, v107
    v_exp_f32 v108, v108
    v_exp_f32 v109, v109
    v_exp_f32 v110, v110
    v_exp_f32 v111, v111
    v_cvt_pk_bf16_f32 v96, v96, v97
    v_cvt_pk_bf16_f32 v97, v98, v99
    v_cvt_pk_bf16_f32 v98, v100, v101
    v_cvt_pk_bf16_f32 v99, v102, v103
    v_cvt_pk_bf16_f32 v100, v104, v105
    v_cvt_pk_bf16_f32 v101, v106, v107
    v_cvt_pk_bf16_f32 v102, v108, v109
    v_cvt_pk_bf16_f32 v103, v110, v111
    s_waitcnt lgkmcnt(4)
    v_mfma_f32_32x32x16_bf16 v[160:175], v[216:219], v[96:99], v[160:175]
    v_fma_f32 v112, v112, v228, v224
    v_fma_f32 v113, v113, v228, v224
    v_fma_f32 v114, v114, v228, v224
    v_fma_f32 v115, v115, v228, v224
    v_fma_f32 v116, v116, v228, v224
    v_fma_f32 v117, v117, v228, v224
    v_fma_f32 v118, v118, v228, v224
    v_fma_f32 v119, v119, v228, v224
    v_fma_f32 v120, v120, v228, v224
    v_fma_f32 v121, v121, v228, v224
    v_fma_f32 v122, v122, v228, v224
    v_fma_f32 v123, v123, v228, v224
    v_mfma_f32_32x32x16_bf16 v[160:175], v[220:223], v[100:103], v[160:175]
    v_fma_f32 v124, v124, v228, v224
    v_fma_f32 v125, v125, v228, v224
    v_fma_f32 v126, v126, v228, v224
    v_fma_f32 v127, v127, v228, v224
    v_exp_f32 v112, v112
    v_exp_f32 v113, v113
    ds_read_b64_tr_b16 v[216:217], v4 offset:30720
    ds_read_b64_tr_b16 v[218:219], v4 offset:30848
    ds_read_b64_tr_b16 v[220:221], v4 offset:30976
    ds_read_b64_tr_b16 v[222:223], v4 offset:31104
    v_exp_f32 v114, v114
    v_exp_f32 v115, v115
    v_exp_f32 v116, v116
    v_exp_f32 v117, v117
    v_exp_f32 v118, v118
    v_exp_f32 v119, v119
    v_exp_f32 v120, v120
    v_exp_f32 v121, v121
    v_exp_f32 v122, v122
    v_exp_f32 v123, v123
    v_exp_f32 v124, v124
    v_exp_f32 v125, v125
    v_exp_f32 v126, v126
    v_exp_f32 v127, v127
    v_cvt_pk_bf16_f32 v112, v112, v113
    v_cvt_pk_bf16_f32 v113, v114, v115
    v_cvt_pk_bf16_f32 v114, v116, v117
    v_cvt_pk_bf16_f32 v115, v118, v119
    v_cvt_pk_bf16_f32 v116, v120, v121
    v_cvt_pk_bf16_f32 v117, v122, v123
    v_cvt_pk_bf16_f32 v118, v124, v125
    v_cvt_pk_bf16_f32 v119, v126, v127
    s_waitcnt lgkmcnt(4)
    v_mfma_f32_32x32x16_bf16 v[160:175], v[208:211], v[112:115], v[160:175]
    v_fma_f32 v128, v128, v228, v224
    v_fma_f32 v129, v129, v228, v224
    v_fma_f32 v130, v130, v228, v224
    v_fma_f32 v131, v131, v228, v224
    v_fma_f32 v132, v132, v228, v224
    v_fma_f32 v133, v133, v228, v224
    v_fma_f32 v134, v134, v228, v224
    v_fma_f32 v135, v135, v228, v224
    v_fma_f32 v136, v136, v228, v224
    v_fma_f32 v137, v137, v228, v224
    v_fma_f32 v138, v138, v228, v224
    v_fma_f32 v139, v139, v228, v224
    v_mfma_f32_32x32x16_bf16 v[160:175], v[212:215], v[116:119], v[160:175]
    v_fma_f32 v140, v140, v228, v224
    v_fma_f32 v141, v141, v228, v224
    v_fma_f32 v142, v142, v228, v224
    v_fma_f32 v143, v143, v228, v224
    v_exp_f32 v128, v128
    v_exp_f32 v129, v129
    ds_read_b64_tr_b16 v[208:209], v4 offset:34816
    ds_read_b64_tr_b16 v[210:211], v4 offset:34944
    ds_read_b64_tr_b16 v[212:213], v4 offset:35072
    ds_read_b64_tr_b16 v[214:215], v4 offset:35200
    v_exp_f32 v130, v130
    v_exp_f32 v131, v131
    v_exp_f32 v132, v132
    v_exp_f32 v133, v133
    v_exp_f32 v134, v134
    v_exp_f32 v135, v135
    v_exp_f32 v136, v136
    v_exp_f32 v137, v137
    v_exp_f32 v138, v138
    v_exp_f32 v139, v139
    v_exp_f32 v140, v140
    v_exp_f32 v141, v141
    v_exp_f32 v142, v142
    v_exp_f32 v143, v143
    v_cvt_pk_bf16_f32 v128, v128, v129
    v_cvt_pk_bf16_f32 v129, v130, v131
    v_cvt_pk_bf16_f32 v130, v132, v133
    v_cvt_pk_bf16_f32 v131, v134, v135
    v_cvt_pk_bf16_f32 v132, v136, v137
    v_cvt_pk_bf16_f32 v133, v138, v139
    v_cvt_pk_bf16_f32 v134, v140, v141
    v_cvt_pk_bf16_f32 v135, v142, v143
    s_waitcnt lgkmcnt(4)
    v_mfma_f32_32x32x16_bf16 v[160:175], v[216:219], v[128:131], v[160:175]
    v_fma_f32 v144, v144, v228, v224
    v_fma_f32 v145, v145, v228, v224
    v_fma_f32 v146, v146, v228, v224
    v_fma_f32 v147, v147, v228, v224
    v_fma_f32 v148, v148, v228, v224
    v_fma_f32 v149, v149, v228, v224
    v_fma_f32 v150, v150, v228, v224
    v_fma_f32 v151, v151, v228, v224
    v_fma_f32 v152, v152, v228, v224
    v_fma_f32 v153, v153, v228, v224
    v_fma_f32 v154, v154, v228, v224
    v_fma_f32 v155, v155, v228, v224
    v_mfma_f32_32x32x16_bf16 v[160:175], v[220:223], v[132:135], v[160:175]
    v_fma_f32 v156, v156, v228, v224
    v_fma_f32 v157, v157, v228, v224
    v_fma_f32 v158, v158, v228, v224
    v_fma_f32 v159, v159, v228, v224
    v_exp_f32 v144, v144
    v_exp_f32 v145, v145
    v_exp_f32 v146, v146
    v_exp_f32 v147, v147
    v_exp_f32 v148, v148
    v_exp_f32 v149, v149
    v_exp_f32 v150, v150
    v_exp_f32 v151, v151
    v_exp_f32 v152, v152
    v_exp_f32 v153, v153
    v_exp_f32 v154, v154
    v_exp_f32 v155, v155
    v_exp_f32 v156, v156
    v_exp_f32 v157, v157
    v_exp_f32 v158, v158
    v_exp_f32 v159, v159
    v_cvt_pk_bf16_f32 v144, v144, v145
    v_cvt_pk_bf16_f32 v145, v146, v147
    v_cvt_pk_bf16_f32 v146, v148, v149
    v_cvt_pk_bf16_f32 v147, v150, v151
    v_cvt_pk_bf16_f32 v148, v152, v153
    v_cvt_pk_bf16_f32 v149, v154, v155
    v_cvt_pk_bf16_f32 v150, v156, v157
    v_cvt_pk_bf16_f32 v151, v158, v159
    s_waitcnt lgkmcnt(0)
    v_mfma_f32_32x32x16_bf16 v[160:175], v[208:211], v[144:147], v[160:175]
    v_mfma_f32_32x32x16_bf16 v[160:175], v[212:215], v[148:151], v[160:175]
    v_bfe_u32 v11, v1, 4, 1
    v_add_u32 v11, s10, v11
    v_mul_u32_u24 v12, 205, v11
    v_lshrrev_b32 v12, 10, v12
    v_mul_u32_u24 v12, 835, v12
    v_add_u32 v11, v11, v12
    v_lshl_add_u32 v5, v11, 10, v7
    v_mov_b32 v176, v184
    v_mov_b32 v177, v185
    v_mov_b32 v178, v186
    v_mov_b32 v179, v187
    v_mov_b32 v180, v188
    v_mov_b32 v181, v189
    v_mov_b32 v182, v190
    v_mov_b32 v183, v191
    v_add_u32 v3, 4096, v3
    v_add_u32 v4, 4096, v4
    s_add_u32 s10, s10, 2
    s_sub_u32 s6, s6, 1
    s_cselect_b32 s6, 0, s6
    v_rcp_f32 v10, v172
    s_nop 0
    v_mul_f32 v160, v160, v10
    v_mul_f32 v161, v161, v10
    v_mul_f32 v162, v162, v10
    v_mul_f32 v163, v163, v10
    v_mul_f32 v164, v164, v10
    v_mul_f32 v165, v165, v10
    v_mul_f32 v166, v166, v10
    v_mul_f32 v167, v167, v10
    v_mul_f32 v168, v168, v10
    v_mul_f32 v169, v169, v10
    v_mul_f32 v170, v170, v10
    v_mul_f32 v171, v171, v10
    v_cvt_pk_bf16_f32 v160, v160, v161
    v_cvt_pk_bf16_f32 v161, v162, v163
    v_cvt_pk_bf16_f32 v162, v164, v165
    v_cvt_pk_bf16_f32 v163, v166, v167
    v_cvt_pk_bf16_f32 v164, v168, v169
    v_cvt_pk_bf16_f32 v165, v170, v171
    v_cndmask_b32 v160, 0, v160, s[84:85]
    v_cndmask_b32 v165, 0, v165, s[86:87]
    v_mov_b32 v166, 0
    v_mov_b32 v167, 0
    s_setprio 3
    s_mov_b32 s40, 737280
    buffer_store_dwordx4 v[160:163], v5, s[32:35], s40 offen sc1
    s_mov_b32 exec_hi, 0
    buffer_store_dwordx4 v[164:167], v5, s[32:35], s7 offen sc1
    s_mov_b64 exec, -1
    s_setprio 3
    s_add_u32 s9, s9, 1
    s_cmp_lt_u32 s9, 2
    s_cbranch_scc1 L_aq
L_apub:
    s_setprio 3
    s_waitcnt vmcnt(0)
    v_mov_b32 v10, 44
    v_mov_b32 v11, 1
    s_lshl_b32 s41, s38, 8
    s_add_u32 s41, s41, 29458432
    v_mov_b32 v13, s41
    v_mov_b32 v14, s3
    s_lshl_b32 s41, s38, 2
    v_mov_b32 v9, s41
    s_mov_b64 exec, 1
    ds_add_rtn_u32 v12, v10, v11
    s_waitcnt lgkmcnt(0)
    v_readfirstlane_b32 s40, v12
    s_cmp_lg_u32 s40, 3
    s_cbranch_scc1 L_fin
    global_atomic_add v12, v9, v11, s[12:13] offset:128 sc0 sc1
    s_waitcnt vmcnt(0)
    v_readfirstlane_b32 s40, v12
    s_and_b32 s40, s40, 31
    s_cmp_lg_u32 s40, 31
    s_cbranch_scc1 L_fin
    buffer_store_dword v14, v13, s[32:35], 0 offen sc1
    s_branch L_fin
L_stouch:
    s_cmp_ge_u32 s75, s60
    s_cbranch_scc1 L_stouch_r
    s_cmp_lg_u32 s82, 0
    s_cbranch_scc1 L_stouch2
    s_cmp_lt_u32 s75, s55
    s_cbranch_scc1 L_stouch_q
    s_sub_u32 s40, s75, s55
    s_lshr_b32 s41, s40, 1
    s_sub_u32 s42, s41, s94
    s_lshl_b32 s43, s53, 1
    s_add_u32 s43, s43, s42
    s_add_u32 s43, s43, 39
    s_add_u32 s42, s53, 24
    s_cmp_eq_u32 s41, s94
    s_cselect_b32 s43, s42, s43
    s_add_u32 s42, s41, s58
    s_cmp_lt_u32 s41, s94
    s_cselect_b32 s41, s42, s43
    s_bitcmp1_b32 s40, 0
    s_cselect_b32 s84, s10, s8
    s_cselect_b32 s85, s11, s9
    s_movk_i32 s86, 9216
    s_branch L_stouch1
L_stouch_q:
    s_add_u32 s41, s75, s57
L_stouch1:
    s_lshl_b32 s41, s41, 7
    s_mul_i32 s87, s83, s86
    s_add_u32 s87, s87, s41
    s_add_u32 s87, s87, 60
L_stouch2:
    s_load_dwordx2 s[90:91], s[84:85], s87
    s_add_u32 s87, s87, s86
    s_load_dwordx2 s[90:91], s[84:85], s87
    s_add_u32 s87, s87, s86
    s_load_dwordx2 s[90:91], s[84:85], s87
    s_add_u32 s87, s87, s86
    s_add_u32 s82, s82, 1
    s_cmp_eq_u32 s82, 3
    s_cselect_b32 s82, 0, s82
    s_addc_u32 s75, s75, 0
L_stouch_r:
    s_setpc_b64 s[98:99]
L_touch:
    s_cmp_ge_u32 s75, s60
    s_cbranch_scc1 L_touch_r
    s_mov_b64 exec, 0x1ff
    s_cmp_lt_u32 s75, s55
    s_cbranch_scc1 L_touch_q
    s_sub_u32 s40, s75, s55
    s_lshr_b32 s41, s40, 1
    s_sub_u32 s42, s41, s94
    s_lshl_b32 s43, s53, 1
    s_add_u32 s43, s43, s42
    s_add_u32 s43, s43, 39
    s_add_u32 s42, s53, 24
    s_cmp_eq_u32 s41, s94
    s_cselect_b32 s43, s42, s43
    s_add_u32 s42, s41, s58
    s_cmp_lt_u32 s41, s94
    s_cselect_b32 s41, s42, s43
    s_lshl_b32 s41, s41, 7
    s_bitcmp1_b32 s40, 0
    s_cselect_b32 s16, s10, s8
    s_cselect_b32 s17, s11, s9
    s_mov_b32 s18, 5308416
    buffer_load_dword v252, v9, s[16:19], s41 offen
    s_branch L_touch_e
L_touch_q:
    s_add_u32 s41, s75, s57
    s_lshl_b32 s41, s41, 7
    buffer_load_dword v252, v8, s[16:19], s41 offen
L_touch_e:
    s_mov_b64 exec, -1
    s_add_u32 s75, s75, 1
L_touch_r:
    s_setpc_b64 s[98:99]
L_issue:
    s_cmp_lg_u32 s61, 0
    s_cbranch_scc1 L_issue2
    s_bitcmp1_b32 s59, 0
    s_cselect_b32 s62, 73728, 0
    s_add_u32 s62, s62, s63
    s_cmp_lt_u32 s59, s55
    s_cbranch_scc1 L_issueq
    s_sub_u32 s40, s59, s55
    s_lshr_b32 s41, s40, 1
    s_sub_u32 s42, s41, s94
    s_lshl_b32 s43, s53, 1
    s_add_u32 s43, s43, s42
    s_add_u32 s43, s43, 39
    s_add_u32 s42, s53, 24
    s_cmp_eq_u32 s41, s94
    s_cselect_b32 s43, s42, s43
    s_add_u32 s42, s41, s58
    s_cmp_lt_u32 s41, s94
    s_cselect_b32 s41, s42, s43
    s_lshl_b32 s68, s41, 7
    s_bitcmp1_b32 s40, 0
    s_cselect_b32 s20, s10, s8
    s_cselect_b32 s21, s11, s9
    s_mov_b32 s22, 5308416
    s_mov_b32 s67, 294912
    v_mov_b32 v3, v2
    s_branch L_issue2
L_issueq:
    s_add_u32 s41, s59, s57
    s_lshl_b32 s68, s41, 7
L_issue2:
    s_mul_i32 s65, s66, s67
    s_add_u32 s65, s65, s68
    s_add_u32 m0, s62, 0
    s_add_u32 s66, s66, 2
    buffer_load_dwordx4 v3, s[20:23], s65 offen  lds
    s_add_u32 m0, s62, 1024
    s_add_u32 s65, s65, s67
    buffer_load_dwordx4 v3, s[20:23], s65 offen  lds
    s_cmp_eq_u32 s66, 18
    s_cselect_b32 s66, 0, s66
    s_mul_i32 s65, s66, s67
    s_add_u32 s65, s65, s68
    s_add_u32 m0, s62, 2048
    s_add_u32 s66, s66, 2
    buffer_load_dwordx4 v3, s[20:23], s65 offen  lds
    s_add_u32 m0, s62, 3072
    s_add_u32 s65, s65, s67
    buffer_load_dwordx4 v3, s[20:23], s65 offen  lds
    s_cmp_eq_u32 s66, 18
    s_cselect_b32 s66, 0, s66
    s_mul_i32 s65, s66, s67
    s_add_u32 s65, s65, s68
    s_add_u32 m0, s62, 4096
    s_add_u32 s66, s66, 2
    buffer_load_dwordx4 v3, s[20:23], s65 offen  lds
    s_add_u32 m0, s62, 5120
    s_add_u32 s65, s65, s67
    buffer_load_dwordx4 v3, s[20:23], s65 offen  lds
    s_cmp_eq_u32 s66, 18
    s_cselect_b32 s66, 0, s66
L_issue3:
    s_add_u32 s62, s62, 6144
    s_add_u32 s61, s61, 1
    s_cmp_eq_u32 s61, 3
    s_cselect_b32 s61, 0, s61
    s_addc_u32 s59, s59, 0
    s_add_u32 s64, s64, 1
    s_setpc_b64 s[98:99]
L_loader:
    s_setprio 3
    s_lshr_b32 s40, s53, 1
    s_bitcmp1_b32 0x15, s40
    s_cselect_b32 s55, 3, 2
    s_add_u32 s57, s40, 1
    s_lshr_b32 s57, s57, 1
    s_min_u32 s57, s57, 3
    s_lshl_b32 s41, s40, 1
    s_add_u32 s57, s57, s41
    s_add_u32 s57, s57, 8
    s_add_u32 s58, s40, 16
    s_bitcmp0_b32 s53, 0
    s_cselect_b32 s55, 1, s55
    s_cselect_b32 s57, s40, s57
    s_cselect_b32 s58, s41, s58
    s_cselect_b32 s94, 2, 1
    s_lshl_b32 s60, s94, 1
    s_add_u32 s60, s60, 6
    s_add_u32 s60, s60, s55
    s_mul_i32 s71, s60, 3
    s_lshl_b32 s40, s52, 2
    s_add_u32 s40, s40, s37
    s_mul_i32 s40, s40, 9
    s_mov_b32 s83, s40
    s_mov_b32 s82, 0
    s_movk_i32 s86, 3456
    v_add_u32 v9, s40, v1
    v_mul_u32_u24 v8, 3456, v9
    v_mul_u32_u24 v9, 9216, v9
    s_mov_b32 s75, 0
    s_waitcnt lgkmcnt(0)
    s_mov_b32 s20, s6
    s_mov_b32 s21, s7
    s_mov_b32 s22, 1990656
    s_mov_b32 s23, 0x00020000
    s_mov_b32 s16, s6
    s_mov_b32 s17, s7
    s_mov_b32 s18, 1990656
    s_mov_b32 s19, 0x00020000
    s_mov_b32 s84, s6
    s_mov_b32 s85, s7
    s_call_b64 s[98:99], L_touch
    s_call_b64 s[98:99], L_touch
    s_mov_b32 s88, s14
    s_mov_b32 s89, s15
    s_mov_b32 s40, s39
    s_sub_u32 s41, s39, 15
    s_cselect_b32 s40, s40, s41
    s_cselect_b32 s88, s88, s8
    s_cselect_b32 s89, s89, s9
    s_sub_u32 s41, s39, 18
    s_cselect_b32 s40, s40, s41
    s_cselect_b32 s88, s88, s10
    s_cselect_b32 s89, s89, s11
    s_sub_u32 s41, s39, 21
    s_cselect_b32 s40, s40, s41
    s_cselect_b32 s88, s88, s48
    s_cselect_b32 s89, s89, s49
    s_sub_u32 s41, s39, 24
    s_cselect_b32 s40, s40, s41
    s_cselect_b32 s88, s88, s50
    s_cselect_b32 s89, s89, s51
    s_sub_u32 s41, s39, 26
    s_cselect_b32 s40, s40, s41
    s_cselect_b32 s88, s88, s44
    s_cselect_b32 s89, s89, s45
    s_cmp_ge_u32 s39, 26
    s_cselect_b32 s40, 0, s40
    s_lshl_b32 s40, s40, 21
    s_cmp_lg_u32 s37, 3
    s_cbranch_scc1 L_notlb
    s_load_dword s90, s[88:89], s40
L_notlb:
    s_lshl_b32 s40, s2, 2
    s_add_u32 s40, s40, s37
    s_cmp_lg_u32 s40, 0
    s_cbranch_scc1 L_notag
    v_mov_b32 v238, 0
    s_or_b32 s88, s92, 1
    v_mov_b32 v239, s88
    s_mov_b64 exec, 1
    global_store_dword v238, v239, s[12:13] sc1
    s_mov_b64 exec, -1
L_notag:
    s_setprio 0
    v_mov_b32 v238, 0
    v_lshlrev_b32 v239, 2, v1
    ds_write_b32 v239, v238 offset:0
    s_mov_b32 s32, s14
    s_mov_b32 s33, s15
    s_mov_b32 s34, 29466624
    s_mov_b32 s35, 0x00020000
    v_bfe_u32 v241, v1, 2, 3
    s_lshl_b32 s40, s37, 3
    v_add_u32 v241, s40, v241
    s_and_b32 s40, s37, 1
    s_lshl_b32 s40, s40, 1
    v_and_b32 v242, 3, v1
    v_xor_b32 v242, s40, v242
    v_lshlrev_b32 v242, 4, v242
    v_lshrrev_b32 v243, 5, v1
    v_lshl_add_u32 v242, v243, 6, v242
    v_mul_u32_u24 v3, 3456, v241
    v_add_u32 v3, v3, v242
    v_mul_u32_u24 v2, 9216, v241
    v_add_u32 v2, v2, v242
    s_mov_b32 s67, 110592
    s_mov_b32 s59, 0
    s_mov_b32 s61, 0
    s_mov_b32 s64, 0
    s_lshl_b32 s66, s54, 1
    s_mul_i32 s63, s37, 18432
    s_add_u32 s63, s63, 4096
    s_mov_b32 s24, s44
    s_mov_b32 s25, s45
    s_mov_b32 s26, 663552
    s_mov_b32 s27, 0x00020000
    s_mov_b32 s28, s48
    s_mov_b32 s29, s49
    s_mov_b32 s30, 5308416
    s_mov_b32 s31, 0x00020000
    v_lshlrev_b32 v7, 7, v1
    s_lshl_b32 s40, s2, 2
    s_add_u32 s40, s40, s37
    s_mul_i32 s73, s40, 5248
    s_mul_i32 s74, s40, 768
    s_mov_b32 s76, 0
    v_mov_b32 v248, 0
    v_mov_b32 v249, 0
    s_waitcnt lgkmcnt(0)
    s_barrier
    s_call_b64 s[98:99], L_issue
    s_call_b64 s[98:99], L_issue
    s_waitcnt vmcnt(6)
    s_barrier
    s_call_b64 s[98:99], L_issue
    s_call_b64 s[98:99], L_issue
    s_waitcnt vmcnt(12)
    s_barrier
    s_call_b64 s[98:99], L_issue
    s_call_b64 s[98:99], L_issue
L_ld:
    s_waitcnt vmcnt(18)
    s_barrier
    s_call_b64 s[98:99], L_issue
    s_cmp_lg_u32 s64, 8
    s_cbranch_scc1 L_notg
    global_load_dword v248, v249, s[12:13]
L_notg:
    s_lshl_b32 s40, s37, 8
    s_add_u32 s40, s40, s64
    s_mul_i32 s41, s55, 3
    s_add_u32 s41, s41, 10
    s_cmp_lg_u32 s40, s41
    s_cbranch_scc1 L_noq
    v_readfirstlane_b32 s3, v248
    s_mov_b32 s47, 100000
    s_sub_u32 s40, s92, s3
    s_cmp_gt_i32 s40, 2000
    s_cselect_b32 s3, 0, s3
L_tg4:
    s_cmp_lg_u32 s3, 0
    s_cbranch_scc1 L_tg4_ok
    s_sub_u32 s47, s47, 1
    s_cbranch_scc1 L_tg4_ok
    s_load_dword s3, s[12:13], 0 glc
    s_waitcnt lgkmcnt(0)
    s_sleep 8
    s_branch L_tg4
L_tg4_ok:
    s_lshl_b32 s40, s52, 6
    s_add_u32 s40, s40, s53
    s_lshl_b32 s40, s40, 2
    s_add_u32 s40, s40, 29442048
    v_mov_b32 v236, s40
    v_mov_b32 v237, s3
    s_mov_b32 s40, 12288
    s_mov_b64 exec, 1
    buffer_store_dword v237, v236, s[32:35], s40 offen sc1
    s_mov_b64 exec, -1
L_noq:
    s_add_u32 s40, s64, 6
    s_cmp_lg_u32 s40, s71
    s_cbranch_scc1 L_nowd
    s_mov_b32 exec_hi, 0x1ff
    buffer_load_dword v252, v7, s[28:31], s73 offen
    s_mov_b64 exec, 63
    buffer_load_dword v253, v7, s[24:27], s74 offen
    s_mov_b64 exec, -1
L_nowd:
    s_add_u32 s40, s64, 6
    s_cmp_lg_u32 s40, s71
    s_cbranch_scc1 L_nol1
    s_cmp_lg_u32 s37, 0
    s_cbranch_scc1 L_nol1
    s_lshl_b32 s40, s52, 6
    s_add_u32 s40, s40, s53
    s_lshl_b32 s40, s40, 2
    s_add_u32 s40, s40, 29442048
    v_mov_b32 v236, s40
    v_mov_b32 v237, s3
    s_mov_b32 s40, 0
    s_mov_b64 exec, 1
    buffer_store_dword v237, v236, s[32:35], s40 offen sc1
    s_mov_b64 exec, -1
L_nol1:
    s_cmp_lt_u32 s64, s71
    s_cbranch_scc1 L_ld
    v_readfirstlane_b32 s3, v248
    s_mov_b32 s47, 100000
    s_sub_u32 s40, s92, s3
    s_cmp_gt_i32 s40, 2000
    s_cselect_b32 s3, 0, s3
L_tg3:
    s_cmp_lg_u32 s3, 0
    s_cbranch_scc1 L_tg3_ok
    s_sub_u32 s47, s47, 1
    s_cbranch_scc1 L_tg3_ok
    s_load_dword s3, s[12:13], 0 glc
    s_waitcnt lgkmcnt(0)
    s_sleep 8
    s_branch L_tg3
L_tg3_ok:
    s_cmp_lg_u32 s37, 0
    s_cbranch_scc1 L_noe
    s_lshl_b32 s40, s52, 6
    s_add_u32 s40, s40, s53
    s_lshl_b32 s40, s40, 2
    s_add_u32 s40, s40, 29442048
    v_mov_b32 v236, s40
    v_mov_b32 v237, s3
    s_mov_b32 s40, 4096
    s_mov_b64 exec, 1
    buffer_store_dword v237, v236, s[32:35], s40 offen sc1
    s_mov_b64 exec, -1
L_noe:
    s_waitcnt vmcnt(18) lgkmcnt(0)
    s_barrier
    s_mul_i32 s40, s38, 29
    s_cmp_eq_u32 s38, 7
    s_addc_u32 s40, s40, 0
    s_add_u32 s40, s40, s39
    s_min_u32 s40, s40, 233
    s_mul_i32 s80, s40, 7282
    s_lshr_b32 s80, s80, 16
    s_mul_i32 s41, s80, 9
    s_sub_u32 s81, s40, s41
    s_cmp_ge_u32 s38, 6
    s_cselect_b32 s75, 30, 29
    s_mul_i32 s40, s80, 80
    s_add_u32 s41, s40, 79
    s_min_u32 s41, s41, 2047
    s_lshr_b32 s42, s40, 7
    s_lshr_b32 s43, s41, 7
    s_lshl_b32 s42, s42, 2
    s_lshl_b32 s43, s43, 2
    v_mov_b32 v2, s42
    v_mov_b32 v3, s43
    s_mov_b32 vcc_lo, 0xffff0000
    s_mov_b32 vcc_hi, 0xffff0000
    v_cndmask_b32 v2, v2, v3, vcc
    v_and_b32 v3, 15, v1
    v_lshl_add_u32 v2, v2, 4, v3
    v_lshlrev_b32 v2, 2, v2
    v_add_u32 v2, 29442048, v2
    buffer_load_dword v3, v2, s[32:35], 0 offen sc1
    s_lshr_b32 s72, s42, 3
    s_lshr_b32 s73, s43, 3
    v_lshlrev_b32 v6, 4, v1
    s_mov_b32 s16, s4
    s_mov_b32 s17, s5
    s_mov_b32 s18, 2359296
    s_mov_b32 s19, 0x00020000
    v_mov_b32 v226, s72
    s_mov_b32 exec_lo, 0
    v_mov_b32 v226, s73
    s_mov_b64 exec, -1
    v_lshlrev_b32 v226, 8, v226
    v_add_u32 v226, 29458432, v226
    s_mov_b32 s20, s48
    s_mov_b32 s21, s49
    s_mov_b32 s22, 5308416
    s_mov_b32 s23, 0x00020000
    s_mov_b32 s28, s50
    s_mov_b32 s29, s51
    s_mov_b32 s30, 2359296
    s_mov_b32 s31, 0x00020000
    s_mul_i32 s82, s80, 168
    s_add_u32 s82, s82, s37
    s_mul_i32 s82, s82, 5120
    s_mul_i32 s85, s37, 36864
    s_lshl_b32 s40, s81, 7
    s_add_u32 s85, s85, s40
    s_mov_b32 s84, s82
    s_mul_i32 s86, s37, 18432
    s_bitcmp1_b32 s60, 0
    s_cselect_b32 s83, 73728, 0
    s_add_u32 s83, s83, 4096
    s_add_u32 s86, s86, s83
    s_cmp_eq_u32 s80, 25
    s_cselect_b32 s40, 0x40000000, 0
    v_add_u32 v224, s40, v6
    v_add_u32 v225, 4096, v224
    v_bfe_u32 v228, v1, 4, 1
    v_bfe_u32 v229, v1, 2, 2
    v_lshlrev_b32 v233, 1, v228
    v_and_b32 v234, 3, v1
    v_xor_b32 v233, v233, v234
    v_lshlrev_b32 v233, 4, v233
    v_lshrrev_b32 v235, 5, v1
    v_lshl_add_u32 v227, v235, 6, v233
    v_bfe_u32 v232, v1, 2, 3
    v_mul_u32_u24 v233, 1152, v232
    v_add_u32 v4, v233, v227
    v_add_u32 v5, 9216, v4
    v_add_u32 v7, 18432, v4
    v_add_u32 v8, 27648, v4
    v_lshlrev_b32 v235, 10, v235
    v_lshl_add_u32 v235, v232, 6, v235
    v_lshl_add_u32 v235, v228, 5, v235
    v_lshl_add_u32 v235, v234, 3, v235
    v_add_u32 v9, s86, v235
    v_xor_b32 v235, 32, v235
    v_add_u32 v10, s86, v235
    v_mov_b32 v16, 0
    v_mov_b32 v17, 0
    v_mov_b32 v18, 0
    v_mov_b32 v19, 0
    v_mov_b32 v20, 0
    v_mov_b32 v21, 0
    v_mov_b32 v22, 0
    v_mov_b32 v23, 0
    v_mov_b32 v24, 0
    v_mov_b32 v25, 0
    v_mov_b32 v26, 0
    v_mov_b32 v27, 0
    v_mov_b32 v28, 0
    v_mov_b32 v29, 0
    v_mov_b32 v30, 0
    v_mov_b32 v31, 0
    v_mov_b32 v32, 0
    v_mov_b32 v33, 0
    v_mov_b32 v34, 0
    v_mov_b32 v35, 0
    v_mov_b32 v36, 0
    v_mov_b32 v37, 0
    v_mov_b32 v38, 0
    v_mov_b32 v39, 0
    v_mov_b32 v40, 0
    v_mov_b32 v41, 0
    v_mov_b32 v42, 0
    v_mov_b32 v43, 0
    v_mov_b32 v44, 0
    v_mov_b32 v45, 0
    v_mov_b32 v46, 0
    v_mov_b32 v47, 0
    v_mov_b32 v48, 0
    v_mov_b32 v49, 0
    v_mov_b32 v50, 0
    v_mov_b32 v51, 0
    v_mov_b32 v52, 0
    v_mov_b32 v53, 0
    v_mov_b32 v54, 0
    v_mov_b32 v55, 0
    v_mov_b32 v56, 0
    v_mov_b32 v57, 0
    v_mov_b32 v58, 0
    v_mov_b32 v59, 0
    v_mov_b32 v60, 0
    v_mov_b32 v61, 0
    v_mov_b32 v62, 0
    v_mov_b32 v63, 0
    v_mov_b32 v64, 0
    v_mov_b32 v65, 0
    v_mov_b32 v66, 0
    v_mov_b32 v67, 0
    v_mov_b32 v68, 0
    v_mov_b32 v69, 0
    v_mov_b32 v70, 0
    v_mov_b32 v71, 0
    v_mov_b32 v72, 0
    v_mov_b32 v73, 0
    v_mov_b32 v74, 0
    v_mov_b32 v75, 0
    v_mov_b32 v76, 0
    v_mov_b32 v77, 0
    v_mov_b32 v78, 0
    v_mov_b32 v79, 0
    v_mov_b32 v80, 0
    v_mov_b32 v81, 0
    v_mov_b32 v82, 0
    v_mov_b32 v83, 0
    v_mov_b32 v84, 0
    v_mov_b32 v85, 0
    v_mov_b32 v86, 0
    v_mov_b32 v87, 0
    v_mov_b32 v88, 0
    v_mov_b32 v89, 0
    v_mov_b32 v90, 0
    v_mov_b32 v91, 0
    v_mov_b32 v92, 0
    v_mov_b32 v93, 0
    v_mov_b32 v94, 0
    v_mov_b32 v95, 0
    s_waitcnt vmcnt(0)
    s_barrier
    s_cmp_ge_u32 s39, s75
    s_cbranch_scc1 L_fin
    s_setprio 2
    s_mov_b32 s47, 100000
L_fe:
    v_cmp_ne_u32 vcc, s3, v3
    s_cbranch_vccz L_fe_ok
    s_sub_u32 s47, s47, 1
    s_cbranch_scc1 L_fe_ok
    s_sleep 16
    buffer_load_dword v3, v2, s[32:35], 0 offen sc1
    s_waitcnt vmcnt(0)
    s_branch L_fe
L_fe_ok:
    v_add_u32 v2, 4096, v2
    s_add_u32 m0, s86, 0
    s_nop 0
    buffer_load_dwordx4 v4, s[20:23], s85 offen  lds
    s_add_u32 m0, s86, 1024
    s_nop 0
    buffer_load_dwordx4 v5, s[20:23], s85 offen  lds
    s_add_u32 m0, s86, 2048
    s_nop 0
    buffer_load_dwordx4 v7, s[20:23], s85 offen  lds
    s_add_u32 m0, s86, 3072
    s_nop 0
    buffer_load_dwordx4 v8, s[20:23], s85 offen  lds
    buffer_load_dwordx4 v[96:99], v6, s[32:35], s84 offen offset:0 sc1
    buffer_load_dwordx4 v[100:103], v6, s[32:35], s84 offen offset:1024 sc1
    buffer_load_dwordx4 v[104:107], v6, s[32:35], s84 offen offset:2048 sc1
    buffer_load_dwordx4 v[108:111], v224, s[32:35], s84 offen offset:3072 sc1
    buffer_load_dwordx4 v[112:115], v225, s[32:35], s84 offen offset:0 sc1
    s_add_u32 s85, s85, 147456
    s_add_u32 s84, s84, 20480
    s_add_u32 m0, s86, 4096
    s_nop 0
    buffer_load_dwordx4 v4, s[20:23], s85 offen  lds
    s_add_u32 m0, s86, 5120
    s_nop 0
    buffer_load_dwordx4 v5, s[20:23], s85 offen  lds
    s_add_u32 m0, s86, 6144
    s_nop 0
    buffer_load_dwordx4 v7, s[20:23], s85 offen  lds
    s_add_u32 m0, s86, 7168
    s_nop 0
    buffer_load_dwordx4 v8, s[20:23], s85 offen  lds
    buffer_load_dwordx4 v[116:119], v6, s[32:35], s84 offen offset:0 sc1
    buffer_load_dwordx4 v[120:123], v6, s[32:35], s84 offen offset:1024 sc1
    buffer_load_dwordx4 v[124:127], v6, s[32:35], s84 offen offset:2048 sc1
    buffer_load_dwordx4 v[128:131], v224, s[32:35], s84 offen offset:3072 sc1
    buffer_load_dwordx4 v[132:135], v225, s[32:35], s84 offen offset:0 sc1
    s_add_u32 s85, s85, 147456
    s_add_u32 s84, s84, 20480
    s_add_u32 m0, s86, 8192
    s_nop 0
    buffer_load_dwordx4 v4, s[20:23], s85 offen  lds
    s_add_u32 m0, s86, 9216
    s_nop 0
    buffer_load_dwordx4 v5, s[20:23], s85 offen  lds
    s_add_u32 m0, s86, 10240
    s_nop 0
    buffer_load_dwordx4 v7, s[20:23], s85 offen  lds
    s_add_u32 m0, s86, 11264
    s_nop 0
    buffer_load_dwordx4 v8, s[20:23], s85 offen  lds
    buffer_load_dwordx4 v[136:139], v6, s[32:35], s84 offen offset:0 sc1
    buffer_load_dwordx4 v[140:143], v6, s[32:35], s84 offen offset:1024 sc1
    buffer_load_dwordx4 v[144:147], v6, s[32:35], s84 offen offset:2048 sc1
    buffer_load_dwordx4 v[148:151], v224, s[32:35], s84 offen offset:3072 sc1
    buffer_load_dwordx4 v[152:155], v225, s[32:35], s84 offen offset:0 sc1
    s_add_u32 s85, s85, 147456
    s_add_u32 s84, s84, 20480
    s_waitcnt vmcnt(23)
    ds_read_b64_tr_b16 v[176:177], v9 offset:0
    ds_read_b64_tr_b16 v[178:179], v9 offset:2048
    ds_read_b64_tr_b16 v[180:181], v10 offset:0
    ds_read_b64_tr_b16 v[182:183], v10 offset:2048
    ds_read_b64_tr_b16 v[184:185], v9 offset:512
    ds_read_b64_tr_b16 v[186:187], v9 offset:2560
    ds_read_b64_tr_b16 v[188:189], v10 offset:512
    ds_read_b64_tr_b16 v[190:191], v10 offset:2560
    s_mov_b32 s87, 0
L_g2loop:
    s_cmp_eq_u32 s87, 1
    s_cbranch_scc1 L_hk_p2
L_hk_p2_r:
    s_waitcnt vmcnt(14) lgkmcnt(0)
    s_add_u32 m0, s86, 0
    v_mfma_f32_16x16x32_bf16 v[16:19], v[176:179], v[96:99], v[16:19]
    buffer_load_dwordx4 v4, s[20:23], s85 offen  lds
    s_add_u32 m0, s86, 1024
    v_mfma_f32_16x16x32_bf16 v[20:23], v[180:183], v[96:99], v[20:23]
    buffer_load_dwordx4 v5, s[20:23], s85 offen  lds
    s_add_u32 m0, s86, 2048
    v_mfma_f32_16x16x32_bf16 v[24:27], v[184:187], v[96:99], v[24:27]
    buffer_load_dwordx4 v7, s[20:23], s85 offen  lds
    s_add_u32 m0, s86, 3072
    v_mfma_f32_16x16x32_bf16 v[28:31], v[188:191], v[96:99], v[28:31]
    buffer_load_dwordx4 v8, s[20:23], s85 offen  lds
    buffer_load_dwordx4 v[96:99], v6, s[32:35], s84 offen offset:0 sc1
    v_mfma_f32_16x16x32_bf16 v[32:35], v[176:179], v[100:103], v[32:35]
    ds_read_b64_tr_b16 v[192:193], v9 offset:4096
    s_add_u32 s85, s85, 147456
    v_mfma_f32_16x16x32_bf16 v[36:39], v[180:183], v[100:103], v[36:39]
    ds_read_b64_tr_b16 v[194:195], v9 offset:6144
    s_add_u32 s74, s84, 20480
    v_mfma_f32_16x16x32_bf16 v[40:43], v[184:187], v[100:103], v[40:43]
    ds_read_b64_tr_b16 v[196:197], v10 offset:4096
    v_mfma_f32_16x16x32_bf16 v[44:47], v[188:191], v[100:103], v[44:47]
    ds_read_b64_tr_b16 v[198:199], v10 offset:6144
    buffer_load_dwordx4 v[100:103], v6, s[32:35], s84 offen offset:1024 sc1
    v_mfma_f32_16x16x32_bf16 v[48:51], v[176:179], v[104:107], v[48:51]
    ds_read_b64_tr_b16 v[200:201], v9 offset:4608
    v_mfma_f32_16x16x32_bf16 v[52:55], v[180:183], v[104:107], v[52:55]
    ds_read_b64_tr_b16 v[202:203], v9 offset:6656
    v_mfma_f32_16x16x32_bf16 v[56:59], v[184:187], v[104:107], v[56:59]
    ds_read_b64_tr_b16 v[204:205], v10 offset:4608
    v_mfma_f32_16x16x32_bf16 v[60:63], v[188:191], v[104:107], v[60:63]
    ds_read_b64_tr_b16 v[206:207], v10 offset:6656
    buffer_load_dwordx4 v[104:107], v6, s[32:35], s84 offen offset:2048 sc1
    v_mfma_f32_16x16x32_bf16 v[64:67], v[176:179], v[108:111], v[64:67]
    v_mfma_f32_16x16x32_bf16 v[68:71], v[180:183], v[108:111], v[68:71]
    v_mfma_f32_16x16x32_bf16 v[72:75], v[184:187], v[108:111], v[72:75]
    v_mfma_f32_16x16x32_bf16 v[76:79], v[188:191], v[108:111], v[76:79]
    buffer_load_dwordx4 v[108:111], v224, s[32:35], s84 offen offset:3072 sc1
    v_mfma_f32_16x16x32_bf16 v[80:83], v[176:179], v[112:115], v[80:83]
    v_mfma_f32_16x16x32_bf16 v[84:87], v[180:183], v[112:115], v[84:87]
    v_mfma_f32_16x16x32_bf16 v[88:91], v[184:187], v[112:115], v[88:91]
    v_mfma_f32_16x16x32_bf16 v[92:95], v[188:191], v[112:115], v[92:95]
    buffer_load_dwordx4 v[112:115], v225, s[32:35], s84 offen offset:0 sc1
    s_waitcnt vmcnt(14) lgkmcnt(0)
    s_add_u32 m0, s86, 4096
    v_mfma_f32_16x16x32_bf16 v[16:19], v[192:195], v[116:119], v[16:19]
    buffer_load_dwordx4 v4, s[20:23], s85 offen  lds
    s_add_u32 m0, s86, 5120
    v_mfma_f32_16x16x32_bf16 v[20:23], v[196:199], v[116:119], v[20:23]
    buffer_load_dwordx4 v5, s[20:23], s85 offen  lds
    s_add_u32 m0, s86, 6144
    v_mfma_f32_16x16x32_bf16 v[24:27], v[200:203], v[116:119], v[24:27]
    buffer_load_dwordx4 v7, s[20:23], s85 offen  lds
    s_add_u32 m0, s86, 7168
    v_mfma_f32_16x16x32_bf16 v[28:31], v[204:207], v[116:119], v[28:31]
    buffer_load_dwordx4 v8, s[20:23], s85 offen  lds
    buffer_load_dwordx4 v[116:119], v6, s[32:35], s74 offen offset:0 sc1
    v_mfma_f32_16x16x32_bf16 v[32:35], v[192:195], v[120:123], v[32:35]
    ds_read_b64_tr_b16 v[176:177], v9 offset:8192
    s_add_u32 s85, s85, 147456
    v_mfma_f32_16x16x32_bf16 v[36:39], v[196:199], v[120:123], v[36:39]
    ds_read_b64_tr_b16 v[178:179], v9 offset:10240
    s_add_u32 s84, s74, 20480
    v_mfma_f32_16x16x32_bf16 v[40:43], v[200:203], v[120:123], v[40:43]
    ds_read_b64_tr_b16 v[180:181], v10 offset:8192
    v_mfma_f32_16x16x32_bf16 v[44:47], v[204:207], v[120:123], v[44:47]
    ds_read_b64_tr_b16 v[182:183], v10 offset:10240
    buffer_load_dwordx4 v[120:123], v6, s[32:35], s74 offen offset:1024 sc1
    v_mfma_f32_16x16x32_bf16 v[48:51], v[192:195], v[124:127], v[48:51]
    ds_read_b64_tr_b16 v[184:185], v9 offset:8704
    v_mfma_f32_16x16x32_bf16 v[52:55], v[196:199], v[124:127], v[52:55]
    ds_read_b64_tr_b16 v[186:187], v9 offset:10752
    v_mfma_f32_16x16x32_bf16 v[56:59], v[200:203], v[124:127], v[56:59]
    ds_read_b64_tr_b16 v[188:189], v10 offset:8704
    v_mfma_f32_16x16x32_bf16 v[60:63], v[204:207], v[124:127], v[60:63]
    ds_read_b64_tr_b16 v[190:191], v10 offset:10752
    buffer_load_dwordx4 v[124:127], v6, s[32:35], s74 offen offset:2048 sc1
    v_mfma_f32_16x16x32_bf16 v[64:67], v[192:195], v[128:131], v[64:67]
    v_mfma_f32_16x16x32_bf16 v[68:71], v[196:199], v[128:131], v[68:71]
    v_mfma_f32_16x16x32_bf16 v[72:75], v[200:203], v[128:131], v[72:75]
    v_mfma_f32_16x16x32_bf16 v[76:79], v[204:207], v[128:131], v[76:79]
    buffer_load_dwordx4 v[128:131], v224, s[32:35], s74 offen offset:3072 sc1
    v_mfma_f32_16x16x32_bf16 v[80:83], v[192:195], v[132:135], v[80:83]
    v_mfma_f32_16x16x32_bf16 v[84:87], v[196:199], v[132:135], v[84:87]
    v_mfma_f32_16x16x32_bf16 v[88:91], v[200:203], v[132:135], v[88:91]
    v_mfma_f32_16x16x32_bf16 v[92:95], v[204:207], v[132:135], v[92:95]
    buffer_load_dwordx4 v[132:135], v225, s[32:35], s74 offen offset:0 sc1
    s_cmp_eq_u32 s87, 2
    s_cbranch_scc1 L_hk_p3
L_hk_p3_r:
    s_waitcnt vmcnt(14) lgkmcnt(0)
    s_add_u32 m0, s86, 8192
    v_mfma_f32_16x16x32_bf16 v[16:19], v[176:179], v[136:139], v[16:19]
    buffer_load_dwordx4 v4, s[20:23], s85 offen  lds
    s_add_u32 m0, s86, 9216
    v_mfma_f32_16x16x32_bf16 v[20:23], v[180:183], v[136:139], v[20:23]
    buffer_load_dwordx4 v5, s[20:23], s85 offen  lds
    s_add_u32 m0, s86, 10240
    v_mfma_f32_16x16x32_bf16 v[24:27], v[184:187], v[136:139], v[24:27]
    buffer_load_dwordx4 v7, s[20:23], s85 offen  lds
    s_add_u32 m0, s86, 11264
    v_mfma_f32_16x16x32_bf16 v[28:31], v[188:191], v[136:139], v[28:31]
    buffer_load_dwordx4 v8, s[20:23], s85 offen  lds
    buffer_load_dwordx4 v[136:139], v6, s[32:35], s84 offen offset:0 sc1
    v_mfma_f32_16x16x32_bf16 v[32:35], v[176:179], v[140:143], v[32:35]
    ds_read_b64_tr_b16 v[192:193], v9 offset:0
    s_add_u32 s85, s85, 147456
    v_mfma_f32_16x16x32_bf16 v[36:39], v[180:183], v[140:143], v[36:39]
    ds_read_b64_tr_b16 v[194:195], v9 offset:2048
    s_add_u32 s74, s84, 20480
    v_mfma_f32_16x16x32_bf16 v[40:43], v[184:187], v[140:143], v[40:43]
    ds_read_b64_tr_b16 v[196:197], v10 offset:0
    v_mfma_f32_16x16x32_bf16 v[44:47], v[188:191], v[140:143], v[44:47]
    ds_read_b64_tr_b16 v[198:199], v10 offset:2048
    buffer_load_dwordx4 v[140:143], v6, s[32:35], s84 offen offset:1024 sc1
    v_mfma_f32_16x16x32_bf16 v[48:51], v[176:179], v[144:147], v[48:51]
    ds_read_b64_tr_b16 v[200:201], v9 offset:512
    v_mfma_f32_16x16x32_bf16 v[52:55], v[180:183], v[144:147], v[52:55]
    ds_read_b64_tr_b16 v[202:203], v9 offset:2560
    v_mfma_f32_16x16x32_bf16 v[56:59], v[184:187], v[144:147], v[56:59]
    ds_read_b64_tr_b16 v[204:205], v10 offset:512
    v_mfma_f32_16x16x32_bf16 v[60:63], v[188:191], v[144:147], v[60:63]
    ds_read_b64_tr_b16 v[206:207], v10 offset:2560
    buffer_load_dwordx4 v[144:147], v6, s[32:35], s84 offen offset:2048 sc1
    v_mfma_f32_16x16x32_bf16 v[64:67], v[176:179], v[148:151], v[64:67]
    v_mfma_f32_16x16x32_bf16 v[68:71], v[180:183], v[148:151], v[68:71]
    v_mfma_f32_16x16x32_bf16 v[72:75], v[184:187], v[148:151], v[72:75]
    v_mfma_f32_16x16x32_bf16 v[76:79], v[188:191], v[148:151], v[76:79]
    buffer_load_dwordx4 v[148:151], v224, s[32:35], s84 offen offset:3072 sc1
    v_mfma_f32_16x16x32_bf16 v[80:83], v[176:179], v[152:155], v[80:83]
    v_mfma_f32_16x16x32_bf16 v[84:87], v[180:183], v[152:155], v[84:87]
    v_mfma_f32_16x16x32_bf16 v[88:91], v[184:187], v[152:155], v[88:91]
    v_mfma_f32_16x16x32_bf16 v[92:95], v[188:191], v[152:155], v[92:95]
    buffer_load_dwordx4 v[152:155], v225, s[32:35], s84 offen offset:0 sc1
    s_cmp_eq_u32 s87, 1
    s_cbranch_scc1 L_hk_c2
L_hk_c2_r:
    s_waitcnt vmcnt(14) lgkmcnt(0)
    s_add_u32 m0, s86, 0
    v_mfma_f32_16x16x32_bf16 v[16:19], v[192:195], v[96:99], v[16:19]
    buffer_load_dwordx4 v4, s[20:23], s85 offen  lds
    s_add_u32 m0, s86, 1024
    v_mfma_f32_16x16x32_bf16 v[20:23], v[196:199], v[96:99], v[20:23]
    buffer_load_dwordx4 v5, s[20:23], s85 offen  lds
    s_add_u32 m0, s86, 2048
    v_mfma_f32_16x16x32_bf16 v[24:27], v[200:203], v[96:99], v[24:27]
    buffer_load_dwordx4 v7, s[20:23], s85 offen  lds
    s_add_u32 m0, s86, 3072
    v_mfma_f32_16x16x32_bf16 v[28:31], v[204:207], v[96:99], v[28:31]
    buffer_load_dwordx4 v8, s[20:23], s85 offen  lds
    buffer_load_dwordx4 v[96:99], v6, s[32:35], s74 offen offset:0 sc1
    v_mfma_f32_16x16x32_bf16 v[32:35], v[192:195], v[100:103], v[32:35]
    ds_read_b64_tr_b16 v[176:177], v9 offset:4096
    s_add_u32 s85, s85, 147456
    v_mfma_f32_16x16x32_bf16 v[36:39], v[196:199], v[100:103], v[36:39]
    ds_read_b64_tr_b16 v[178:179], v9 offset:6144
    s_add_u32 s84, s74, 20480
    v_mfma_f32_16x16x32_bf16 v[40:43], v[200:203], v[100:103], v[40:43]
    ds_read_b64_tr_b16 v[180:181], v10 offset:4096
    v_mfma_f32_16x16x32_bf16 v[44:47], v[204:207], v[100:103], v[44:47]
    ds_read_b64_tr_b16 v[182:183], v10 offset:6144
    buffer_load_dwordx4 v[100:103], v6, s[32:35], s74 offen offset:1024 sc1
    v_mfma_f32_16x16x32_bf16 v[48:51], v[192:195], v[104:107], v[48:51]
    ds_read_b64_tr_b16 v[184:185], v9 offset:4608
    v_mfma_f32_16x16x32_bf16 v[52:55], v[196:199], v[104:107], v[52:55]
    ds_read_b64_tr_b16 v[186:187], v9 offset:6656
    v_mfma_f32_16x16x32_bf16 v[56:59], v[200:203], v[104:107], v[56:59]
    ds_read_b64_tr_b16 v[188:189], v10 offset:4608
    v_mfma_f32_16x16x32_bf16 v[60:63], v[204:207], v[104:107], v[60:63]
    ds_read_b64_tr_b16 v[190:191], v10 offset:6656
    buffer_load_dwordx4 v[104:107], v6, s[32:35], s74 offen offset:2048 sc1
    v_mfma_f32_16x16x32_bf16 v[64:67], v[192:195], v[108:111], v[64:67]
    v_mfma_f32_16x16x32_bf16 v[68:71], v[196:199], v[108:111], v[68:71]
    v_mfma_f32_16x16x32_bf16 v[72:75], v[200:203], v[108:111], v[72:75]
    v_mfma_f32_16x16x32_bf16 v[76:79], v[204:207], v[108:111], v[76:79]
    buffer_load_dwordx4 v[108:111], v224, s[32:35], s74 offen offset:3072 sc1
    v_mfma_f32_16x16x32_bf16 v[80:83], v[192:195], v[112:115], v[80:83]
    v_mfma_f32_16x16x32_bf16 v[84:87], v[196:199], v[112:115], v[84:87]
    v_mfma_f32_16x16x32_bf16 v[88:91], v[200:203], v[112:115], v[88:91]
    v_mfma_f32_16x16x32_bf16 v[92:95], v[204:207], v[112:115], v[92:95]
    buffer_load_dwordx4 v[112:115], v225, s[32:35], s74 offen offset:0 sc1
    s_waitcnt vmcnt(14) lgkmcnt(0)
    s_add_u32 m0, s86, 4096
    v_mfma_f32_16x16x32_bf16 v[16:19], v[176:179], v[116:119], v[16:19]
    buffer_load_dwordx4 v4, s[20:23], s85 offen  lds
    s_add_u32 m0, s86, 5120
    v_mfma_f32_16x16x32_bf16 v[20:23], v[180:183], v[116:119], v[20:23]
    buffer_load_dwordx4 v5, s[20:23], s85 offen  lds
    s_add_u32 m0, s86, 6144
    v_mfma_f32_16x16x32_bf16 v[24:27], v[184:187], v[116:119], v[24:27]
    buffer_load_dwordx4 v7, s[20:23], s85 offen  lds
    s_add_u32 m0, s86, 7168
    v_mfma_f32_16x16x32_bf16 v[28:31], v[188:191], v[116:119], v[28:31]
    buffer_load_dwordx4 v8, s[20:23], s85 offen  lds
    buffer_load_dwordx4 v[116:119], v6, s[32:35], s84 offen offset:0 sc1
    v_mfma_f32_16x16x32_bf16 v[32:35], v[176:179], v[120:123], v[32:35]
    ds_read_b64_tr_b16 v[192:193], v9 offset:8192
    s_add_u32 s85, s85, 147456
    v_mfma_f32_16x16x32_bf16 v[36:39], v[180:183], v[120:123], v[36:39]
    ds_read_b64_tr_b16 v[194:195], v9 offset:10240
    s_add_u32 s74, s84, 20480
    v_mfma_f32_16x16x32_bf16 v[40:43], v[184:187], v[120:123], v[40:43]
    ds_read_b64_tr_b16 v[196:197], v10 offset:8192
    v_mfma_f32_16x16x32_bf16 v[44:47], v[188:191], v[120:123], v[44:47]
    ds_read_b64_tr_b16 v[198:199], v10 offset:10240
    buffer_load_dwordx4 v[120:123], v6, s[32:35], s84 offen offset:1024 sc1
    v_mfma_f32_16x16x32_bf16 v[48:51], v[176:179], v[124:127], v[48:51]
    ds_read_b64_tr_b16 v[200:201], v9 offset:8704
    v_mfma_f32_16x16x32_bf16 v[52:55], v[180:183], v[124:127], v[52:55]
    ds_read_b64_tr_b16 v[202:203], v9 offset:10752
    v_mfma_f32_16x16x32_bf16 v[56:59], v[184:187], v[124:127], v[56:59]
    ds_read_b64_tr_b16 v[204:205], v10 offset:8704
    v_mfma_f32_16x16x32_bf16 v[60:63], v[188:191], v[124:127], v[60:63]
    ds_read_b64_tr_b16 v[206:207], v10 offset:10752
    buffer_load_dwordx4 v[124:127], v6, s[32:35], s84 offen offset:2048 sc1
    v_mfma_f32_16x16x32_bf16 v[64:67], v[176:179], v[128:131], v[64:67]
    v_mfma_f32_16x16x32_bf16 v[68:71], v[180:183], v[128:131], v[68:71]
    v_mfma_f32_16x16x32_bf16 v[72:75], v[184:187], v[128:131], v[72:75]
    v_mfma_f32_16x16x32_bf16 v[76:79], v[188:191], v[128:131], v[76:79]
    buffer_load_dwordx4 v[128:131], v224, s[32:35], s84 offen offset:3072 sc1
    v_mfma_f32_16x16x32_bf16 v[80:83], v[176:179], v[132:135], v[80:83]
    v_mfma_f32_16x16x32_bf16 v[84:87], v[180:183], v[132:135], v[84:87]
    v_mfma_f32_16x16x32_bf16 v[88:91], v[184:187], v[132:135], v[88:91]
    v_mfma_f32_16x16x32_bf16 v[92:95], v[188:191], v[132:135], v[92:95]
    buffer_load_dwordx4 v[132:135], v225, s[32:35], s84 offen offset:0 sc1
    s_cmp_eq_u32 s87, 2
    s_cbranch_scc1 L_hk_c3
L_hk_c3_r:
    s_waitcnt vmcnt(14) lgkmcnt(0)
    s_add_u32 m0, s86, 8192
    v_mfma_f32_16x16x32_bf16 v[16:19], v[192:195], v[136:139], v[16:19]
    buffer_load_dwordx4 v4, s[20:23], s85 offen  lds
    s_add_u32 m0, s86, 9216
    v_mfma_f32_16x16x32_bf16 v[20:23], v[196:199], v[136:139], v[20:23]
    buffer_load_dwordx4 v5, s[20:23], s85 offen  lds
    s_add_u32 m0, s86, 10240
    v_mfma_f32_16x16x32_bf16 v[24:27], v[200:203], v[136:139], v[24:27]
    buffer_load_dwordx4 v7, s[20:23], s85 offen  lds
    s_add_u32 m0, s86, 11264
    v_mfma_f32_16x16x32_bf16 v[28:31], v[204:207], v[136:139], v[28:31]
    buffer_load_dwordx4 v8, s[20:23], s85 offen  lds
    buffer_load_dwordx4 v[136:139], v6, s[32:35], s74 offen offset:0 sc1
    v_mfma_f32_16x16x32_bf16 v[32:35], v[192:195], v[140:143], v[32:35]
    ds_read_b64_tr_b16 v[176:177], v9 offset:0
    s_add_u32 s85, s85, 147456
    v_mfma_f32_16x16x32_bf16 v[36:39], v[196:199], v[140:143], v[36:39]
    ds_read_b64_tr_b16 v[178:179], v9 offset:2048
    s_add_u32 s84, s74, 20480
    v_mfma_f32_16x16x32_bf16 v[40:43], v[200:203], v[140:143], v[40:43]
    ds_read_b64_tr_b16 v[180:181], v10 offset:0
    v_mfma_f32_16x16x32_bf16 v[44:47], v[204:207], v[140:143], v[44:47]
    ds_read_b64_tr_b16 v[182:183], v10 offset:2048
    buffer_load_dwordx4 v[140:143], v6, s[32:35], s74 offen offset:1024 sc1
    v_mfma_f32_16x16x32_bf16 v[48:51], v[192:195], v[144:147], v[48:51]
    ds_read_b64_tr_b16 v[184:185], v9 offset:512
    v_mfma_f32_16x16x32_bf16 v[52:55], v[196:199], v[144:147], v[52:55]
    ds_read_b64_tr_b16 v[186:187], v9 offset:2560
    v_mfma_f32_16x16x32_bf16 v[56:59], v[200:203], v[144:147], v[56:59]
    ds_read_b64_tr_b16 v[188:189], v10 offset:512
    v_mfma_f32_16x16x32_bf16 v[60:63], v[204:207], v[144:147], v[60:63]
    ds_read_b64_tr_b16 v[190:191], v10 offset:2560
    buffer_load_dwordx4 v[144:147], v6, s[32:35], s74 offen offset:2048 sc1
    v_mfma_f32_16x16x32_bf16 v[64:67], v[192:195], v[148:151], v[64:67]
    v_mfma_f32_16x16x32_bf16 v[68:71], v[196:199], v[148:151], v[68:71]
    v_mfma_f32_16x16x32_bf16 v[72:75], v[200:203], v[148:151], v[72:75]
    v_mfma_f32_16x16x32_bf16 v[76:79], v[204:207], v[148:151], v[76:79]
    buffer_load_dwordx4 v[148:151], v224, s[32:35], s74 offen offset:3072 sc1
    v_mfma_f32_16x16x32_bf16 v[80:83], v[192:195], v[152:155], v[80:83]
    v_mfma_f32_16x16x32_bf16 v[84:87], v[196:199], v[152:155], v[84:87]
    v_mfma_f32_16x16x32_bf16 v[88:91], v[200:203], v[152:155], v[88:91]
    v_mfma_f32_16x16x32_bf16 v[92:95], v[204:207], v[152:155], v[92:95]
    buffer_load_dwordx4 v[152:155], v225, s[32:35], s74 offen offset:0 sc1
    s_add_u32 s87, s87, 1
    s_cmp_lg_u32 s87, 5
    s_cbranch_scc1 L_g2loop
    buffer_load_dword v3, v226, s[32:35], 0 offen sc1
    s_waitcnt vmcnt(14) lgkmcnt(0)
    s_add_u32 m0, s86, 0
    v_mfma_f32_16x16x32_bf16 v[16:19], v[176:179], v[96:99], v[16:19]
    buffer_load_dwordx4 v4, s[20:23], s85 offen  lds
    s_add_u32 m0, s86, 1024
    v_mfma_f32_16x16x32_bf16 v[20:23], v[180:183], v[96:99], v[20:23]
    buffer_load_dwordx4 v5, s[20:23], s85 offen  lds
    s_add_u32 m0, s86, 2048
    v_mfma_f32_16x16x32_bf16 v[24:27], v[184:187], v[96:99], v[24:27]
    buffer_load_dwordx4 v7, s[20:23], s85 offen  lds
    s_add_u32 m0, s86, 3072
    v_mfma_f32_16x16x32_bf16 v[28:31], v[188:191], v[96:99], v[28:31]
    buffer_load_dwordx4 v8, s[20:23], s85 offen  lds
    buffer_load_dwordx4 v[96:99], v6, s[32:35], s84 offen offset:0 sc1
    v_mfma_f32_16x16x32_bf16 v[32:35], v[176:179], v[100:103], v[32:35]
    ds_read_b64_tr_b16 v[192:193], v9 offset:4096
    s_add_u32 s85, s85, 147456
    v_mfma_f32_16x16x32_bf16 v[36:39], v[180:183], v[100:103], v[36:39]
    ds_read_b64_tr_b16 v[194:195], v9 offset:6144
    s_add_u32 s74, s84, 20480
    v_mfma_f32_16x16x32_bf16 v[40:43], v[184:187], v[100:103], v[40:43]
    ds_read_b64_tr_b16 v[196:197], v10 offset:4096
    v_mfma_f32_16x16x32_bf16 v[44:47], v[188:191], v[100:103], v[44:47]
    ds_read_b64_tr_b16 v[198:199], v10 offset:6144
    buffer_load_dwordx4 v[100:103], v6, s[32:35], s84 offen offset:1024 sc1
    v_mfma_f32_16x16x32_bf16 v[48:51], v[176:179], v[104:107], v[48:51]
    ds_read_b64_tr_b16 v[200:201], v9 offset:4608
    v_mfma_f32_16x16x32_bf16 v[52:55], v[180:183], v[104:107], v[52:55]
    ds_read_b64_tr_b16 v[202:203], v9 offset:6656
    v_mfma_f32_16x16x32_bf16 v[56:59], v[184:187], v[104:107], v[56:59]
    ds_read_b64_tr_b16 v[204:205], v10 offset:4608
    v_mfma_f32_16x16x32_bf16 v[60:63], v[188:191], v[104:107], v[60:63]
    ds_read_b64_tr_b16 v[206:207], v10 offset:6656
    buffer_load_dwordx4 v[104:107], v6, s[32:35], s84 offen offset:2048 sc1
    v_mfma_f32_16x16x32_bf16 v[64:67], v[176:179], v[108:111], v[64:67]
    v_mfma_f32_16x16x32_bf16 v[68:71], v[180:183], v[108:111], v[68:71]
    v_mfma_f32_16x16x32_bf16 v[72:75], v[184:187], v[108:111], v[72:75]
    v_mfma_f32_16x16x32_bf16 v[76:79], v[188:191], v[108:111], v[76:79]
    buffer_load_dwordx4 v[108:111], v224, s[32:35], s84 offen offset:3072 sc1
    v_mfma_f32_16x16x32_bf16 v[80:83], v[176:179], v[112:115], v[80:83]
    v_mfma_f32_16x16x32_bf16 v[84:87], v[180:183], v[112:115], v[84:87]
    v_mfma_f32_16x16x32_bf16 v[88:91], v[184:187], v[112:115], v[88:91]
    v_mfma_f32_16x16x32_bf16 v[92:95], v[188:191], v[112:115], v[92:95]
    buffer_load_dwordx4 v[112:115], v225, s[32:35], s84 offen offset:0 sc1
    s_waitcnt vmcnt(14) lgkmcnt(0)
    s_add_u32 m0, s86, 4096
    v_mfma_f32_16x16x32_bf16 v[16:19], v[192:195], v[116:119], v[16:19]
    buffer_load_dwordx4 v4, s[20:23], s85 offen  lds
    s_add_u32 m0, s86, 5120
    v_mfma_f32_16x16x32_bf16 v[20:23], v[196:199], v[116:119], v[20:23]
    buffer_load_dwordx4 v5, s[20:23], s85 offen  lds
    s_add_u32 m0, s86, 6144
    v_mfma_f32_16x16x32_bf16 v[24:27], v[200:203], v[116:119], v[24:27]
    buffer_load_dwordx4 v7, s[20:23], s85 offen  lds
    s_add_u32 m0, s86, 7168
    v_mfma_f32_16x16x32_bf16 v[28:31], v[204:207], v[116:119], v[28:31]
    buffer_load_dwordx4 v8, s[20:23], s85 offen  lds
    buffer_load_dwordx4 v[116:119], v6, s[32:35], s74 offen offset:0 sc1
    v_mfma_f32_16x16x32_bf16 v[32:35], v[192:195], v[120:123], v[32:35]
    ds_read_b64_tr_b16 v[176:177], v9 offset:8192
    s_add_u32 s85, s85, 147456
    v_mfma_f32_16x16x32_bf16 v[36:39], v[196:199], v[120:123], v[36:39]
    ds_read_b64_tr_b16 v[178:179], v9 offset:10240
    s_add_u32 s84, s74, 20480
    v_mfma_f32_16x16x32_bf16 v[40:43], v[200:203], v[120:123], v[40:43]
    ds_read_b64_tr_b16 v[180:181], v10 offset:8192
    v_mfma_f32_16x16x32_bf16 v[44:47], v[204:207], v[120:123], v[44:47]
    ds_read_b64_tr_b16 v[182:183], v10 offset:10240
    buffer_load_dwordx4 v[120:123], v6, s[32:35], s74 offen offset:1024 sc1
    v_mfma_f32_16x16x32_bf16 v[48:51], v[192:195], v[124:127], v[48:51]
    ds_read_b64_tr_b16 v[184:185], v9 offset:8704
    v_mfma_f32_16x16x32_bf16 v[52:55], v[196:199], v[124:127], v[52:55]
    ds_read_b64_tr_b16 v[186:187], v9 offset:10752
    v_mfma_f32_16x16x32_bf16 v[56:59], v[200:203], v[124:127], v[56:59]
    ds_read_b64_tr_b16 v[188:189], v10 offset:8704
    v_mfma_f32_16x16x32_bf16 v[60:63], v[204:207], v[124:127], v[60:63]
    ds_read_b64_tr_b16 v[190:191], v10 offset:10752
    buffer_load_dwordx4 v[124:127], v6, s[32:35], s74 offen offset:2048 sc1
    v_mfma_f32_16x16x32_bf16 v[64:67], v[192:195], v[128:131], v[64:67]
    v_mfma_f32_16x16x32_bf16 v[68:71], v[196:199], v[128:131], v[68:71]
    v_mfma_f32_16x16x32_bf16 v[72:75], v[200:203], v[128:131], v[72:75]
    v_mfma_f32_16x16x32_bf16 v[76:79], v[204:207], v[128:131], v[76:79]
    buffer_load_dwordx4 v[128:131], v224, s[32:35], s74 offen offset:3072 sc1
    v_mfma_f32_16x16x32_bf16 v[80:83], v[192:195], v[132:135], v[80:83]
    v_mfma_f32_16x16x32_bf16 v[84:87], v[196:199], v[132:135], v[84:87]
    v_mfma_f32_16x16x32_bf16 v[88:91], v[200:203], v[132:135], v[88:91]
    v_mfma_f32_16x16x32_bf16 v[92:95], v[204:207], v[132:135], v[92:95]
    buffer_load_dwordx4 v[132:135], v225, s[32:35], s74 offen offset:0 sc1
    s_waitcnt vmcnt(14) lgkmcnt(0)
    s_add_u32 m0, s86, 8192
    v_mfma_f32_16x16x32_bf16 v[16:19], v[176:179], v[136:139], v[16:19]
    buffer_load_dwordx4 v4, s[20:23], s85 offen  lds
    s_add_u32 m0, s86, 9216
    v_mfma_f32_16x16x32_bf16 v[20:23], v[180:183], v[136:139], v[20:23]
    buffer_load_dwordx4 v5, s[20:23], s85 offen  lds
    s_add_u32 m0, s86, 10240
    v_mfma_f32_16x16x32_bf16 v[24:27], v[184:187], v[136:139], v[24:27]
    buffer_load_dwordx4 v7, s[20:23], s85 offen  lds
    s_add_u32 m0, s86, 11264
    v_mfma_f32_16x16x32_bf16 v[28:31], v[188:191], v[136:139], v[28:31]
    buffer_load_dwordx4 v8, s[20:23], s85 offen  lds
    buffer_load_dwordx4 v[136:139], v6, s[32:35], s84 offen offset:0 sc1
    v_mfma_f32_16x16x32_bf16 v[32:35], v[176:179], v[140:143], v[32:35]
    ds_read_b64_tr_b16 v[192:193], v9 offset:0
    s_add_u32 s74, s82, 737280
    s_lshl_b32 s85, s81, 7
    s_lshl_b32 s40, s37, 2
    v_mfma_f32_16x16x32_bf16 v[36:39], v[180:183], v[140:143], v[36:39]
    ds_read_b64_tr_b16 v[194:195], v9 offset:2048
    s_add_u32 s41, s40, 0
    v_add_u32 v232, s41, v228
    v_mul_u32_u24 v233, 171, v232
    v_mfma_f32_16x16x32_bf16 v[40:43], v[184:187], v[140:143], v[40:43]
    ds_read_b64_tr_b16 v[196:197], v10 offset:0
    v_lshrrev_b32 v233, 9, v233
    v_mul_u32_u24 v234, 3, v233
    v_sub_u32 v232, v232, v234
    v_mfma_f32_16x16x32_bf16 v[44:47], v[188:191], v[140:143], v[44:47]
    ds_read_b64_tr_b16 v[198:199], v10 offset:2048
    v_mul_u32_u24 v232, v232, v232
    v_mul_u32_u24 v234, 18, v233
    v_and_b32 v234, -4, v234
    buffer_load_dwordx4 v[140:143], v6, s[32:35], s84 offen offset:1024 sc1
    v_mfma_f32_16x16x32_bf16 v[48:51], v[176:179], v[144:147], v[48:51]
    ds_read_b64_tr_b16 v[200:201], v9 offset:512
    v_lshl_add_u32 v234, v232, 2, v234
    v_add_u32 v234, v234, v229
    v_mul_u32_u24 v234, 1152, v234
    v_mfma_f32_16x16x32_bf16 v[52:55], v[180:183], v[144:147], v[52:55]
    ds_read_b64_tr_b16 v[202:203], v9 offset:2560
    v_add_u32 v4, v234, v227
    v_add_u32 v7, 9216, v4
    s_add_u32 s41, s40, 2
    v_mfma_f32_16x16x32_bf16 v[56:59], v[184:187], v[144:147], v[56:59]
    ds_read_b64_tr_b16 v[204:205], v10 offset:512
    v_add_u32 v232, s41, v228
    v_mul_u32_u24 v233, 171, v232
    v_lshrrev_b32 v233, 9, v233
    v_mfma_f32_16x16x32_bf16 v[60:63], v[188:191], v[144:147], v[60:63]
    ds_read_b64_tr_b16 v[206:207], v10 offset:2560
    v_mul_u32_u24 v234, 3, v233
    v_sub_u32 v232, v232, v234
    v_mul_u32_u24 v232, v232, v232
    buffer_load_dwordx4 v[144:147], v6, s[32:35], s84 offen offset:2048 sc1
    v_mfma_f32_16x16x32_bf16 v[64:67], v[176:179], v[148:151], v[64:67]
    v_mul_u32_u24 v234, 18, v233
    v_and_b32 v234, -4, v234
    v_lshl_add_u32 v234, v232, 2, v234
    v_mfma_f32_16x16x32_bf16 v[68:71], v[180:183], v[148:151], v[68:71]
    v_add_u32 v234, v234, v229
    v_mul_u32_u24 v234, 1152, v234
    v_add_u32 v5, v234, v227
    v_mfma_f32_16x16x32_bf16 v[72:75], v[184:187], v[148:151], v[72:75]
    v_add_u32 v8, 9216, v5
    v_mfma_f32_16x16x32_bf16 v[76:79], v[188:191], v[148:151], v[76:79]
    buffer_load_dwordx4 v[148:151], v224, s[32:35], s84 offen offset:3072 sc1
    v_mfma_f32_16x16x32_bf16 v[80:83], v[176:179], v[152:155], v[80:83]
    v_mfma_f32_16x16x32_bf16 v[84:87], v[180:183], v[152:155], v[84:87]
    v_mfma_f32_16x16x32_bf16 v[88:91], v[184:187], v[152:155], v[88:91]
    v_mfma_f32_16x16x32_bf16 v[92:95], v[188:191], v[152:155], v[92:95]
    buffer_load_dwordx4 v[152:155], v225, s[32:35], s84 offen offset:0 sc1
    s_mov_b32 s47, 100000
L_fa:
    v_cmp_ne_u32 vcc, s3, v3
    s_cbranch_vccz L_fa_ok
    s_sub_u32 s47, s47, 1
    s_cbranch_scc1 L_fa_ok
    s_sleep 16
    buffer_load_dword v3, v226, s[32:35], 0 offen sc1
    s_waitcnt vmcnt(0)
    s_branch L_fa
L_fa_ok:
    s_mov_b32 s20, s44
    s_mov_b32 s21, s45
    s_mov_b32 s22, 663552
    s_mov_b32 s23, 0x00020000
    s_waitcnt vmcnt(14) lgkmcnt(0)
    s_add_u32 m0, s86, 0
    v_mfma_f32_16x16x32_bf16 v[16:19], v[192:195], v[96:99], v[16:19]
    buffer_load_dwordx4 v4, s[20:23], s85 offen  lds
    s_add_u32 m0, s86, 1024
    v_mfma_f32_16x16x32_bf16 v[20:23], v[196:199], v[96:99], v[20:23]
    buffer_load_dwordx4 v5, s[20:23], s85 offen  lds
    s_add_u32 m0, s86, 2048
    v_mfma_f32_16x16x32_bf16 v[24:27], v[200:203], v[96:99], v[24:27]
    buffer_load_dwordx4 v7, s[20:23], s85 offen  lds
    s_add_u32 m0, s86, 3072
    v_mfma_f32_16x16x32_bf16 v[28:31], v[204:207], v[96:99], v[28:31]
    buffer_load_dwordx4 v8, s[20:23], s85 offen  lds
    buffer_load_dwordx4 v[96:99], v6, s[32:35], s74 offen offset:0 sc1
    v_mfma_f32_16x16x32_bf16 v[32:35], v[192:195], v[100:103], v[32:35]
    ds_read_b64_tr_b16 v[176:177], v9 offset:4096
    s_add_u32 s84, s82, 757760
    s_lshl_b32 s85, s81, 7
    s_lshl_b32 s40, s37, 2
    v_mfma_f32_16x16x32_bf16 v[36:39], v[196:199], v[100:103], v[36:39]
    ds_read_b64_tr_b16 v[178:179], v9 offset:6144
    s_add_u32 s41, s40, 16
    v_add_u32 v232, s41, v228
    v_mul_u32_u24 v233, 171, v232
    v_mfma_f32_16x16x32_bf16 v[40:43], v[200:203], v[100:103], v[40:43]
    ds_read_b64_tr_b16 v[180:181], v10 offset:4096
    v_lshrrev_b32 v233, 9, v233
    v_mul_u32_u24 v234, 3, v233
    v_sub_u32 v232, v232, v234
    v_mfma_f32_16x16x32_bf16 v[44:47], v[204:207], v[100:103], v[44:47]
    ds_read_b64_tr_b16 v[182:183], v10 offset:6144
    v_mul_u32_u24 v232, v232, v232
    v_mul_u32_u24 v234, 18, v233
    v_and_b32 v234, -4, v234
    buffer_load_dwordx4 v[100:103], v6, s[32:35], s74 offen offset:1024 sc1
    v_mfma_f32_16x16x32_bf16 v[48:51], v[192:195], v[104:107], v[48:51]
    ds_read_b64_tr_b16 v[184:185], v9 offset:4608
    v_lshl_add_u32 v234, v232, 2, v234
    v_add_u32 v234, v234, v229
    v_mul_u32_u24 v234, 1152, v234
    v_mfma_f32_16x16x32_bf16 v[52:55], v[196:199], v[104:107], v[52:55]
    ds_read_b64_tr_b16 v[186:187], v9 offset:6656
    v_add_u32 v4, v234, v227
    v_add_u32 v7, 9216, v4
    s_add_u32 s41, s40, 18
    v_mfma_f32_16x16x32_bf16 v[56:59], v[200:203], v[104:107], v[56:59]
    ds_read_b64_tr_b16 v[188:189], v10 offset:4608
    v_add_u32 v232, s41, v228
    v_mul_u32_u24 v233, 171, v232
    v_lshrrev_b32 v233, 9, v233
    v_mfma_f32_16x16x32_bf16 v[60:63], v[204:207], v[104:107], v[60:63]
    ds_read_b64_tr_b16 v[190:191], v10 offset:6656
    v_mul_u32_u24 v234, 3, v233
    v_sub_u32 v232, v232, v234
    v_mul_u32_u24 v232, v232, v232
    buffer_load_dwordx4 v[104:107], v6, s[32:35], s74 offen offset:2048 sc1
    v_mfma_f32_16x16x32_bf16 v[64:67], v[192:195], v[108:111], v[64:67]
    v_mul_u32_u24 v234, 18, v233
    v_and_b32 v234, -4, v234
    v_lshl_add_u32 v234, v232, 2, v234
    v_mfma_f32_16x16x32_bf16 v[68:71], v[196:199], v[108:111], v[68:71]
    v_add_u32 v234, v234, v229
    v_mul_u32_u24 v234, 1152, v234
    v_add_u32 v5, v234, v227
    v_mfma_f32_16x16x32_bf16 v[72:75], v[200:203], v[108:111], v[72:75]
    v_add_u32 v8, 9216, v5
    v_mfma_f32_16x16x32_bf16 v[76:79], v[204:207], v[108:111], v[76:79]
    buffer_load_dwordx4 v[108:111], v224, s[32:35], s74 offen offset:3072 sc1
    v_mfma_f32_16x16x32_bf16 v[80:83], v[192:195], v[112:115], v[80:83]
    v_mfma_f32_16x16x32_bf16 v[84:87], v[196:199], v[112:115], v[84:87]
    v_mfma_f32_16x16x32_bf16 v[88:91], v[200:203], v[112:115], v[88:91]
    v_mfma_f32_16x16x32_bf16 v[92:95], v[204:207], v[112:115], v[92:95]
    buffer_load_dwordx4 v[112:115], v225, s[32:35], s74 offen offset:0 sc1
    s_waitcnt vmcnt(14) lgkmcnt(0)
    s_add_u32 m0, s86, 4096
    v_mfma_f32_16x16x32_bf16 v[16:19], v[176:179], v[116:119], v[16:19]
    buffer_load_dwordx4 v4, s[20:23], s85 offen  lds
    s_add_u32 m0, s86, 5120
    v_mfma_f32_16x16x32_bf16 v[20:23], v[180:183], v[116:119], v[20:23]
    buffer_load_dwordx4 v5, s[20:23], s85 offen  lds
    s_add_u32 m0, s86, 6144
    v_mfma_f32_16x16x32_bf16 v[24:27], v[184:187], v[116:119], v[24:27]
    buffer_load_dwordx4 v7, s[20:23], s85 offen  lds
    s_add_u32 m0, s86, 7168
    v_mfma_f32_16x16x32_bf16 v[28:31], v[188:191], v[116:119], v[28:31]
    buffer_load_dwordx4 v8, s[20:23], s85 offen  lds
    buffer_load_dwordx4 v[116:119], v6, s[32:35], s84 offen offset:0 sc1
    v_mfma_f32_16x16x32_bf16 v[32:35], v[176:179], v[120:123], v[32:35]
    ds_read_b64_tr_b16 v[192:193], v9 offset:8192
    s_add_u32 s74, s82, 778240
    s_lshl_b32 s85, s81, 7
    s_lshl_b32 s40, s37, 2
    v_mfma_f32_16x16x32_bf16 v[36:39], v[180:183], v[120:123], v[36:39]
    ds_read_b64_tr_b16 v[194:195], v9 offset:10240
    s_add_u32 s41, s40, 32
    v_add_u32 v232, s41, v228
    v_mul_u32_u24 v233, 171, v232
    v_mfma_f32_16x16x32_bf16 v[40:43], v[184:187], v[120:123], v[40:43]
    ds_read_b64_tr_b16 v[196:197], v10 offset:8192
    v_lshrrev_b32 v233, 9, v233
    v_mul_u32_u24 v234, 3, v233
    v_sub_u32 v232, v232, v234
    v_mfma_f32_16x16x32_bf16 v[44:47], v[188:191], v[120:123], v[44:47]
    ds_read_b64_tr_b16 v[198:199], v10 offset:10240
    v_mul_u32_u24 v232, v232, v232
    v_mul_u32_u24 v234, 18, v233
    v_and_b32 v234, -4, v234
    buffer_load_dwordx4 v[120:123], v6, s[32:35], s84 offen offset:1024 sc1
    v_mfma_f32_16x16x32_bf16 v[48:51], v[176:179], v[124:127], v[48:51]
    ds_read_b64_tr_b16 v[200:201], v9 offset:8704
    v_lshl_add_u32 v234, v232, 2, v234
    v_add_u32 v234, v234, v229
    v_mul_u32_u24 v234, 1152, v234
    v_mfma_f32_16x16x32_bf16 v[52:55], v[180:183], v[124:127], v[52:55]
    ds_read_b64_tr_b16 v[202:203], v9 offset:10752
    v_add_u32 v4, v234, v227
    v_add_u32 v7, 9216, v4
    s_add_u32 s41, s40, 34
    v_mfma_f32_16x16x32_bf16 v[56:59], v[184:187], v[124:127], v[56:59]
    ds_read_b64_tr_b16 v[204:205], v10 offset:8704
    v_add_u32 v232, s41, v228
    v_mul_u32_u24 v233, 171, v232
    v_lshrrev_b32 v233, 9, v233
    v_mfma_f32_16x16x32_bf16 v[60:63], v[188:191], v[124:127], v[60:63]
    ds_read_b64_tr_b16 v[206:207], v10 offset:10752
    v_mul_u32_u24 v234, 3, v233
    v_sub_u32 v232, v232, v234
    v_mul_u32_u24 v232, v232, v232
    buffer_load_dwordx4 v[124:127], v6, s[32:35], s84 offen offset:2048 sc1
    v_mfma_f32_16x16x32_bf16 v[64:67], v[176:179], v[128:131], v[64:67]
    v_mul_u32_u24 v234, 18, v233
    v_and_b32 v234, -4, v234
    v_lshl_add_u32 v234, v232, 2, v234
    v_mfma_f32_16x16x32_bf16 v[68:71], v[180:183], v[128:131], v[68:71]
    v_add_u32 v234, v234, v229
    v_mul_u32_u24 v234, 1152, v234
    v_add_u32 v5, v234, v227
    v_mfma_f32_16x16x32_bf16 v[72:75], v[184:187], v[128:131], v[72:75]
    v_add_u32 v8, 9216, v5
    v_mfma_f32_16x16x32_bf16 v[76:79], v[188:191], v[128:131], v[76:79]
    buffer_load_dwordx4 v[128:131], v224, s[32:35], s84 offen offset:3072 sc1
    v_mfma_f32_16x16x32_bf16 v[80:83], v[176:179], v[132:135], v[80:83]
    v_mfma_f32_16x16x32_bf16 v[84:87], v[180:183], v[132:135], v[84:87]
    v_mfma_f32_16x16x32_bf16 v[88:91], v[184:187], v[132:135], v[88:91]
    v_mfma_f32_16x16x32_bf16 v[92:95], v[188:191], v[132:135], v[92:95]
    buffer_load_dwordx4 v[132:135], v225, s[32:35], s84 offen offset:0 sc1
    s_waitcnt vmcnt(14) lgkmcnt(0)
    s_add_u32 m0, s86, 8192
    v_mfma_f32_16x16x32_bf16 v[16:19], v[192:195], v[136:139], v[16:19]
    buffer_load_dwordx4 v4, s[20:23], s85 offen  lds
    s_add_u32 m0, s86, 9216
    v_mfma_f32_16x16x32_bf16 v[20:23], v[196:199], v[136:139], v[20:23]
    buffer_load_dwordx4 v5, s[20:23], s85 offen  lds
    s_add_u32 m0, s86, 10240
    v_mfma_f32_16x16x32_bf16 v[24:27], v[200:203], v[136:139], v[24:27]
    buffer_load_dwordx4 v7, s[20:23], s85 offen  lds
    s_add_u32 m0, s86, 11264
    v_mfma_f32_16x16x32_bf16 v[28:31], v[204:207], v[136:139], v[28:31]
    buffer_load_dwordx4 v8, s[20:23], s85 offen  lds
    buffer_load_dwordx4 v[136:139], v6, s[32:35], s74 offen offset:0 sc1
    v_mfma_f32_16x16x32_bf16 v[32:35], v[192:195], v[140:143], v[32:35]
    ds_read_b64_tr_b16 v[176:177], v9 offset:0
    s_add_u32 s84, s82, 798720
    s_lshl_b32 s85, s81, 7
    s_lshl_b32 s40, s37, 2
    v_mfma_f32_16x16x32_bf16 v[36:39], v[196:199], v[140:143], v[36:39]
    ds_read_b64_tr_b16 v[178:179], v9 offset:2048
    s_add_u32 s41, s40, 48
    v_add_u32 v232, s41, v228
    v_mul_u32_u24 v233, 171, v232
    v_mfma_f32_16x16x32_bf16 v[40:43], v[200:203], v[140:143], v[40:43]
    ds_read_b64_tr_b16 v[180:181], v10 offset:0
    v_lshrrev_b32 v233, 9, v233
    v_mul_u32_u24 v234, 3, v233
    v_sub_u32 v232, v232, v234
    v_mfma_f32_16x16x32_bf16 v[44:47], v[204:207], v[140:143], v[44:47]
    ds_read_b64_tr_b16 v[182:183], v10 offset:2048
    v_mul_u32_u24 v232, v232, v232
    v_mul_u32_u24 v234, 18, v233
    v_and_b32 v234, -4, v234
    buffer_load_dwordx4 v[140:143], v6, s[32:35], s74 offen offset:1024 sc1
    v_mfma_f32_16x16x32_bf16 v[48:51], v[192:195], v[144:147], v[48:51]
    ds_read_b64_tr_b16 v[184:185], v9 offset:512
    v_lshl_add_u32 v234, v232, 2, v234
    v_add_u32 v234, v234, v229
    v_mul_u32_u24 v234, 1152, v234
    v_mfma_f32_16x16x32_bf16 v[52:55], v[196:199], v[144:147], v[52:55]
    ds_read_b64_tr_b16 v[186:187], v9 offset:2560
    v_add_u32 v4, v234, v227
    v_add_u32 v7, 9216, v4
    s_add_u32 s41, s40, 50
    v_mfma_f32_16x16x32_bf16 v[56:59], v[200:203], v[144:147], v[56:59]
    ds_read_b64_tr_b16 v[188:189], v10 offset:512
    v_add_u32 v232, s41, v228
    v_mul_u32_u24 v233, 171, v232
    v_lshrrev_b32 v233, 9, v233
    v_mfma_f32_16x16x32_bf16 v[60:63], v[204:207], v[144:147], v[60:63]
    ds_read_b64_tr_b16 v[190:191], v10 offset:2560
    v_mul_u32_u24 v234, 3, v233
    v_sub_u32 v232, v232, v234
    v_mul_u32_u24 v232, v232, v232
    buffer_load_dwordx4 v[144:147], v6, s[32:35], s74 offen offset:2048 sc1
    v_mfma_f32_16x16x32_bf16 v[64:67], v[192:195], v[148:151], v[64:67]
    v_mul_u32_u24 v234, 18, v233
    v_and_b32 v234, -4, v234
    v_lshl_add_u32 v234, v232, 2, v234
    v_mfma_f32_16x16x32_bf16 v[68:71], v[196:199], v[148:151], v[68:71]
    v_add_u32 v234, v234, v229
    v_mul_u32_u24 v234, 1152, v234
    v_add_u32 v5, v234, v227
    v_mfma_f32_16x16x32_bf16 v[72:75], v[200:203], v[148:151], v[72:75]
    v_add_u32 v8, 9216, v5
    v_mfma_f32_16x16x32_bf16 v[76:79], v[204:207], v[148:151], v[76:79]
    buffer_load_dwordx4 v[148:151], v224, s[32:35], s74 offen offset:3072 sc1
    v_mfma_f32_16x16x32_bf16 v[80:83], v[192:195], v[152:155], v[80:83]
    v_mfma_f32_16x16x32_bf16 v[84:87], v[196:199], v[152:155], v[84:87]
    v_mfma_f32_16x16x32_bf16 v[88:91], v[200:203], v[152:155], v[88:91]
    v_mfma_f32_16x16x32_bf16 v[92:95], v[204:207], v[152:155], v[92:95]
    buffer_load_dwordx4 v[152:155], v225, s[32:35], s74 offen offset:0 sc1
    s_waitcnt vmcnt(14) lgkmcnt(0)
    s_add_u32 m0, s86, 0
    v_mfma_f32_16x16x32_bf16 v[16:19], v[176:179], v[96:99], v[16:19]
    buffer_load_dwordx4 v4, s[20:23], s85 offen  lds
    s_add_u32 m0, s86, 1024
    v_mfma_f32_16x16x32_bf16 v[20:23], v[180:183], v[96:99], v[20:23]
    buffer_load_dwordx4 v5, s[20:23], s85 offen  lds
    s_add_u32 m0, s86, 2048
    v_mfma_f32_16x16x32_bf16 v[24:27], v[184:187], v[96:99], v[24:27]
    buffer_load_dwordx4 v7, s[20:23], s85 offen  lds
    s_add_u32 m0, s86, 3072
    v_mfma_f32_16x16x32_bf16 v[28:31], v[188:191], v[96:99], v[28:31]
    buffer_load_dwordx4 v8, s[20:23], s85 offen  lds
    buffer_load_dwordx4 v[96:99], v6, s[32:35], s84 offen offset:0 sc1
    v_mfma_f32_16x16x32_bf16 v[32:35], v[176:179], v[100:103], v[32:35]
    ds_read_b64_tr_b16 v[192:193], v9 offset:4096
    s_add_u32 s74, s82, 819200
    s_lshl_b32 s85, s81, 7
    s_lshl_b32 s40, s37, 2
    v_mfma_f32_16x16x32_bf16 v[36:39], v[180:183], v[100:103], v[36:39]
    ds_read_b64_tr_b16 v[194:195], v9 offset:6144
    s_add_u32 s41, s40, 64
    v_add_u32 v232, s41, v228
    v_mul_u32_u24 v233, 171, v232
    v_mfma_f32_16x16x32_bf16 v[40:43], v[184:187], v[100:103], v[40:43]
    ds_read_b64_tr_b16 v[196:197], v10 offset:4096
    v_lshrrev_b32 v233, 9, v233
    v_mul_u32_u24 v234, 3, v233
    v_sub_u32 v232, v232, v234
    v_mfma_f32_16x16x32_bf16 v[44:47], v[188:191], v[100:103], v[44:47]
    ds_read_b64_tr_b16 v[198:199], v10 offset:6144
    v_mul_u32_u24 v232, v232, v232
    v_mul_u32_u24 v234, 18, v233
    v_and_b32 v234, -4, v234
    buffer_load_dwordx4 v[100:103], v6, s[32:35], s84 offen offset:1024 sc1
    v_mfma_f32_16x16x32_bf16 v[48:51], v[176:179], v[104:107], v[48:51]
    ds_read_b64_tr_b16 v[200:201], v9 offset:4608
    v_lshl_add_u32 v234, v232, 2, v234
    v_add_u32 v234, v234, v229
    v_mul_u32_u24 v234, 1152, v234
    v_mfma_f32_16x16x32_bf16 v[52:55], v[180:183], v[104:107], v[52:55]
    ds_read_b64_tr_b16 v[202:203], v9 offset:6656
    v_add_u32 v4, v234, v227
    v_add_u32 v7, 9216, v4
    s_add_u32 s41, s40, 66
    v_mfma_f32_16x16x32_bf16 v[56:59], v[184:187], v[104:107], v[56:59]
    ds_read_b64_tr_b16 v[204:205], v10 offset:4608
    v_add_u32 v232, s41, v228
    v_mul_u32_u24 v233, 171, v232
    v_lshrrev_b32 v233, 9, v233
    v_mfma_f32_16x16x32_bf16 v[60:63], v[188:191], v[104:107], v[60:63]
    ds_read_b64_tr_b16 v[206:207], v10 offset:6656
    v_mul_u32_u24 v234, 3, v233
    v_sub_u32 v232, v232, v234
    v_mul_u32_u24 v232, v232, v232
    buffer_load_dwordx4 v[104:107], v6, s[32:35], s84 offen offset:2048 sc1
    v_mfma_f32_16x16x32_bf16 v[64:67], v[176:179], v[108:111], v[64:67]
    v_mul_u32_u24 v234, 18, v233
    v_and_b32 v234, -4, v234
    v_lshl_add_u32 v234, v232, 2, v234
    v_mfma_f32_16x16x32_bf16 v[68:71], v[180:183], v[108:111], v[68:71]
    v_add_u32 v234, v234, v229
    v_mul_u32_u24 v234, 1152, v234
    v_add_u32 v5, v234, v227
    v_mfma_f32_16x16x32_bf16 v[72:75], v[184:187], v[108:111], v[72:75]
    v_add_u32 v8, 9216, v5
    v_mfma_f32_16x16x32_bf16 v[76:79], v[188:191], v[108:111], v[76:79]
    buffer_load_dwordx4 v[108:111], v224, s[32:35], s84 offen offset:3072 sc1
    v_mfma_f32_16x16x32_bf16 v[80:83], v[176:179], v[112:115], v[80:83]
    v_mfma_f32_16x16x32_bf16 v[84:87], v[180:183], v[112:115], v[84:87]
    v_mfma_f32_16x16x32_bf16 v[88:91], v[184:187], v[112:115], v[88:91]
    v_mfma_f32_16x16x32_bf16 v[92:95], v[188:191], v[112:115], v[92:95]
    buffer_load_dwordx4 v[112:115], v225, s[32:35], s84 offen offset:0 sc1
    s_waitcnt vmcnt(14) lgkmcnt(0)
    s_add_u32 m0, s86, 4096
    v_mfma_f32_16x16x32_bf16 v[16:19], v[192:195], v[116:119], v[16:19]
    buffer_load_dwordx4 v4, s[20:23], s85 offen  lds
    s_add_u32 m0, s86, 5120
    v_mfma_f32_16x16x32_bf16 v[20:23], v[196:199], v[116:119], v[20:23]
    buffer_load_dwordx4 v5, s[20:23], s85 offen  lds
    s_add_u32 m0, s86, 6144
    v_mfma_f32_16x16x32_bf16 v[24:27], v[200:203], v[116:119], v[24:27]
    buffer_load_dwordx4 v7, s[20:23], s85 offen  lds
    s_add_u32 m0, s86, 7168
    v_mfma_f32_16x16x32_bf16 v[28:31], v[204:207], v[116:119], v[28:31]
    buffer_load_dwordx4 v8, s[20:23], s85 offen  lds
    buffer_load_dwordx4 v[116:119], v6, s[32:35], s74 offen offset:0 sc1
    v_mfma_f32_16x16x32_bf16 v[32:35], v[192:195], v[120:123], v[32:35]
    ds_read_b64_tr_b16 v[176:177], v9 offset:8192
    s_add_u32 s84, s82, 839680
    s_lshl_b32 s85, s81, 7
    s_lshl_b32 s40, s37, 2
    v_mfma_f32_16x16x32_bf16 v[36:39], v[196:199], v[120:123], v[36:39]
    ds_read_b64_tr_b16 v[178:179], v9 offset:10240
    s_add_u32 s41, s40, 80
    v_add_u32 v232, s41, v228
    v_mul_u32_u24 v233, 171, v232
    v_mfma_f32_16x16x32_bf16 v[40:43], v[200:203], v[120:123], v[40:43]
    ds_read_b64_tr_b16 v[180:181], v10 offset:8192
    v_lshrrev_b32 v233, 9, v233
    v_mul_u32_u24 v234, 3, v233
    v_sub_u32 v232, v232, v234
    v_mfma_f32_16x16x32_bf16 v[44:47], v[204:207], v[120:123], v[44:47]
    ds_read_b64_tr_b16 v[182:183], v10 offset:10240
    v_mul_u32_u24 v232, v232, v232
    v_mul_u32_u24 v234, 18, v233
    v_and_b32 v234, -4, v234
    buffer_load_dwordx4 v[120:123], v6, s[32:35], s74 offen offset:1024 sc1
    v_mfma_f32_16x16x32_bf16 v[48:51], v[192:195], v[124:127], v[48:51]
    ds_read_b64_tr_b16 v[184:185], v9 offset:8704
    v_lshl_add_u32 v234, v232, 2, v234
    v_add_u32 v234, v234, v229
    v_mul_u32_u24 v234, 1152, v234
    v_mfma_f32_16x16x32_bf16 v[52:55], v[196:199], v[124:127], v[52:55]
    ds_read_b64_tr_b16 v[186:187], v9 offset:10752
    v_add_u32 v4, v234, v227
    v_add_u32 v7, 9216, v4
    s_add_u32 s41, s40, 82
    v_mfma_f32_16x16x32_bf16 v[56:59], v[200:203], v[124:127], v[56:59]
    ds_read_b64_tr_b16 v[188:189], v10 offset:8704
    v_add_u32 v232, s41, v228
    v_mul_u32_u24 v233, 171, v232
    v_lshrrev_b32 v233, 9, v233
    v_mfma_f32_16x16x32_bf16 v[60:63], v[204:207], v[124:127], v[60:63]
    ds_read_b64_tr_b16 v[190:191], v10 offset:10752
    v_mul_u32_u24 v234, 3, v233
    v_sub_u32 v232, v232, v234
    v_mul_u32_u24 v232, v232, v232
    buffer_load_dwordx4 v[124:127], v6, s[32:35], s74 offen offset:2048 sc1
    v_mfma_f32_16x16x32_bf16 v[64:67], v[192:195], v[128:131], v[64:67]
    v_mul_u32_u24 v234, 18, v233
    v_and_b32 v234, -4, v234
    v_lshl_add_u32 v234, v232, 2, v234
    v_mfma_f32_16x16x32_bf16 v[68:71], v[196:199], v[128:131], v[68:71]
    v_add_u32 v234, v234, v229
    v_mul_u32_u24 v234, 1152, v234
    v_add_u32 v5, v234, v227
    v_mfma_f32_16x16x32_bf16 v[72:75], v[200:203], v[128:131], v[72:75]
    v_add_u32 v8, 9216, v5
    v_mfma_f32_16x16x32_bf16 v[76:79], v[204:207], v[128:131], v[76:79]
    buffer_load_dwordx4 v[128:131], v224, s[32:35], s74 offen offset:3072 sc1
    v_mfma_f32_16x16x32_bf16 v[80:83], v[192:195], v[132:135], v[80:83]
    v_mfma_f32_16x16x32_bf16 v[84:87], v[196:199], v[132:135], v[84:87]
    v_mfma_f32_16x16x32_bf16 v[88:91], v[200:203], v[132:135], v[88:91]
    v_mfma_f32_16x16x32_bf16 v[92:95], v[204:207], v[132:135], v[92:95]
    buffer_load_dwordx4 v[132:135], v225, s[32:35], s74 offen offset:0 sc1
    s_waitcnt vmcnt(14) lgkmcnt(0)
    s_add_u32 m0, s86, 8192
    v_mfma_f32_16x16x32_bf16 v[16:19], v[176:179], v[136:139], v[16:19]
    buffer_load_dwordx4 v4, s[20:23], s85 offen  lds
    s_add_u32 m0, s86, 9216
    v_mfma_f32_16x16x32_bf16 v[20:23], v[180:183], v[136:139], v[20:23]
    buffer_load_dwordx4 v5, s[20:23], s85 offen  lds
    s_add_u32 m0, s86, 10240
    v_mfma_f32_16x16x32_bf16 v[24:27], v[184:187], v[136:139], v[24:27]
    buffer_load_dwordx4 v7, s[20:23], s85 offen  lds
    s_add_u32 m0, s86, 11264
    v_mfma_f32_16x16x32_bf16 v[28:31], v[188:191], v[136:139], v[28:31]
    buffer_load_dwordx4 v8, s[20:23], s85 offen  lds
    buffer_load_dwordx4 v[136:139], v6, s[32:35], s84 offen offset:0 sc1
    v_mfma_f32_16x16x32_bf16 v[32:35], v[176:179], v[140:143], v[32:35]
    ds_read_b64_tr_b16 v[192:193], v9 offset:0
    v_mfma_f32_16x16x32_bf16 v[36:39], v[180:183], v[140:143], v[36:39]
    ds_read_b64_tr_b16 v[194:195], v9 offset:2048
    v_mfma_f32_16x16x32_bf16 v[40:43], v[184:187], v[140:143], v[40:43]
    ds_read_b64_tr_b16 v[196:197], v10 offset:0
    v_mfma_f32_16x16x32_bf16 v[44:47], v[188:191], v[140:143], v[44:47]
    ds_read_b64_tr_b16 v[198:199], v10 offset:2048
    buffer_load_dwordx4 v[140:143], v6, s[32:35], s84 offen offset:1024 sc1
    v_mfma_f32_16x16x32_bf16 v[48:51], v[176:179], v[144:147], v[48:51]
    ds_read_b64_tr_b16 v[200:201], v9 offset:512
    v_mfma_f32_16x16x32_bf16 v[52:55], v[180:183], v[144:147], v[52:55]
    ds_read_b64_tr_b16 v[202:203], v9 offset:2560
    v_mfma_f32_16x16x32_bf16 v[56:59], v[184:187], v[144:147], v[56:59]
    ds_read_b64_tr_b16 v[204:205], v10 offset:512
    v_mfma_f32_16x16x32_bf16 v[60:63], v[188:191], v[144:147], v[60:63]
    ds_read_b64_tr_b16 v[206:207], v10 offset:2560
    buffer_load_dwordx4 v[144:147], v6, s[32:35], s84 offen offset:2048 sc1
    v_mfma_f32_16x16x32_bf16 v[64:67], v[176:179], v[148:151], v[64:67]
    v_mfma_f32_16x16x32_bf16 v[68:71], v[180:183], v[148:151], v[68:71]
    v_mfma_f32_16x16x32_bf16 v[72:75], v[184:187], v[148:151], v[72:75]
    v_mfma_f32_16x16x32_bf16 v[76:79], v[188:191], v[148:151], v[76:79]
    buffer_load_dwordx4 v[148:151], v224, s[32:35], s84 offen offset:3072 sc1
    v_mfma_f32_16x16x32_bf16 v[80:83], v[176:179], v[152:155], v[80:83]
    v_mfma_f32_16x16x32_bf16 v[84:87], v[180:183], v[152:155], v[84:87]
    v_mfma_f32_16x16x32_bf16 v[88:91], v[184:187], v[152:155], v[88:91]
    v_mfma_f32_16x16x32_bf16 v[92:95], v[188:191], v[152:155], v[92:95]
    buffer_load_dwordx4 v[152:155], v225, s[32:35], s84 offen offset:0 sc1
    s_waitcnt vmcnt(14) lgkmcnt(0)
    v_mfma_f32_16x16x32_bf16 v[16:19], v[192:195], v[96:99], v[16:19]
    v_mfma_f32_16x16x32_bf16 v[20:23], v[196:199], v[96:99], v[20:23]
    v_mfma_f32_16x16x32_bf16 v[24:27], v[200:203], v[96:99], v[24:27]
    v_mfma_f32_16x16x32_bf16 v[28:31], v[204:207], v[96:99], v[28:31]
    v_mfma_f32_16x16x32_bf16 v[32:35], v[192:195], v[100:103], v[32:35]
    ds_read_b64_tr_b16 v[176:177], v9 offset:4096
    s_mul_i32 s42, s80, 92160
    s_lshl_b32 s40, s81, 7
    v_mfma_f32_16x16x32_bf16 v[36:39], v[196:199], v[100:103], v[36:39]
    ds_read_b64_tr_b16 v[178:179], v9 offset:6144
    s_add_u32 s42, s42, s40
    s_lshl_b32 s43, s37, 3
    v_mfma_f32_16x16x32_bf16 v[40:43], v[200:203], v[100:103], v[40:43]
    ds_read_b64_tr_b16 v[180:181], v10 offset:4096
    v_lshrrev_b32 v232, 3, v1
    v_add_u32 v232, s43, v232
    v_mfma_f32_16x16x32_bf16 v[44:47], v[204:207], v[100:103], v[44:47]
    ds_read_b64_tr_b16 v[182:183], v10 offset:6144
    v_and_b32 v233, 7, v1
    v_lshrrev_b32 v234, 4, v232
    v_mfma_f32_16x16x32_bf16 v[48:51], v[192:195], v[104:107], v[48:51]
    ds_read_b64_tr_b16 v[184:185], v9 offset:4608
    v_lshlrev_b32 v234, 12, v234
    v_lshl_add_u32 v234, v233, 9, v234
    v_mfma_f32_16x16x32_bf16 v[52:55], v[196:199], v[104:107], v[52:55]
    ds_read_b64_tr_b16 v[186:187], v9 offset:6656
    v_lshlrev_b32 v235, 1, v233
    v_xor_b32 v235, v235, v232
    v_mfma_f32_16x16x32_bf16 v[56:59], v[200:203], v[104:107], v[56:59]
    ds_read_b64_tr_b16 v[188:189], v10 offset:4608
    v_and_b32 v235, 15, v235
    v_lshl_add_u32 v230, v235, 4, v234
    v_mfma_f32_16x16x32_bf16 v[60:63], v[204:207], v[104:107], v[60:63]
    ds_read_b64_tr_b16 v[190:191], v10 offset:6656
    v_mul_u32_u24 v234, 1152, v232
    v_lshl_add_u32 v234, v233, 4, v234
    v_mfma_f32_16x16x32_bf16 v[64:67], v[192:195], v[108:111], v[64:67]
    v_add_u32 v231, s42, v234
    s_mov_b32 s40, 36864
    v_mfma_f32_16x16x32_bf16 v[68:71], v[196:199], v[108:111], v[68:71]
    s_mov_b32 s41, 73728
    buffer_load_dwordx4 v[236:239], v231, s[16:19], 0 offen
    v_mfma_f32_16x16x32_bf16 v[72:75], v[200:203], v[108:111], v[72:75]
    buffer_load_dwordx4 v[240:243], v231, s[16:19], s40 offen
    buffer_load_dwordx4 v[244:247], v231, s[16:19], s41 offen
    v_mfma_f32_16x16x32_bf16 v[76:79], v[204:207], v[108:111], v[76:79]
    v_mfma_f32_16x16x32_bf16 v[80:83], v[192:195], v[112:115], v[80:83]
    v_mfma_f32_16x16x32_bf16 v[84:87], v[196:199], v[112:115], v[84:87]
    v_mfma_f32_16x16x32_bf16 v[88:91], v[200:203], v[112:115], v[88:91]
    v_mfma_f32_16x16x32_bf16 v[92:95], v[204:207], v[112:115], v[92:95]
    s_waitcnt vmcnt(8) lgkmcnt(0)
    v_mfma_f32_16x16x32_bf16 v[16:19], v[176:179], v[116:119], v[16:19]
    v_mfma_f32_16x16x32_bf16 v[20:23], v[180:183], v[116:119], v[20:23]
    v_mfma_f32_16x16x32_bf16 v[24:27], v[184:187], v[116:119], v[24:27]
    v_mfma_f32_16x16x32_bf16 v[28:31], v[188:191], v[116:119], v[28:31]
    v_mfma_f32_16x16x32_bf16 v[32:35], v[176:179], v[120:123], v[32:35]
    ds_read_b64_tr_b16 v[192:193], v9 offset:8192
    v_mfma_f32_16x16x32_bf16 v[36:39], v[180:183], v[120:123], v[36:39]
    ds_read_b64_tr_b16 v[194:195], v9 offset:10240
    v_mfma_f32_16x16x32_bf16 v[40:43], v[184:187], v[120:123], v[40:43]
    ds_read_b64_tr_b16 v[196:197], v10 offset:8192
    v_mfma_f32_16x16x32_bf16 v[44:47], v[188:191], v[120:123], v[44:47]
    ds_read_b64_tr_b16 v[198:199], v10 offset:10240
    v_mfma_f32_16x16x32_bf16 v[48:51], v[176:179], v[124:127], v[48:51]
    ds_read_b64_tr_b16 v[200:201], v9 offset:8704
    v_mfma_f32_16x16x32_bf16 v[52:55], v[180:183], v[124:127], v[52:55]
    ds_read_b64_tr_b16 v[202:203], v9 offset:10752
    v_mfma_f32_16x16x32_bf16 v[56:59], v[184:187], v[124:127], v[56:59]
    ds_read_b64_tr_b16 v[204:205], v10 offset:8704
    v_mfma_f32_16x16x32_bf16 v[60:63], v[188:191], v[124:127], v[60:63]
    ds_read_b64_tr_b16 v[206:207], v10 offset:10752
    v_mfma_f32_16x16x32_bf16 v[64:67], v[176:179], v[128:131], v[64:67]
    v_mfma_f32_16x16x32_bf16 v[68:71], v[180:183], v[128:131], v[68:71]
    v_mfma_f32_16x16x32_bf16 v[72:75], v[184:187], v[128:131], v[72:75]
    v_mfma_f32_16x16x32_bf16 v[76:79], v[188:191], v[128:131], v[76:79]
    v_mfma_f32_16x16x32_bf16 v[80:83], v[176:179], v[132:135], v[80:83]
    v_mfma_f32_16x16x32_bf16 v[84:87], v[180:183], v[132:135], v[84:87]
    v_mfma_f32_16x16x32_bf16 v[88:91], v[184:187], v[132:135], v[88:91]
    v_mfma_f32_16x16x32_bf16 v[92:95], v[188:191], v[132:135], v[92:95]
    s_waitcnt vmcnt(3) lgkmcnt(0)
    v_mfma_f32_16x16x32_bf16 v[16:19], v[192:195], v[136:139], v[16:19]
    v_mfma_f32_16x16x32_bf16 v[20:23], v[196:199], v[136:139], v[20:23]
    v_mfma_f32_16x16x32_bf16 v[24:27], v[200:203], v[136:139], v[24:27]
    v_mfma_f32_16x16x32_bf16 v[28:31], v[204:207], v[136:139], v[28:31]
    v_mfma_f32_16x16x32_bf16 v[32:35], v[192:195], v[140:143], v[32:35]
    v_mfma_f32_16x16x32_bf16 v[36:39], v[196:199], v[140:143], v[36:39]
    v_mfma_f32_16x16x32_bf16 v[40:43], v[200:203], v[140:143], v[40:43]
    v_mfma_f32_16x16x32_bf16 v[44:47], v[204:207], v[140:143], v[44:47]
    v_mfma_f32_16x16x32_bf16 v[48:51], v[192:195], v[144:147], v[48:51]
    v_mfma_f32_16x16x32_bf16 v[52:55], v[196:199], v[144:147], v[52:55]
    v_mfma_f32_16x16x32_bf16 v[56:59], v[200:203], v[144:147], v[56:59]
    v_mfma_f32_16x16x32_bf16 v[60:63], v[204:207], v[144:147], v[60:63]
    v_mfma_f32_16x16x32_bf16 v[64:67], v[192:195], v[148:151], v[64:67]
    v_mfma_f32_16x16x32_bf16 v[68:71], v[196:199], v[148:151], v[68:71]
    v_mfma_f32_16x16x32_bf16 v[72:75], v[200:203], v[148:151], v[72:75]
    v_mfma_f32_16x16x32_bf16 v[76:79], v[204:207], v[148:151], v[76:79]
    v_mfma_f32_16x16x32_bf16 v[80:83], v[192:195], v[152:155], v[80:83]
    v_mfma_f32_16x16x32_bf16 v[84:87], v[196:199], v[152:155], v[84:87]
    v_mfma_f32_16x16x32_bf16 v[88:91], v[200:203], v[152:155], v[88:91]
    v_mfma_f32_16x16x32_bf16 v[92:95], v[204:207], v[152:155], v[92:95]
    v_and_b32 v232, 15, v1
    v_lshrrev_b32 v233, 5, v1
    v_lshlrev_b32 v233, 1, v233
    v_xor_b32 v232, v232, v233
    v_lshrrev_b32 v233, 4, v1
    v_lshlrev_b32 v233, 8, v233
    s_lshl_b32 s42, s37, 11
    s_add_u32 s42, s42, 149504
    v_xor_b32 v234, 0, v232
    v_lshl_add_u32 v234, v234, 4, v233
    v_add_u32 v208, s86, v234
    v_xor_b32 v234, 4, v232
    v_lshl_add_u32 v234, v234, 4, v233
    v_add_u32 v209, s86, v234
    v_xor_b32 v234, 8, v232
    v_lshl_add_u32 v234, v234, 4, v233
    v_add_u32 v210, s86, v234
    v_add_u32 v212, s42, v234
    v_xor_b32 v234, 12, v232
    v_lshl_add_u32 v234, v234, 4, v233
    v_add_u32 v211, s86, v234
    v_add_u32 v213, s42, v234
    ds_write_b128 v208, v[16:19] offset:0
    ds_write_b128 v209, v[20:23] offset:1024
    ds_write_b128 v210, v[24:27] offset:2048
    ds_write_b128 v211, v[28:31] offset:3072
    ds_write_b128 v208, v[32:35] offset:4096
    ds_write_b128 v209, v[36:39] offset:5120
    ds_write_b128 v210, v[40:43] offset:6144
    ds_write_b128 v211, v[44:47] offset:7168
    ds_write_b128 v208, v[48:51] offset:8192
    ds_write_b128 v209, v[52:55] offset:9216
    ds_write_b128 v210, v[56:59] offset:10240
    ds_write_b128 v211, v[60:63] offset:11264
    ds_write_b128 v208, v[64:67] offset:12288
    ds_write_b128 v209, v[68:71] offset:13312
    ds_write_b128 v210, v[72:75] offset:14336
    ds_write_b128 v211, v[76:79] offset:15360
    ds_write_b128 v208, v[80:83] offset:16384
    ds_write_b128 v209, v[84:87] offset:17408
    ds_write_b128 v212, v[88:91] offset:2048
    ds_write_b128 v213, v[92:95] offset:3072
    v_and_b32 v234, 0xfff, v230
    v_add_u32 v230, s83, v230
    v_cmp_gt_u32 vcc, 2048, v234
    s_add_u32 s42, s83, 16384
    v_mov_b32 v232, 149504
    v_mov_b32 v233, s42
    v_cndmask_b32 v232, v232, v233, vcc
    v_add_u32 v214, v232, v234
    v_mov_b32 v232, 2048
    v_mov_b32 v233, 18432
    v_cndmask_b32 v232, v232, v233, vcc
    v_add_u32 v215, v214, v232
    v_add_u32 v216, v215, v232
    v_add_u32 v217, v216, v232
    s_mov_b32 s40, 36864
    s_mov_b32 s41, 73728
    s_waitcnt vmcnt(0) lgkmcnt(0)
    s_barrier
    ds_read_b128 v[96:99], v230 offset:0
    ds_read_b128 v[100:103], v230 offset:256
    ds_read_b128 v[104:107], v230 offset:18432
    ds_read_b128 v[108:111], v230 offset:18688
    ds_read_b128 v[112:115], v230 offset:36864
    ds_read_b128 v[116:119], v230 offset:37120
    ds_read_b128 v[120:123], v230 offset:55296
    ds_read_b128 v[124:127], v230 offset:55552
    ds_read_b128 v[128:131], v230 offset:8192
    ds_read_b128 v[132:135], v230 offset:8448
    ds_read_b128 v[136:139], v230 offset:26624
    ds_read_b128 v[140:143], v230 offset:26880
    ds_read_b128 v[144:147], v230 offset:45056
    ds_read_b128 v[148:151], v230 offset:45312
    ds_read_b128 v[152:155], v230 offset:63488
    ds_read_b128 v[156:159], v230 offset:63744
    v_lshlrev_b32 v16, 16, v236
    v_and_b32 v17, 0xffff0000, v236
    v_lshlrev_b32 v18, 16, v237
    v_and_b32 v19, 0xffff0000, v237
    v_lshlrev_b32 v20, 16, v238
    v_and_b32 v21, 0xffff0000, v238
    v_lshlrev_b32 v22, 16, v239
    v_and_b32 v23, 0xffff0000, v239
    s_waitcnt lgkmcnt(8)
    v_pk_add_f32 v[96:97], v[96:97], v[104:105]
    v_pk_add_f32 v[112:113], v[112:113], v[120:121]
    v_pk_add_f32 v[98:99], v[98:99], v[106:107]
    v_pk_add_f32 v[114:115], v[114:115], v[122:123]
    v_pk_add_f32 v[100:101], v[100:101], v[108:109]
    v_pk_add_f32 v[116:117], v[116:117], v[124:125]
    v_pk_add_f32 v[102:103], v[102:103], v[110:111]
    v_pk_add_f32 v[118:119], v[118:119], v[126:127]
    v_pk_add_f32 v[96:97], v[96:97], v[16:17]
    v_pk_add_f32 v[98:99], v[98:99], v[18:19]
    v_pk_add_f32 v[100:101], v[100:101], v[20:21]
    v_pk_add_f32 v[102:103], v[102:103], v[22:23]
    v_pk_add_f32 v[96:97], v[96:97], v[112:113]
    v_pk_add_f32 v[98:99], v[98:99], v[114:115]
    v_pk_add_f32 v[100:101], v[100:101], v[116:117]
    v_pk_add_f32 v[102:103], v[102:103], v[118:119]
    v_cvt_pk_bf16_f32 v96, v96, v97
    v_cvt_pk_bf16_f32 v97, v98, v99
    v_cvt_pk_bf16_f32 v98, v100, v101
    v_cvt_pk_bf16_f32 v99, v102, v103
    buffer_store_dwordx4 v[96:99], v231, s[28:31], 0 offen sc1
    s_cmp_ge_u32 s37, 2
    s_cbranch_scc1 L_red2
    ds_read_b128 v[160:163], v214 offset:0
    ds_read_b128 v[164:167], v214 offset:256
    ds_read_b128 v[168:171], v215 offset:0
    ds_read_b128 v[172:175], v215 offset:256
    ds_read_b128 v[176:179], v216 offset:0
    ds_read_b128 v[180:183], v216 offset:256
    ds_read_b128 v[184:187], v217 offset:0
    ds_read_b128 v[188:191], v217 offset:256
    v_lshlrev_b32 v16, 16, v240
    v_and_b32 v17, 0xffff0000, v240
    v_lshlrev_b32 v18, 16, v241
    v_and_b32 v19, 0xffff0000, v241
    v_lshlrev_b32 v20, 16, v242
    v_and_b32 v21, 0xffff0000, v242
    v_lshlrev_b32 v22, 16, v243
    v_and_b32 v23, 0xffff0000, v243
    s_waitcnt lgkmcnt(8)
    v_pk_add_f32 v[128:129], v[128:129], v[136:137]
    v_pk_add_f32 v[144:145], v[144:145], v[152:153]
    v_pk_add_f32 v[130:131], v[130:131], v[138:139]
    v_pk_add_f32 v[146:147], v[146:147], v[154:155]
    v_pk_add_f32 v[132:133], v[132:133], v[140:141]
    v_pk_add_f32 v[148:149], v[148:149], v[156:157]
    v_pk_add_f32 v[134:135], v[134:135], v[142:143]
    v_pk_add_f32 v[150:151], v[150:151], v[158:159]
    v_pk_add_f32 v[128:129], v[128:129], v[16:17]
    v_pk_add_f32 v[130:131], v[130:131], v[18:19]
    v_pk_add_f32 v[132:133], v[132:133], v[20:21]
    v_pk_add_f32 v[134:135], v[134:135], v[22:23]
    v_pk_add_f32 v[128:129], v[128:129], v[144:145]
    v_pk_add_f32 v[130:131], v[130:131], v[146:147]
    v_pk_add_f32 v[132:133], v[132:133], v[148:149]
    v_pk_add_f32 v[134:135], v[134:135], v[150:151]
    v_cvt_pk_bf16_f32 v128, v128, v129
    v_cvt_pk_bf16_f32 v129, v130, v131
    v_cvt_pk_bf16_f32 v130, v132, v133
    v_cvt_pk_bf16_f32 v131, v134, v135
    buffer_store_dwordx4 v[128:131], v231, s[28:31], s40 offen sc1
    v_lshlrev_b32 v16, 16, v244
    v_and_b32 v17, 0xffff0000, v244
    v_lshlrev_b32 v18, 16, v245
    v_and_b32 v19, 0xffff0000, v245
    v_lshlrev_b32 v20, 16, v246
    v_and_b32 v21, 0xffff0000, v246
    v_lshlrev_b32 v22, 16, v247
    v_and_b32 v23, 0xffff0000, v247
    s_waitcnt lgkmcnt(0)
    v_pk_add_f32 v[160:161], v[160:161], v[168:169]
    v_pk_add_f32 v[176:177], v[176:177], v[184:185]
    v_pk_add_f32 v[162:163], v[162:163], v[170:171]
    v_pk_add_f32 v[178:179], v[178:179], v[186:187]
    v_pk_add_f32 v[164:165], v[164:165], v[172:173]
    v_pk_add_f32 v[180:181], v[180:181], v[188:189]
    v_pk_add_f32 v[166:167], v[166:167], v[174:175]
    v_pk_add_f32 v[182:183], v[182:183], v[190:191]
    v_pk_add_f32 v[160:161], v[160:161], v[16:17]
    v_pk_add_f32 v[162:163], v[162:163], v[18:19]
    v_pk_add_f32 v[164:165], v[164:165], v[20:21]
    v_pk_add_f32 v[166:167], v[166:167], v[22:23]
    v_pk_add_f32 v[160:161], v[160:161], v[176:177]
    v_pk_add_f32 v[162:163], v[162:163], v[178:179]
    v_pk_add_f32 v[164:165], v[164:165], v[180:181]
    v_pk_add_f32 v[166:167], v[166:167], v[182:183]
    v_cvt_pk_bf16_f32 v160, v160, v161
    v_cvt_pk_bf16_f32 v161, v162, v163
    v_cvt_pk_bf16_f32 v162, v164, v165
    v_cvt_pk_bf16_f32 v163, v166, v167
    buffer_store_dwordx4 v[160:163], v231, s[28:31], s41 offen sc1
    s_branch L_fin
L_red2:
    v_lshlrev_b32 v16, 16, v240
    v_and_b32 v17, 0xffff0000, v240
    v_lshlrev_b32 v18, 16, v241
    v_and_b32 v19, 0xffff0000, v241
    v_lshlrev_b32 v20, 16, v242
    v_and_b32 v21, 0xffff0000, v242
    v_lshlrev_b32 v22, 16, v243
    v_and_b32 v23, 0xffff0000, v243
    s_waitcnt lgkmcnt(0)
    v_pk_add_f32 v[128:129], v[128:129], v[136:137]
    v_pk_add_f32 v[144:145], v[144:145], v[152:153]
    v_pk_add_f32 v[130:131], v[130:131], v[138:139]
    v_pk_add_f32 v[146:147], v[146:147], v[154:155]
    v_pk_add_f32 v[132:133], v[132:133], v[140:141]
    v_pk_add_f32 v[148:149], v[148:149], v[156:157]
    v_pk_add_f32 v[134:135], v[134:135], v[142:143]
    v_pk_add_f32 v[150:151], v[150:151], v[158:159]
    v_pk_add_f32 v[128:129], v[128:129], v[16:17]
    v_pk_add_f32 v[130:131], v[130:131], v[18:19]
    v_pk_add_f32 v[132:133], v[132:133], v[20:21]
    v_pk_add_f32 v[134:135], v[134:135], v[22:23]
    v_pk_add_f32 v[128:129], v[128:129], v[144:145]
    v_pk_add_f32 v[130:131], v[130:131], v[146:147]
    v_pk_add_f32 v[132:133], v[132:133], v[148:149]
    v_pk_add_f32 v[134:135], v[134:135], v[150:151]
    v_cvt_pk_bf16_f32 v128, v128, v129
    v_cvt_pk_bf16_f32 v129, v130, v131
    v_cvt_pk_bf16_f32 v130, v132, v133
    v_cvt_pk_bf16_f32 v131, v134, v135
    buffer_store_dwordx4 v[128:131], v231, s[28:31], s40 offen sc1
    s_branch L_fin
L_hk_p2:
    buffer_load_dword v3, v2, s[32:35], 0 offen sc1
    s_branch L_hk_p2_r
L_hk_p3:
    buffer_load_dword v3, v2, s[32:35], 0 offen sc1
    s_branch L_hk_p3_r
L_hk_c2:
    s_mov_b32 s47, 100000
L_f2:
    v_cmp_ne_u32 vcc, s3, v3
    s_cbranch_vccz L_f2_ok
    s_sub_u32 s47, s47, 1
    s_cbranch_scc1 L_f2_ok
    s_sleep 16
    buffer_load_dword v3, v2, s[32:35], 0 offen sc1
    s_waitcnt vmcnt(0)
    s_branch L_f2
L_f2_ok:
    v_add_u32 v2, 4096, v2
    s_branch L_hk_c2_r
L_hk_c3:
    s_mov_b32 s47, 100000
L_f3:
    v_cmp_ne_u32 vcc, s3, v3
    s_cbranch_vccz L_f3_ok
    s_sub_u32 s47, s47, 1
    s_cbranch_scc1 L_f3_ok
    s_sleep 16
    buffer_load_dword v3, v2, s[32:35], 0 offen sc1
    s_waitcnt vmcnt(0)
    s_branch L_f3
L_f3_ok:
    s_branch L_hk_c3_r
L_fin:
L_end:
    s_endpgm
L_code_end:
.section .rodata,"a"
.p2align 6
.amdhsa_kernel parallel_sum__sliding_block__glu_gated_bilinear__prompt_kernel
  .amdhsa_next_free_vgpr 256
  .amdhsa_next_free_sgpr 102
  .amdhsa_accum_offset 256
  .amdhsa_group_segment_fixed_size 0
  .amdhsa_kernarg_size 80
  .amdhsa_user_sgpr_count 2
  .amdhsa_user_sgpr_kernarg_segment_ptr 1
  .amdhsa_system_sgpr_workgroup_id_x 1
  .amdhsa_float_denorm_mode_32 3
.end_amdhsa_kernel
```
